```python
import torch

def _softmax(x, axis=-1):
    return torch.softmax(x, dim=axis)

def _gelu(x):
    return torch.nn.functional.gelu(x, approximate='tanh')

def _silu(x):
    return torch.nn.functional.silu(x)

def _sigmoid(x):
    return torch.sigmoid(x)

def _layernorm(x, axis=-1, eps=1e-05):
    m = x.mean(dim=axis, keepdim=True)
    v = x.var(dim=axis, keepdim=True, unbiased=False)
    return (x - m) / torch.sqrt(v + eps)

def _scatter_add(tgt, idx, src, axis=0):
    return tgt.clone().index_add_(axis, idx, src)

def _segment_sum(src, seg, n):
    out = torch.zeros((n,) + src.shape[1:], dtype=src.dtype)
    return out.index_add_(0, seg, src)

def _pad(x, pw):
    flat = tuple((v for pair in reversed(pw) for v in pair))
    return torch.nn.functional.pad(x, flat)
kernel_name = 'concat_heads__memory_aug_recurrent_mem_tr__sliding_local_dilated__prompt'

def setup_inputs():

    _w = lambda a: (lambda t: t.to(torch.bfloat16) if t.is_floating_point() else t)(torch.as_tensor(a))

    def _A_setup():
        B, S, Dm = (1, 2048, 640)
        H, Dh = (32, 128)
        M, seg = (8, 32)
        seg = min(seg, S)
        S = S // seg * seg
        return {'x': _w((lambda *s: torch.randn(*s, dtype=torch.bfloat16) * 0.05)(B, S, Dm)), 'mem0': _w((lambda *s: torch.randn(*s, dtype=torch.bfloat16) * 1.6)(B, M, Dm)), 'Wq': _w((lambda *s: torch.randn(*s, dtype=torch.bfloat16) * 0.8)(Dm, H, Dh) * Dm ** (-0.5)), 'Wk': _w((lambda *s: torch.randn(*s, dtype=torch.bfloat16) * 0.8)(Dm, H, Dh) * Dm ** (-0.5)), 'Wv': _w((lambda *s: torch.randn(*s, dtype=torch.bfloat16) * 1.6)(Dm, H, Dh) * Dm ** (-0.5)), 'Wo': _w((lambda *s: torch.randn(*s, dtype=torch.bfloat16) * 1.6)(H, Dh, Dm) * (H * Dh) ** (-0.5)), 'seg_len': seg}
    _A_in = _A_setup()

    def _B_setup():
        B, S, D = (1, 2048, 640)
        return {'x': _w((lambda *s: torch.randn(*s, dtype=torch.bfloat16) * 0.2)(B, S, D)), 'wqkv': _w((lambda *s: torch.randn(*s, dtype=torch.bfloat16) * 0.2)(D, 3 * D)), 'wo': _w((lambda *s: torch.randn(*s, dtype=torch.bfloat16) * 0.05)(D, D))}
    _B_in = _B_setup()
    return {'A_x': _A_in['x'], 'A_mem0': _A_in['mem0'], 'A_Wq': _A_in['Wq'], 'A_Wk': _A_in['Wk'], 'A_Wv': _A_in['Wv'], 'A_Wo': _A_in['Wo'], 'A_seg_len': _A_in['seg_len'], 'B_x': _B_in['x'], 'B_wqkv': _B_in['wqkv'], 'B_wo': _B_in['wo']}

def reference(A_x, A_mem0, A_Wq, A_Wk, A_Wv, A_Wo, A_seg_len, B_x, B_wqkv, B_wo):

    def _A_ref(x, mem0, Wq, Wk, Wv, Wo, seg_len):
        B, S, Dm = x.shape
        H, Dh = (Wq.shape[1], Wq.shape[2])
        M = mem0.shape[1]
        scale = Dh ** (-0.5)
        n_seg = S // seg_len
        L = M + seg_len
        idx = torch.arange(L)
        mask = (idx[:, None] < M) | (idx[:, None] >= idx[None, :])
        mem = mem0
        outs = []
        for s in range(n_seg):
            xs = x[:, s * seg_len:(s + 1) * seg_len, :].clone()
            h = torch.concatenate([mem, xs], axis=1)
            q = torch.einsum('btd,dhe->bhte', h, Wq)
            k = torch.einsum('btd,dhe->bhte', h, Wk)
            v = torch.einsum('btd,dhe->bhte', h, Wv)
            scores = torch.einsum('bhqe,bhke->bhqk', q, k) * scale
            scores = torch.where(mask[None, None], scores, -1000000000.0)
            p = _softmax(scores, axis=-1)
            o = torch.einsum('bhqk,bhke->bhqe', p, v)
            o = torch.einsum('bhte,hed->btd', o, Wo)
            mem = o[:, :M, :].clone()
            outs.append(o[:, M:, :])
        return torch.concatenate(outs, axis=1)

    def _B_ref(x, wqkv, wo):
        B, S, D = x.shape
        H = 32
        Dh = D // H
        W, dil = (8, 2)
        qkv = (lambda x, *d: x.permute(*d))((x @ wqkv).reshape(B, S, 3, H, Dh), 2, 0, 3, 1, 4)
        q, k, v = (qkv[0], qkv[1], qkv[2])
        scale = Dh ** (-0.5)
        pos = torch.arange(S)
        off = torch.arange(W) * dil
        idx = pos[:, None] - off[None, :]
        mask = idx >= 0
        idx_c = torch.where(mask, idx, 0).reshape(-1)
        kg = k[:, :, idx_c, :].reshape(B, H, S, W, Dh)
        vg = v[:, :, idx_c, :].reshape(B, H, S, W, Dh)
        logits = torch.einsum('bhsd,bhswd->bhsw', q, kg) * scale
        logits = torch.where(mask[None, None, :, :], logits, -1000000000.0)
        attn = _softmax(logits, axis=-1)
        o = torch.einsum('bhsw,bhswd->bhsd', attn, vg)
        return (lambda x, *d: x.permute(*d))(o, 0, 2, 1, 3).reshape(B, S, D) @ wo
    a = _A_ref(A_x, A_mem0, A_Wq, A_Wk, A_Wv, A_Wo, A_seg_len)
    b = _B_ref(B_x, B_wqkv, B_wo)
    return torch.concatenate([a, b], axis=-1)
```

```asm
; @launch kernel=k0_transpose_kernel grid=(861,1,1) block=(256,1,1) lds=0
; @launch kernel=k2_chain_kernel grid=(256,1,1) block=(256,1,1) lds=123136
; @launch kernel=k3_attn_kernel grid=(384,1,1) block=(64,1,1) lds=0
; @launch kernel=k4_tail_kernel grid=(240,1,1) block=(512,1,1) lds=32768
.amdgcn_target "amdgcn-amd-amdhsa--gfx950"
.text
.globl k0_transpose_kernel
.p2align 8
.type k0_transpose_kernel,@function
k0_transpose_kernel:
    s_cmp_ge_u32 s2, 861
    s_cbranch_scc1 .k0_end
    s_load_dwordx2 s[4:5], s[0:1], 96
    s_waitcnt lgkmcnt(0)

    s_mov_b32 s12, s4
    s_mov_b32 s13, s5
    s_mov_b32 s14, 268435456
    s_mov_b32 s15, 0x00020000
    s_cmp_lt_u32 s2, 740
    s_cbranch_scc1 .k0_tr
    s_sub_u32 s3, s2, 740
    s_lshl_b32 s3, s3, 14
    s_add_u32 s3, s3, 134217728
    v_lshlrev_b32 v1, 4, v0
    v_add_u32 v1, s3, v1
    v_mov_b32 v4, 2
    v_mov_b32 v5, 2
    v_mov_b32 v6, 2
    v_mov_b32 v7, 2
    buffer_store_dwordx4 v[4:7], v1, s[12:15], 0 offen
    v_add_u32 v1, 0x1000, v1
    buffer_store_dwordx4 v[4:7], v1, s[12:15], 0 offen
    v_add_u32 v1, 0x1000, v1
    buffer_store_dwordx4 v[4:7], v1, s[12:15], 0 offen
    v_add_u32 v1, 0x1000, v1
    buffer_store_dwordx4 v[4:7], v1, s[12:15], 0 offen
    s_waitcnt vmcnt(0)
    s_endpgm

.k0_tr:
    v_lshrrev_b32 v1, 6, v0
    s_nop 1
    v_readfirstlane_b32 s3, v1
    s_lshl_b32 s6, s2, 2
    s_add_u32 s6, s6, s3

    s_cmp_ge_u32 s6, 640
    s_cbranch_scc1 .k0_j1
    s_sub_u32 s7, s6, 0
    s_load_dwordx2 s[8:9], s[0:1], 16
    s_lshr_b32 s20, s7, 6
    s_mul_i32 s21, s20, 64
    s_sub_u32 s21, s7, s21
    s_mov_b32 s22, 8192
    s_mov_b32 s23, 1280
    s_mov_b32 s24, 0
    s_mov_b32 s25, 5242880
    s_branch .k0_go
.k0_j1:
    s_cmp_ge_u32 s6, 1280
    s_cbranch_scc1 .k0_j2
    s_sub_u32 s7, s6, 640
    s_load_dwordx2 s[8:9], s[0:1], 24
    s_lshr_b32 s20, s7, 6
    s_mul_i32 s21, s20, 64
    s_sub_u32 s21, s7, s21
    s_mov_b32 s22, 8192
    s_mov_b32 s23, 1280
    s_mov_b32 s24, 5242880
    s_mov_b32 s25, 5242880
    s_branch .k0_go
.k0_j2:
    s_cmp_ge_u32 s6, 1920
    s_cbranch_scc1 .k0_j3
    s_sub_u32 s7, s6, 1280
    s_load_dwordx2 s[8:9], s[0:1], 32
    s_lshr_b32 s20, s7, 6
    s_mul_i32 s21, s20, 64
    s_sub_u32 s21, s7, s21
    s_mov_b32 s22, 8192
    s_mov_b32 s23, 1280
    s_mov_b32 s24, 10485760
    s_mov_b32 s25, 5242880
    s_branch .k0_go
.k0_j3:
    s_cmp_ge_u32 s6, 2560
    s_cbranch_scc1 .k0_j4
    s_sub_u32 s7, s6, 1920
    s_load_dwordx2 s[8:9], s[0:1], 40
    s_lshr_b32 s21, s7, 6
    s_mul_i32 s20, s21, 64
    s_sub_u32 s20, s7, s20
    s_mov_b32 s22, 1280
    s_mov_b32 s23, 8192
    s_mov_b32 s24, 16777216
    s_mov_b32 s25, 5242880
    s_branch .k0_go
.k0_j4:
    s_cmp_ge_u32 s6, 2860
    s_cbranch_scc1 .k0_j5
    s_sub_u32 s7, s6, 2560
    s_load_dwordx2 s[8:9], s[0:1], 64
    s_mul_i32 s20, s7, 2185
    s_lshr_b32 s20, s20, 16
    s_mul_i32 s21, s20, 30
    s_sub_u32 s21, s7, s21
    s_mov_b32 s22, 3840
    s_mov_b32 s23, 1280
    s_mov_b32 s24, 23068672
    s_mov_b32 s25, 2457600
    s_branch .k0_go
.k0_j5:
    s_cmp_ge_u32 s6, 2960
    s_cbranch_scc1 .k0_j6
    s_sub_u32 s7, s6, 2860
    s_load_dwordx2 s[8:9], s[0:1], 72
    s_mul_i32 s20, s7, 6554
    s_lshr_b32 s20, s20, 16
    s_mul_i32 s21, s20, 10
    s_sub_u32 s21, s7, s21
    s_mov_b32 s22, 1280
    s_mov_b32 s23, 1280
    s_mov_b32 s24, 26214400
    s_mov_b32 s25, 819200
    s_branch .k0_go
.k0_j6:
    s_endpgm
.k0_go:
    s_waitcnt lgkmcnt(0)
    s_mov_b32 s16, s8
    s_mov_b32 s17, s9
    s_mov_b32 s18, s25
    s_mov_b32 s19, 0x00020000
    v_and_b32 v1, 63, v0
    v_and_b32 v2, 7, v1
    v_lshrrev_b32 v3, 3, v1

    s_lshl_b32 s26, s20, 6
    v_lshlrev_b32 v4, 3, v3
    v_add_u32 v4, s26, v4
    v_mul_lo_u32 v5, v4, s22
    s_lshl_b32 s27, s21, 6
    v_lshlrev_b32 v6, 3, v2
    v_add_u32 v6, s27, v6
    v_lshlrev_b32 v7, 1, v6
    v_add_u32 v5, v5, v7
    v_mul_lo_u32 v8, v6, s23
    v_lshlrev_b32 v9, 1, v4
    v_add_u32 v8, v8, v9
    v_add_u32 v8, s24, v8

    buffer_load_dwordx4 v[16:19], v5, s[16:19], 0 offen
    v_add_u32 v5, s22, v5
    buffer_load_dwordx4 v[20:23], v5, s[16:19], 0 offen
    v_add_u32 v5, s22, v5
    buffer_load_dwordx4 v[24:27], v5, s[16:19], 0 offen
    v_add_u32 v5, s22, v5
    buffer_load_dwordx4 v[28:31], v5, s[16:19], 0 offen
    v_add_u32 v5, s22, v5
    buffer_load_dwordx4 v[32:35], v5, s[16:19], 0 offen
    v_add_u32 v5, s22, v5
    buffer_load_dwordx4 v[36:39], v5, s[16:19], 0 offen
    v_add_u32 v5, s22, v5
    buffer_load_dwordx4 v[40:43], v5, s[16:19], 0 offen
    v_add_u32 v5, s22, v5
    buffer_load_dwordx4 v[44:47], v5, s[16:19], 0 offen
    s_mov_b32 s28, 0x05040100
    s_mov_b32 s29, 0x07060302
    s_waitcnt vmcnt(0)
    v_perm_b32 v48, v20, v16, s28
    v_perm_b32 v49, v28, v24, s28
    v_perm_b32 v50, v36, v32, s28
    v_perm_b32 v51, v44, v40, s28
    v_perm_b32 v52, v20, v16, s29
    v_perm_b32 v53, v28, v24, s29
    v_perm_b32 v54, v36, v32, s29
    v_perm_b32 v55, v44, v40, s29
    v_perm_b32 v56, v21, v17, s28
    v_perm_b32 v57, v29, v25, s28
    v_perm_b32 v58, v37, v33, s28
    v_perm_b32 v59, v45, v41, s28
    v_perm_b32 v60, v21, v17, s29
    v_perm_b32 v61, v29, v25, s29
    v_perm_b32 v62, v37, v33, s29
    v_perm_b32 v63, v45, v41, s29
    v_perm_b32 v64, v22, v18, s28
    v_perm_b32 v65, v30, v26, s28
    v_perm_b32 v66, v38, v34, s28
    v_perm_b32 v67, v46, v42, s28
    v_perm_b32 v68, v22, v18, s29
    v_perm_b32 v69, v30, v26, s29
    v_perm_b32 v70, v38, v34, s29
    v_perm_b32 v71, v46, v42, s29
    v_perm_b32 v72, v23, v19, s28
    v_perm_b32 v73, v31, v27, s28
    v_perm_b32 v74, v39, v35, s28
    v_perm_b32 v75, v47, v43, s28
    v_perm_b32 v76, v23, v19, s29
    v_perm_b32 v77, v31, v27, s29
    v_perm_b32 v78, v39, v35, s29
    v_perm_b32 v79, v47, v43, s29
    buffer_store_dwordx4 v[48:51], v8, s[12:15], 0 offen
    v_add_u32 v8, s23, v8
    buffer_store_dwordx4 v[52:55], v8, s[12:15], 0 offen
    v_add_u32 v8, s23, v8
    buffer_store_dwordx4 v[56:59], v8, s[12:15], 0 offen
    v_add_u32 v8, s23, v8
    buffer_store_dwordx4 v[60:63], v8, s[12:15], 0 offen
    v_add_u32 v8, s23, v8
    buffer_store_dwordx4 v[64:67], v8, s[12:15], 0 offen
    v_add_u32 v8, s23, v8
    buffer_store_dwordx4 v[68:71], v8, s[12:15], 0 offen
    v_add_u32 v8, s23, v8
    buffer_store_dwordx4 v[72:75], v8, s[12:15], 0 offen
    v_add_u32 v8, s23, v8
    buffer_store_dwordx4 v[76:79], v8, s[12:15], 0 offen
    s_waitcnt vmcnt(0)
.k0_end:
    s_endpgm
.globl k2_chain_kernel
.p2align 8
.type k2_chain_kernel,@function
k2_chain_kernel:
    s_cmp_ge_u32 s2, 256
    s_cbranch_scc1 .k2_exit
    s_load_dwordx2 s[6:7], s[0:1], 88
    s_load_dwordx2 s[4:5], s[0:1], 96
    v_lshrrev_b32 v1, 6, v0
    s_nop 1
    v_readfirstlane_b32 s96, v1
    s_getreg_b32 s97, hwreg(HW_REG_XCC_ID)
    s_and_b32 s97, s97, 15
    s_mov_b32 s90, 0
    s_waitcnt lgkmcnt(0)

    s_mov_b32 s92, s6
    s_mov_b32 s93, s7
    s_mov_b32 s94, 256
    s_mov_b32 s95, 0x00020000
    s_mov_b32 s83, s2
    s_mov_b32 s84, s4
    s_mov_b32 s85, s5
    s_mov_b32 s86, 268435456
    s_mov_b32 s87, 0x00020000
    s_cmp_ge_u32 s97, 2
    s_cbranch_scc1 .k2_wstart
    s_lshl_b32 s98, s97, 6

    s_waitcnt vmcnt(0) lgkmcnt(0)
    s_barrier
    s_cmp_lg_u32 s96, 0
    s_cbranch_scc1 .at_1
    s_mov_b64 exec, 1

    v_mov_b32 v1, 1
    v_mov_b32 v2, s98
    buffer_atomic_add v1, v2, s[92:95], 0 offen sc0
    s_waitcnt vmcnt(0)
    v_mov_b32 v2, 122880
    ds_write_b32 v2, v1
    s_mov_b64 exec, -1

.at_1:
    s_waitcnt lgkmcnt(0)
    s_barrier
    v_mov_b32 v2, 122880
    ds_read_b32 v1, v2
    s_waitcnt lgkmcnt(0)
    v_readfirstlane_b32 s4, v1
    s_mov_b32 s90, 0

    s_cmp_ge_u32 s4, 32
    s_cbranch_scc1 .k2_wstart
    s_lshl_b32 s99, s97, 5
    s_add_u32 s99, s99, s4
    s_mov_b32 s98, 1
    s_branch .k2_chain

.k2_wstart:
    s_add_u32 s82, s97, 4
    s_sub_u32 s4, s82, 6
    s_cmp_ge_u32 s82, 6
    s_cselect_b32 s82, s4, s82
    s_sub_u32 s4, s82, 6
    s_cmp_ge_u32 s82, 6
    s_cselect_b32 s82, s4, s82
    s_sub_u32 s4, s82, 6
    s_cmp_ge_u32 s82, 6
    s_cselect_b32 s82, s4, s82
    s_mov_b32 s91, 6

.k2_wloop:
    s_lshl_b32 s98, s82, 2
    s_add_u32 s98, s98, 200

    s_waitcnt vmcnt(0) lgkmcnt(0)
    s_barrier
    s_cmp_lg_u32 s96, 0
    s_cbranch_scc1 .at_2
    s_mov_b64 exec, 1

    s_cmp_eq_u32 s90, 0
    s_cbranch_scc1 .at_3
    v_mov_b32 v3, 1
    v_mov_b32 v4, s90
    buffer_atomic_add v3, v4, s[84:87], 0 offen sc1

.at_3:
    v_mov_b32 v1, 1
    v_mov_b32 v2, s98
    buffer_atomic_add v1, v2, s[92:95], 0 offen sc0
    s_waitcnt vmcnt(0)
    v_mov_b32 v2, 122880
    ds_write_b32 v2, v1
    s_mov_b64 exec, -1

.at_2:
    s_waitcnt lgkmcnt(0)
    s_barrier
    v_mov_b32 v2, 122880
    ds_read_b32 v1, v2
    s_waitcnt lgkmcnt(0)
    v_readfirstlane_b32 s4, v1
    s_mov_b32 s90, 0

    s_mov_b32 s6, 6554
    s_cmp_lt_u32 s82, 2
    s_cselect_b32 s5, 12, 10
    s_cselect_b32 s6, 5462, s6
    s_lshl_b32 s7, s5, 3
    s_cmp_ge_u32 s4, s7
    s_cbranch_scc1 .k2_q2
    s_mul_i32 s6, s4, s6
    s_lshr_b32 s6, s6, 16
    s_mul_i32 s7, s6, s5
    s_sub_u32 s7, s4, s7
    s_min_u32 s5, s82, 2
    s_mul_i32 s2, s82, 5
    s_add_u32 s5, s5, s2
    s_lshr_b32 s2, s7, 1
    s_add_u32 s5, s5, s2
    s_and_b32 s7, s7, 1
    s_cmp_ge_u32 s5, 16
    s_cbranch_scc1 .k2_qv
    s_lshl_b32 s2, s6, 1
    s_add_u32 s2, s2, s7
    s_lshl_b32 s2, s2, 1
    s_and_b32 s7, s5, 1
    s_add_u32 s2, s2, s7
    s_lshl_b32 s2, s2, 3
    s_lshr_b32 s5, s5, 1
    s_add_u32 s2, s2, s5
    s_branch .k2_p1

.k2_qv:
    s_sub_u32 s5, s5, 16
    s_lshl_b32 s5, s5, 1
    s_add_u32 s5, s5, s7
    s_lshl_b32 s2, s6, 2
    s_and_b32 s7, s5, 3
    s_add_u32 s2, s2, s7
    s_add_u32 s2, s2, 32
    s_lshl_b32 s2, s2, 3
    s_lshr_b32 s5, s5, 2
    s_add_u32 s2, s2, s5
    s_branch .k2_p1

.k2_q2:
    s_sub_u32 s4, s4, s7
    s_cmp_lt_u32 s4, 64
    s_cbranch_scc1 .k2_q3
    s_sub_u32 s91, s91, 1
    s_cmp_eq_u32 s91, 0
    s_cbranch_scc1 .k2_claim
    s_add_u32 s82, s82, 1
    s_cmp_eq_u32 s82, 6
    s_cselect_b32 s82, 0, s82
    s_branch .k2_wloop

.k2_q3:
    s_lshr_b32 s6, s4, 2
    s_and_b32 s5, s4, 3
    s_lshl_b32 s2, s82, 2
    s_add_u32 s5, s5, s2
    s_cmp_ge_u32 s5, 16
    s_cbranch_scc1 .k2_qb
    s_lshl_b32 s2, s6, 1
    s_and_b32 s7, s5, 1
    s_add_u32 s2, s2, s7
    s_add_u32 s2, s2, 64
    s_lshl_b32 s2, s2, 3
    s_lshr_b32 s5, s5, 1
    s_add_u32 s2, s2, s5
    s_branch .k2_p1

.k2_qb:
    s_add_u32 s2, s6, 96
    s_lshl_b32 s2, s2, 3
    s_sub_u32 s5, s5, 16
    s_add_u32 s2, s2, s5

.k2_p1:
    s_cmp_ge_u32 s2, 896
    s_cbranch_scc1 .k2_claim
    v_lshrrev_b32 v1, 6, v0
    s_sub_u32 s5, s2, 0
    s_and_b32 s4, s5, 7
    v_readfirstlane_b32 s3, v1
    s_lshr_b32 s5, s5, 3
    v_and_b32 v1, 63, v0
    s_lshl_b32 s50, s3, 10

    s_cmp_ge_u32 s5, 32
    s_cbranch_scc1 .k2w_j1
    s_sub_u32 s7, s5, 0
    s_load_dwordx2 s[8:9], s[0:1], 96
    s_load_dwordx2 s[10:11], s[0:1], 0
    s_load_dwordx2 s[12:13], s[0:1], 96
    s_lshr_b32 s21, s7, 1
    s_mul_i32 s20, s21, 2
    s_sub_u32 s20, s7, s20
    s_mul_i32 s6, s4, 2
    s_add_u32 s20, s20, s6
    s_lshr_b32 s90, s21, 1
    s_lshl_b32 s90, s90, 7
    s_add_u32 s90, s90, 136183808
    v_lshrrev_b32 v2, 2, v1
    v_lshrrev_b32 v3, 4, v1
    v_xor_b32 v3, v3, v1
    v_and_b32 v3, 3, v3
    v_lshlrev_b32 v3, 4, v3
    s_lshl_b32 s6, s3, 4
    s_mul_i32 s22, s20, 256
    s_add_u32 s22, s22, s6
    s_mul_i32 s23, s21, 128
    s_add_u32 s23, s23, s6
    s_mov_b32 s24, 1280
    s_mov_b32 s25, 1280

    v_add_u32 v4, s22, v2
    v_mul_lo_u32 v4, v4, s24
    v_add_u32 v4, v4, v3
    v_add_u32 v4, 5242880, v4
    v_add_u32 v5, s22, v2
    v_add_u32 v5, 64, v5
    v_mul_lo_u32 v5, v5, s24
    v_add_u32 v5, v5, v3
    v_add_u32 v5, 5242880, v5
    v_add_u32 v6, s22, v2
    v_add_u32 v6, 128, v6
    v_mul_lo_u32 v6, v6, s24
    v_add_u32 v6, v6, v3
    v_add_u32 v6, 5242880, v6
    v_add_u32 v7, s22, v2
    v_add_u32 v7, 192, v7
    v_mul_lo_u32 v7, v7, s24
    v_add_u32 v7, v7, v3
    v_add_u32 v7, 5242880, v7
    v_add_u32 v8, s23, v2
    v_mul_lo_u32 v8, v8, s25
    v_add_u32 v8, v8, v3
    v_add_u32 v9, s23, v2
    v_add_u32 v9, 64, v9
    v_mul_lo_u32 v9, v9, s25
    v_add_u32 v9, v9, v3
    s_waitcnt lgkmcnt(0)
    s_mov_b32 s32, s8
    s_mov_b32 s33, s9
    s_mov_b32 s34, 268435456
    s_mov_b32 s35, 0x00020000
    s_mov_b32 s36, s10
    s_mov_b32 s37, s11
    s_mov_b32 s38, 2621440
    s_mov_b32 s39, 0x00020000
    s_mov_b32 s40, s12
    s_mov_b32 s41, s13
    s_mov_b32 s42, 268435456
    s_mov_b32 s43, 0x00020000
    s_mov_b32 s48, 0
    s_add_u32 m0, s50, 0
    s_nop 0
    buffer_load_dwordx4 v4, s[32:35], s48 offen lds
    s_add_u32 m0, s50, 4096
    s_nop 0
    buffer_load_dwordx4 v5, s[32:35], s48 offen lds
    s_add_u32 m0, s50, 8192
    s_nop 0
    buffer_load_dwordx4 v6, s[32:35], s48 offen lds
    s_add_u32 m0, s50, 12288
    s_nop 0
    buffer_load_dwordx4 v7, s[32:35], s48 offen lds
    s_add_u32 m0, s50, 16384
    s_nop 0
    buffer_load_dwordx4 v8, s[36:39], s48 offen lds
    s_add_u32 m0, s50, 20480
    s_nop 0
    buffer_load_dwordx4 v9, s[36:39], s48 offen lds
    s_add_u32 s48, s48, 64
    s_add_u32 m0, s50, 24576
    s_nop 0
    buffer_load_dwordx4 v4, s[32:35], s48 offen lds
    s_add_u32 m0, s50, 28672
    s_nop 0
    buffer_load_dwordx4 v5, s[32:35], s48 offen lds
    s_add_u32 m0, s50, 32768
    s_nop 0
    buffer_load_dwordx4 v6, s[32:35], s48 offen lds
    s_add_u32 m0, s50, 36864
    s_nop 0
    buffer_load_dwordx4 v7, s[32:35], s48 offen lds
    s_add_u32 m0, s50, 40960
    s_nop 0
    buffer_load_dwordx4 v8, s[36:39], s48 offen lds
    s_add_u32 m0, s50, 45056
    s_nop 0
    buffer_load_dwordx4 v9, s[36:39], s48 offen lds
    s_add_u32 s48, s48, 64
    s_add_u32 m0, s50, 49152
    s_nop 0
    buffer_load_dwordx4 v4, s[32:35], s48 offen lds
    s_add_u32 m0, s50, 53248
    s_nop 0
    buffer_load_dwordx4 v5, s[32:35], s48 offen lds
    s_add_u32 m0, s50, 57344
    s_nop 0
    buffer_load_dwordx4 v6, s[32:35], s48 offen lds
    s_add_u32 m0, s50, 61440
    s_nop 0
    buffer_load_dwordx4 v7, s[32:35], s48 offen lds
    s_add_u32 m0, s50, 65536
    s_nop 0
    buffer_load_dwordx4 v8, s[36:39], s48 offen lds
    s_add_u32 m0, s50, 69632
    s_nop 0
    buffer_load_dwordx4 v9, s[36:39], s48 offen lds
    s_add_u32 s48, s48, 64
    s_add_u32 m0, s50, 73728
    s_nop 0
    buffer_load_dwordx4 v4, s[32:35], s48 offen lds
    s_add_u32 m0, s50, 77824
    s_nop 0
    buffer_load_dwordx4 v5, s[32:35], s48 offen lds
    s_add_u32 m0, s50, 81920
    s_nop 0
    buffer_load_dwordx4 v6, s[32:35], s48 offen lds
    s_add_u32 m0, s50, 86016
    s_nop 0
    buffer_load_dwordx4 v7, s[32:35], s48 offen lds
    s_add_u32 m0, s50, 90112
    s_nop 0
    buffer_load_dwordx4 v8, s[36:39], s48 offen lds
    s_add_u32 m0, s50, 94208
    s_nop 0
    buffer_load_dwordx4 v9, s[36:39], s48 offen lds
    s_add_u32 s48, s48, 64
    s_add_u32 m0, s50, 98304
    s_nop 0
    buffer_load_dwordx4 v4, s[32:35], s48 offen lds
    s_add_u32 m0, s50, 102400
    s_nop 0
    buffer_load_dwordx4 v5, s[32:35], s48 offen lds
    s_add_u32 m0, s50, 106496
    s_nop 0
    buffer_load_dwordx4 v6, s[32:35], s48 offen lds
    s_add_u32 m0, s50, 110592
    s_nop 0
    buffer_load_dwordx4 v7, s[32:35], s48 offen lds
    s_add_u32 m0, s50, 114688
    s_nop 0
    buffer_load_dwordx4 v8, s[36:39], s48 offen lds
    s_add_u32 m0, s50, 118784
    s_nop 0
    buffer_load_dwordx4 v9, s[36:39], s48 offen lds
    s_add_u32 s48, s48, 64
    s_and_b32 s44, s3, 1
    s_lshr_b32 s45, s3, 1
    s_mul_i32 s44, s44, 128
    s_mul_i32 s45, s45, 64
    v_and_b32 v2, 31, v1
    v_lshrrev_b32 v3, 5, v1
    v_lshrrev_b32 v24, 2, v1
    v_xor_b32 v24, v24, v3
    v_and_b32 v24, 3, v24
    v_lshlrev_b32 v24, 4, v24
    v_add_u32 v10, s44, v2
    v_lshlrev_b32 v10, 6, v10
    v_add_u32 v10, v10, v24
    v_xor_b32 v11, 32, v10
    v_add_u32 v12, s45, v2
    v_lshlrev_b32 v12, 6, v12
    v_add_u32 v12, v12, v24
    v_add_u32 v12, 16384, v12
    v_xor_b32 v13, 32, v12

    v_add_u32 v14, 49152, v10
    v_add_u32 v15, 49152, v11
    v_add_u32 v16, 49152, v12
    v_add_u32 v17, 49152, v13
    v_add_u32 v18, 98304, v10
    v_add_u32 v19, 98304, v11
    v_add_u32 v20, 98304, v12
    v_add_u32 v21, 98304, v13
    v_mov_b32 v72, 0
    v_mov_b32 v73, 0
    v_mov_b32 v74, 0
    v_mov_b32 v75, 0
    v_mov_b32 v76, 0
    v_mov_b32 v77, 0
    v_mov_b32 v78, 0
    v_mov_b32 v79, 0
    v_mov_b32 v80, 0
    v_mov_b32 v81, 0
    v_mov_b32 v82, 0
    v_mov_b32 v83, 0
    v_mov_b32 v84, 0
    v_mov_b32 v85, 0
    v_mov_b32 v86, 0
    v_mov_b32 v87, 0
    v_mov_b32 v88, 0
    v_mov_b32 v89, 0
    v_mov_b32 v90, 0
    v_mov_b32 v91, 0
    v_mov_b32 v92, 0
    v_mov_b32 v93, 0
    v_mov_b32 v94, 0
    v_mov_b32 v95, 0
    v_mov_b32 v96, 0
    v_mov_b32 v97, 0
    v_mov_b32 v98, 0
    v_mov_b32 v99, 0
    v_mov_b32 v100, 0
    v_mov_b32 v101, 0
    v_mov_b32 v102, 0
    v_mov_b32 v103, 0
    v_mov_b32 v104, 0
    v_mov_b32 v105, 0
    v_mov_b32 v106, 0
    v_mov_b32 v107, 0
    v_mov_b32 v108, 0
    v_mov_b32 v109, 0
    v_mov_b32 v110, 0
    v_mov_b32 v111, 0
    v_mov_b32 v112, 0
    v_mov_b32 v113, 0
    v_mov_b32 v114, 0
    v_mov_b32 v115, 0
    v_mov_b32 v116, 0
    v_mov_b32 v117, 0
    v_mov_b32 v118, 0
    v_mov_b32 v119, 0
    v_mov_b32 v120, 0
    v_mov_b32 v121, 0
    v_mov_b32 v122, 0
    v_mov_b32 v123, 0
    v_mov_b32 v124, 0
    v_mov_b32 v125, 0
    v_mov_b32 v126, 0
    v_mov_b32 v127, 0
    v_mov_b32 v128, 0
    v_mov_b32 v129, 0
    v_mov_b32 v130, 0
    v_mov_b32 v131, 0
    v_mov_b32 v132, 0
    v_mov_b32 v133, 0
    v_mov_b32 v134, 0
    v_mov_b32 v135, 0
    v_mov_b32 v136, 0
    v_mov_b32 v137, 0
    v_mov_b32 v138, 0
    v_mov_b32 v139, 0
    v_mov_b32 v140, 0
    v_mov_b32 v141, 0
    v_mov_b32 v142, 0
    v_mov_b32 v143, 0
    v_mov_b32 v144, 0
    v_mov_b32 v145, 0
    v_mov_b32 v146, 0
    v_mov_b32 v147, 0
    v_mov_b32 v148, 0
    v_mov_b32 v149, 0
    v_mov_b32 v150, 0
    v_mov_b32 v151, 0
    v_mov_b32 v152, 0
    v_mov_b32 v153, 0
    v_mov_b32 v154, 0
    v_mov_b32 v155, 0
    v_mov_b32 v156, 0
    v_mov_b32 v157, 0
    v_mov_b32 v158, 0
    v_mov_b32 v159, 0
    v_mov_b32 v160, 0
    v_mov_b32 v161, 0
    v_mov_b32 v162, 0
    v_mov_b32 v163, 0
    v_mov_b32 v164, 0
    v_mov_b32 v165, 0
    v_mov_b32 v166, 0
    v_mov_b32 v167, 0
    v_mov_b32 v168, 0
    v_mov_b32 v169, 0
    v_mov_b32 v170, 0
    v_mov_b32 v171, 0
    v_mov_b32 v172, 0
    v_mov_b32 v173, 0
    v_mov_b32 v174, 0
    v_mov_b32 v175, 0
    v_mov_b32 v176, 0
    v_mov_b32 v177, 0
    v_mov_b32 v178, 0
    v_mov_b32 v179, 0
    v_mov_b32 v180, 0
    v_mov_b32 v181, 0
    v_mov_b32 v182, 0
    v_mov_b32 v183, 0
    v_mov_b32 v184, 0
    v_mov_b32 v185, 0
    v_mov_b32 v186, 0
    v_mov_b32 v187, 0
    v_mov_b32 v188, 0
    v_mov_b32 v189, 0
    v_mov_b32 v190, 0
    v_mov_b32 v191, 0
    v_mov_b32 v192, 0
    v_mov_b32 v193, 0
    v_mov_b32 v194, 0
    v_mov_b32 v195, 0
    v_mov_b32 v196, 0
    v_mov_b32 v197, 0
    v_mov_b32 v198, 0
    v_mov_b32 v199, 0
    s_waitcnt vmcnt(24)
    s_barrier
    ds_read_b128 v[24:27], v10 offset:0
    ds_read_b128 v[28:31], v10 offset:2048
    ds_read_b128 v[32:35], v10 offset:4096
    ds_read_b128 v[36:39], v10 offset:6144
    ds_read_b128 v[40:43], v12 offset:0
    ds_read_b128 v[44:47], v12 offset:2048
    s_mov_b32 s49, 3
.k2w_b0_loop:
    s_waitcnt lgkmcnt(0)
    v_mfma_f32_32x32x16_bf16 v[72:87], v[24:27], v[40:43], v[72:87]
    ds_read_b128 v[48:51], v11 offset:0
    v_mfma_f32_32x32x16_bf16 v[104:119], v[28:31], v[40:43], v[104:119]
    ds_read_b128 v[52:55], v11 offset:2048
    v_mfma_f32_32x32x16_bf16 v[136:151], v[32:35], v[40:43], v[136:151]
    ds_read_b128 v[56:59], v11 offset:4096
    v_mfma_f32_32x32x16_bf16 v[168:183], v[36:39], v[40:43], v[168:183]
    ds_read_b128 v[60:63], v11 offset:6144
    v_mfma_f32_32x32x16_bf16 v[88:103], v[24:27], v[44:47], v[88:103]
    ds_read_b128 v[64:67], v13 offset:0
    v_mfma_f32_32x32x16_bf16 v[120:135], v[28:31], v[44:47], v[120:135]
    ds_read_b128 v[68:71], v13 offset:2048
    v_mfma_f32_32x32x16_bf16 v[152:167], v[32:35], v[44:47], v[152:167]
    v_mfma_f32_32x32x16_bf16 v[184:199], v[36:39], v[44:47], v[184:199]
    s_waitcnt vmcnt(18) lgkmcnt(0)
    s_barrier
    v_mfma_f32_32x32x16_bf16 v[72:87], v[48:51], v[64:67], v[72:87]
    ds_read_b128 v[24:27], v10 offset:24576
    ds_read_b128 v[28:31], v10 offset:26624
    v_mfma_f32_32x32x16_bf16 v[104:119], v[52:55], v[64:67], v[104:119]
    ds_read_b128 v[32:35], v10 offset:28672
    ds_read_b128 v[36:39], v10 offset:30720
    v_mfma_f32_32x32x16_bf16 v[136:151], v[56:59], v[64:67], v[136:151]
    ds_read_b128 v[40:43], v12 offset:24576
    ds_read_b128 v[44:47], v12 offset:26624
    v_mfma_f32_32x32x16_bf16 v[168:183], v[60:63], v[64:67], v[168:183]
    s_add_u32 m0, s50, 0
    s_nop 0
    buffer_load_dwordx4 v4, s[32:35], s48 offen lds
    s_add_u32 m0, s50, 4096
    s_nop 0
    buffer_load_dwordx4 v5, s[32:35], s48 offen lds
    v_mfma_f32_32x32x16_bf16 v[88:103], v[48:51], v[68:71], v[88:103]
    s_add_u32 m0, s50, 8192
    s_nop 0
    buffer_load_dwordx4 v6, s[32:35], s48 offen lds
    s_add_u32 m0, s50, 12288
    s_nop 0
    buffer_load_dwordx4 v7, s[32:35], s48 offen lds
    v_mfma_f32_32x32x16_bf16 v[120:135], v[52:55], v[68:71], v[120:135]
    s_add_u32 m0, s50, 16384
    s_nop 0
    buffer_load_dwordx4 v8, s[36:39], s48 offen lds
    s_add_u32 m0, s50, 20480
    s_nop 0
    buffer_load_dwordx4 v9, s[36:39], s48 offen lds
    v_mfma_f32_32x32x16_bf16 v[152:167], v[56:59], v[68:71], v[152:167]
    v_mfma_f32_32x32x16_bf16 v[184:199], v[60:63], v[68:71], v[184:199]
    s_add_u32 s48, s48, 64
    s_waitcnt lgkmcnt(0)
    v_mfma_f32_32x32x16_bf16 v[72:87], v[24:27], v[40:43], v[72:87]
    ds_read_b128 v[48:51], v11 offset:24576
    v_mfma_f32_32x32x16_bf16 v[104:119], v[28:31], v[40:43], v[104:119]
    ds_read_b128 v[52:55], v11 offset:26624
    v_mfma_f32_32x32x16_bf16 v[136:151], v[32:35], v[40:43], v[136:151]
    ds_read_b128 v[56:59], v11 offset:28672
    v_mfma_f32_32x32x16_bf16 v[168:183], v[36:39], v[40:43], v[168:183]
    ds_read_b128 v[60:63], v11 offset:30720
    v_mfma_f32_32x32x16_bf16 v[88:103], v[24:27], v[44:47], v[88:103]
    ds_read_b128 v[64:67], v13 offset:24576
    v_mfma_f32_32x32x16_bf16 v[120:135], v[28:31], v[44:47], v[120:135]
    ds_read_b128 v[68:71], v13 offset:26624
    v_mfma_f32_32x32x16_bf16 v[152:167], v[32:35], v[44:47], v[152:167]
    v_mfma_f32_32x32x16_bf16 v[184:199], v[36:39], v[44:47], v[184:199]
    s_waitcnt vmcnt(18) lgkmcnt(0)
    s_barrier
    v_mfma_f32_32x32x16_bf16 v[72:87], v[48:51], v[64:67], v[72:87]
    ds_read_b128 v[24:27], v14 offset:0
    ds_read_b128 v[28:31], v14 offset:2048
    v_mfma_f32_32x32x16_bf16 v[104:119], v[52:55], v[64:67], v[104:119]
    ds_read_b128 v[32:35], v14 offset:4096
    ds_read_b128 v[36:39], v14 offset:6144
    v_mfma_f32_32x32x16_bf16 v[136:151], v[56:59], v[64:67], v[136:151]
    ds_read_b128 v[40:43], v16 offset:0
    ds_read_b128 v[44:47], v16 offset:2048
    v_mfma_f32_32x32x16_bf16 v[168:183], v[60:63], v[64:67], v[168:183]
    s_add_u32 m0, s50, 24576
    s_nop 0
    buffer_load_dwordx4 v4, s[32:35], s48 offen lds
    s_add_u32 m0, s50, 28672
    s_nop 0
    buffer_load_dwordx4 v5, s[32:35], s48 offen lds
    v_mfma_f32_32x32x16_bf16 v[88:103], v[48:51], v[68:71], v[88:103]
    s_add_u32 m0, s50, 32768
    s_nop 0
    buffer_load_dwordx4 v6, s[32:35], s48 offen lds
    s_add_u32 m0, s50, 36864
    s_nop 0
    buffer_load_dwordx4 v7, s[32:35], s48 offen lds
    v_mfma_f32_32x32x16_bf16 v[120:135], v[52:55], v[68:71], v[120:135]
    s_add_u32 m0, s50, 40960
    s_nop 0
    buffer_load_dwordx4 v8, s[36:39], s48 offen lds
    s_add_u32 m0, s50, 45056
    s_nop 0
    buffer_load_dwordx4 v9, s[36:39], s48 offen lds
    v_mfma_f32_32x32x16_bf16 v[152:167], v[56:59], v[68:71], v[152:167]
    v_mfma_f32_32x32x16_bf16 v[184:199], v[60:63], v[68:71], v[184:199]
    s_add_u32 s48, s48, 64
    s_waitcnt lgkmcnt(0)
    v_mfma_f32_32x32x16_bf16 v[72:87], v[24:27], v[40:43], v[72:87]
    ds_read_b128 v[48:51], v15 offset:0
    v_mfma_f32_32x32x16_bf16 v[104:119], v[28:31], v[40:43], v[104:119]
    ds_read_b128 v[52:55], v15 offset:2048
    v_mfma_f32_32x32x16_bf16 v[136:151], v[32:35], v[40:43], v[136:151]
    ds_read_b128 v[56:59], v15 offset:4096
    v_mfma_f32_32x32x16_bf16 v[168:183], v[36:39], v[40:43], v[168:183]
    ds_read_b128 v[60:63], v15 offset:6144
    v_mfma_f32_32x32x16_bf16 v[88:103], v[24:27], v[44:47], v[88:103]
    ds_read_b128 v[64:67], v17 offset:0
    v_mfma_f32_32x32x16_bf16 v[120:135], v[28:31], v[44:47], v[120:135]
    ds_read_b128 v[68:71], v17 offset:2048
    v_mfma_f32_32x32x16_bf16 v[152:167], v[32:35], v[44:47], v[152:167]
    v_mfma_f32_32x32x16_bf16 v[184:199], v[36:39], v[44:47], v[184:199]
    s_waitcnt vmcnt(18) lgkmcnt(0)
    s_barrier
    v_mfma_f32_32x32x16_bf16 v[72:87], v[48:51], v[64:67], v[72:87]
    ds_read_b128 v[24:27], v14 offset:24576
    ds_read_b128 v[28:31], v14 offset:26624
    v_mfma_f32_32x32x16_bf16 v[104:119], v[52:55], v[64:67], v[104:119]
    ds_read_b128 v[32:35], v14 offset:28672
    ds_read_b128 v[36:39], v14 offset:30720
    v_mfma_f32_32x32x16_bf16 v[136:151], v[56:59], v[64:67], v[136:151]
    ds_read_b128 v[40:43], v16 offset:24576
    ds_read_b128 v[44:47], v16 offset:26624
    v_mfma_f32_32x32x16_bf16 v[168:183], v[60:63], v[64:67], v[168:183]
    s_add_u32 m0, s50, 49152
    s_nop 0
    buffer_load_dwordx4 v4, s[32:35], s48 offen lds
    s_add_u32 m0, s50, 53248
    s_nop 0
    buffer_load_dwordx4 v5, s[32:35], s48 offen lds
    v_mfma_f32_32x32x16_bf16 v[88:103], v[48:51], v[68:71], v[88:103]
    s_add_u32 m0, s50, 57344
    s_nop 0
    buffer_load_dwordx4 v6, s[32:35], s48 offen lds
    s_add_u32 m0, s50, 61440
    s_nop 0
    buffer_load_dwordx4 v7, s[32:35], s48 offen lds
    v_mfma_f32_32x32x16_bf16 v[120:135], v[52:55], v[68:71], v[120:135]
    s_add_u32 m0, s50, 65536
    s_nop 0
    buffer_load_dwordx4 v8, s[36:39], s48 offen lds
    s_add_u32 m0, s50, 69632
    s_nop 0
    buffer_load_dwordx4 v9, s[36:39], s48 offen lds
    v_mfma_f32_32x32x16_bf16 v[152:167], v[56:59], v[68:71], v[152:167]
    v_mfma_f32_32x32x16_bf16 v[184:199], v[60:63], v[68:71], v[184:199]
    s_add_u32 s48, s48, 64
    s_waitcnt lgkmcnt(0)
    v_mfma_f32_32x32x16_bf16 v[72:87], v[24:27], v[40:43], v[72:87]
    ds_read_b128 v[48:51], v15 offset:24576
    v_mfma_f32_32x32x16_bf16 v[104:119], v[28:31], v[40:43], v[104:119]
    ds_read_b128 v[52:55], v15 offset:26624
    v_mfma_f32_32x32x16_bf16 v[136:151], v[32:35], v[40:43], v[136:151]
    ds_read_b128 v[56:59], v15 offset:28672
    v_mfma_f32_32x32x16_bf16 v[168:183], v[36:39], v[40:43], v[168:183]
    ds_read_b128 v[60:63], v15 offset:30720
    v_mfma_f32_32x32x16_bf16 v[88:103], v[24:27], v[44:47], v[88:103]
    ds_read_b128 v[64:67], v17 offset:24576
    v_mfma_f32_32x32x16_bf16 v[120:135], v[28:31], v[44:47], v[120:135]
    ds_read_b128 v[68:71], v17 offset:26624
    v_mfma_f32_32x32x16_bf16 v[152:167], v[32:35], v[44:47], v[152:167]
    v_mfma_f32_32x32x16_bf16 v[184:199], v[36:39], v[44:47], v[184:199]
    s_waitcnt vmcnt(18) lgkmcnt(0)
    s_barrier
    v_mfma_f32_32x32x16_bf16 v[72:87], v[48:51], v[64:67], v[72:87]
    ds_read_b128 v[24:27], v18 offset:0
    ds_read_b128 v[28:31], v18 offset:2048
    v_mfma_f32_32x32x16_bf16 v[104:119], v[52:55], v[64:67], v[104:119]
    ds_read_b128 v[32:35], v18 offset:4096
    ds_read_b128 v[36:39], v18 offset:6144
    v_mfma_f32_32x32x16_bf16 v[136:151], v[56:59], v[64:67], v[136:151]
    ds_read_b128 v[40:43], v20 offset:0
    ds_read_b128 v[44:47], v20 offset:2048
    v_mfma_f32_32x32x16_bf16 v[168:183], v[60:63], v[64:67], v[168:183]
    s_add_u32 m0, s50, 73728
    s_nop 0
    buffer_load_dwordx4 v4, s[32:35], s48 offen lds
    s_add_u32 m0, s50, 77824
    s_nop 0
    buffer_load_dwordx4 v5, s[32:35], s48 offen lds
    v_mfma_f32_32x32x16_bf16 v[88:103], v[48:51], v[68:71], v[88:103]
    s_add_u32 m0, s50, 81920
    s_nop 0
    buffer_load_dwordx4 v6, s[32:35], s48 offen lds
    s_add_u32 m0, s50, 86016
    s_nop 0
    buffer_load_dwordx4 v7, s[32:35], s48 offen lds
    v_mfma_f32_32x32x16_bf16 v[120:135], v[52:55], v[68:71], v[120:135]
    s_add_u32 m0, s50, 90112
    s_nop 0
    buffer_load_dwordx4 v8, s[36:39], s48 offen lds
    s_add_u32 m0, s50, 94208
    s_nop 0
    buffer_load_dwordx4 v9, s[36:39], s48 offen lds
    v_mfma_f32_32x32x16_bf16 v[152:167], v[56:59], v[68:71], v[152:167]
    v_mfma_f32_32x32x16_bf16 v[184:199], v[60:63], v[68:71], v[184:199]
    s_add_u32 s48, s48, 64
    s_waitcnt lgkmcnt(0)
    v_mfma_f32_32x32x16_bf16 v[72:87], v[24:27], v[40:43], v[72:87]
    ds_read_b128 v[48:51], v19 offset:0
    v_mfma_f32_32x32x16_bf16 v[104:119], v[28:31], v[40:43], v[104:119]
    ds_read_b128 v[52:55], v19 offset:2048
    v_mfma_f32_32x32x16_bf16 v[136:151], v[32:35], v[40:43], v[136:151]
    ds_read_b128 v[56:59], v19 offset:4096
    v_mfma_f32_32x32x16_bf16 v[168:183], v[36:39], v[40:43], v[168:183]
    ds_read_b128 v[60:63], v19 offset:6144
    v_mfma_f32_32x32x16_bf16 v[88:103], v[24:27], v[44:47], v[88:103]
    ds_read_b128 v[64:67], v21 offset:0
    v_mfma_f32_32x32x16_bf16 v[120:135], v[28:31], v[44:47], v[120:135]
    ds_read_b128 v[68:71], v21 offset:2048
    v_mfma_f32_32x32x16_bf16 v[152:167], v[32:35], v[44:47], v[152:167]
    v_mfma_f32_32x32x16_bf16 v[184:199], v[36:39], v[44:47], v[184:199]
    s_waitcnt vmcnt(18) lgkmcnt(0)
    s_barrier
    v_mfma_f32_32x32x16_bf16 v[72:87], v[48:51], v[64:67], v[72:87]
    ds_read_b128 v[24:27], v10 offset:0
    ds_read_b128 v[28:31], v10 offset:2048
    v_mfma_f32_32x32x16_bf16 v[104:119], v[52:55], v[64:67], v[104:119]
    ds_read_b128 v[32:35], v10 offset:4096
    ds_read_b128 v[36:39], v10 offset:6144
    v_mfma_f32_32x32x16_bf16 v[136:151], v[56:59], v[64:67], v[136:151]
    ds_read_b128 v[40:43], v12 offset:0
    ds_read_b128 v[44:47], v12 offset:2048
    v_mfma_f32_32x32x16_bf16 v[168:183], v[60:63], v[64:67], v[168:183]
    s_add_u32 m0, s50, 98304
    s_nop 0
    buffer_load_dwordx4 v4, s[32:35], s48 offen lds
    s_add_u32 m0, s50, 102400
    s_nop 0
    buffer_load_dwordx4 v5, s[32:35], s48 offen lds
    v_mfma_f32_32x32x16_bf16 v[88:103], v[48:51], v[68:71], v[88:103]
    s_add_u32 m0, s50, 106496
    s_nop 0
    buffer_load_dwordx4 v6, s[32:35], s48 offen lds
    s_add_u32 m0, s50, 110592
    s_nop 0
    buffer_load_dwordx4 v7, s[32:35], s48 offen lds
    v_mfma_f32_32x32x16_bf16 v[120:135], v[52:55], v[68:71], v[120:135]
    s_add_u32 m0, s50, 114688
    s_nop 0
    buffer_load_dwordx4 v8, s[36:39], s48 offen lds
    s_add_u32 m0, s50, 118784
    s_nop 0
    buffer_load_dwordx4 v9, s[36:39], s48 offen lds
    v_mfma_f32_32x32x16_bf16 v[152:167], v[56:59], v[68:71], v[152:167]
    v_mfma_f32_32x32x16_bf16 v[184:199], v[60:63], v[68:71], v[184:199]
    s_add_u32 s48, s48, 64
    s_sub_u32 s49, s49, 1
    s_cmp_lg_u32 s49, 0
    s_cbranch_scc1 .k2w_b0_loop
    s_waitcnt lgkmcnt(0)
    v_mfma_f32_32x32x16_bf16 v[72:87], v[24:27], v[40:43], v[72:87]
    ds_read_b128 v[48:51], v11 offset:0
    v_mfma_f32_32x32x16_bf16 v[104:119], v[28:31], v[40:43], v[104:119]
    ds_read_b128 v[52:55], v11 offset:2048
    v_mfma_f32_32x32x16_bf16 v[136:151], v[32:35], v[40:43], v[136:151]
    ds_read_b128 v[56:59], v11 offset:4096
    v_mfma_f32_32x32x16_bf16 v[168:183], v[36:39], v[40:43], v[168:183]
    ds_read_b128 v[60:63], v11 offset:6144
    v_mfma_f32_32x32x16_bf16 v[88:103], v[24:27], v[44:47], v[88:103]
    ds_read_b128 v[64:67], v13 offset:0
    v_mfma_f32_32x32x16_bf16 v[120:135], v[28:31], v[44:47], v[120:135]
    ds_read_b128 v[68:71], v13 offset:2048
    v_mfma_f32_32x32x16_bf16 v[152:167], v[32:35], v[44:47], v[152:167]
    v_mfma_f32_32x32x16_bf16 v[184:199], v[36:39], v[44:47], v[184:199]
    s_waitcnt vmcnt(18) lgkmcnt(0)
    s_barrier
    v_mfma_f32_32x32x16_bf16 v[72:87], v[48:51], v[64:67], v[72:87]
    ds_read_b128 v[24:27], v10 offset:24576
    v_mfma_f32_32x32x16_bf16 v[104:119], v[52:55], v[64:67], v[104:119]
    ds_read_b128 v[28:31], v10 offset:26624
    v_mfma_f32_32x32x16_bf16 v[136:151], v[56:59], v[64:67], v[136:151]
    ds_read_b128 v[32:35], v10 offset:28672
    v_mfma_f32_32x32x16_bf16 v[168:183], v[60:63], v[64:67], v[168:183]
    ds_read_b128 v[36:39], v10 offset:30720
    v_mfma_f32_32x32x16_bf16 v[88:103], v[48:51], v[68:71], v[88:103]
    ds_read_b128 v[40:43], v12 offset:24576
    v_mfma_f32_32x32x16_bf16 v[120:135], v[52:55], v[68:71], v[120:135]
    ds_read_b128 v[44:47], v12 offset:26624
    v_mfma_f32_32x32x16_bf16 v[152:167], v[56:59], v[68:71], v[152:167]
    v_mfma_f32_32x32x16_bf16 v[184:199], v[60:63], v[68:71], v[184:199]
    s_waitcnt lgkmcnt(0)
    v_mfma_f32_32x32x16_bf16 v[72:87], v[24:27], v[40:43], v[72:87]
    ds_read_b128 v[48:51], v11 offset:24576
    v_mfma_f32_32x32x16_bf16 v[104:119], v[28:31], v[40:43], v[104:119]
    ds_read_b128 v[52:55], v11 offset:26624
    v_mfma_f32_32x32x16_bf16 v[136:151], v[32:35], v[40:43], v[136:151]
    ds_read_b128 v[56:59], v11 offset:28672
    v_mfma_f32_32x32x16_bf16 v[168:183], v[36:39], v[40:43], v[168:183]
    ds_read_b128 v[60:63], v11 offset:30720
    v_mfma_f32_32x32x16_bf16 v[88:103], v[24:27], v[44:47], v[88:103]
    ds_read_b128 v[64:67], v13 offset:24576
    v_mfma_f32_32x32x16_bf16 v[120:135], v[28:31], v[44:47], v[120:135]
    ds_read_b128 v[68:71], v13 offset:26624
    v_mfma_f32_32x32x16_bf16 v[152:167], v[32:35], v[44:47], v[152:167]
    v_mfma_f32_32x32x16_bf16 v[184:199], v[36:39], v[44:47], v[184:199]
    s_waitcnt vmcnt(12) lgkmcnt(0)
    s_barrier
    v_mfma_f32_32x32x16_bf16 v[72:87], v[48:51], v[64:67], v[72:87]
    ds_read_b128 v[24:27], v14 offset:0
    v_mfma_f32_32x32x16_bf16 v[104:119], v[52:55], v[64:67], v[104:119]
    ds_read_b128 v[28:31], v14 offset:2048
    v_mfma_f32_32x32x16_bf16 v[136:151], v[56:59], v[64:67], v[136:151]
    ds_read_b128 v[32:35], v14 offset:4096
    v_mfma_f32_32x32x16_bf16 v[168:183], v[60:63], v[64:67], v[168:183]
    ds_read_b128 v[36:39], v14 offset:6144
    v_mfma_f32_32x32x16_bf16 v[88:103], v[48:51], v[68:71], v[88:103]
    ds_read_b128 v[40:43], v16 offset:0
    v_mfma_f32_32x32x16_bf16 v[120:135], v[52:55], v[68:71], v[120:135]
    ds_read_b128 v[44:47], v16 offset:2048
    v_mfma_f32_32x32x16_bf16 v[152:167], v[56:59], v[68:71], v[152:167]
    v_mfma_f32_32x32x16_bf16 v[184:199], v[60:63], v[68:71], v[184:199]
    s_waitcnt lgkmcnt(0)
    v_mfma_f32_32x32x16_bf16 v[72:87], v[24:27], v[40:43], v[72:87]
    ds_read_b128 v[48:51], v15 offset:0
    v_mfma_f32_32x32x16_bf16 v[104:119], v[28:31], v[40:43], v[104:119]
    ds_read_b128 v[52:55], v15 offset:2048
    v_mfma_f32_32x32x16_bf16 v[136:151], v[32:35], v[40:43], v[136:151]
    ds_read_b128 v[56:59], v15 offset:4096
    v_mfma_f32_32x32x16_bf16 v[168:183], v[36:39], v[40:43], v[168:183]
    ds_read_b128 v[60:63], v15 offset:6144
    v_mfma_f32_32x32x16_bf16 v[88:103], v[24:27], v[44:47], v[88:103]
    ds_read_b128 v[64:67], v17 offset:0
    v_mfma_f32_32x32x16_bf16 v[120:135], v[28:31], v[44:47], v[120:135]
    ds_read_b128 v[68:71], v17 offset:2048
    v_mfma_f32_32x32x16_bf16 v[152:167], v[32:35], v[44:47], v[152:167]
    v_mfma_f32_32x32x16_bf16 v[184:199], v[36:39], v[44:47], v[184:199]
    s_waitcnt vmcnt(6) lgkmcnt(0)
    s_barrier
    v_mfma_f32_32x32x16_bf16 v[72:87], v[48:51], v[64:67], v[72:87]
    ds_read_b128 v[24:27], v14 offset:24576
    v_mfma_f32_32x32x16_bf16 v[104:119], v[52:55], v[64:67], v[104:119]
    ds_read_b128 v[28:31], v14 offset:26624
    v_mfma_f32_32x32x16_bf16 v[136:151], v[56:59], v[64:67], v[136:151]
    ds_read_b128 v[32:35], v14 offset:28672
    v_mfma_f32_32x32x16_bf16 v[168:183], v[60:63], v[64:67], v[168:183]
    ds_read_b128 v[36:39], v14 offset:30720
    v_mfma_f32_32x32x16_bf16 v[88:103], v[48:51], v[68:71], v[88:103]
    ds_read_b128 v[40:43], v16 offset:24576
    v_mfma_f32_32x32x16_bf16 v[120:135], v[52:55], v[68:71], v[120:135]
    ds_read_b128 v[44:47], v16 offset:26624
    v_mfma_f32_32x32x16_bf16 v[152:167], v[56:59], v[68:71], v[152:167]
    v_mfma_f32_32x32x16_bf16 v[184:199], v[60:63], v[68:71], v[184:199]
    s_waitcnt lgkmcnt(0)
    v_mfma_f32_32x32x16_bf16 v[72:87], v[24:27], v[40:43], v[72:87]
    ds_read_b128 v[48:51], v15 offset:24576
    v_mfma_f32_32x32x16_bf16 v[104:119], v[28:31], v[40:43], v[104:119]
    ds_read_b128 v[52:55], v15 offset:26624
    v_mfma_f32_32x32x16_bf16 v[136:151], v[32:35], v[40:43], v[136:151]
    ds_read_b128 v[56:59], v15 offset:28672
    v_mfma_f32_32x32x16_bf16 v[168:183], v[36:39], v[40:43], v[168:183]
    ds_read_b128 v[60:63], v15 offset:30720
    v_mfma_f32_32x32x16_bf16 v[88:103], v[24:27], v[44:47], v[88:103]
    ds_read_b128 v[64:67], v17 offset:24576
    v_mfma_f32_32x32x16_bf16 v[120:135], v[28:31], v[44:47], v[120:135]
    ds_read_b128 v[68:71], v17 offset:26624
    v_mfma_f32_32x32x16_bf16 v[152:167], v[32:35], v[44:47], v[152:167]
    v_mfma_f32_32x32x16_bf16 v[184:199], v[36:39], v[44:47], v[184:199]
    s_waitcnt vmcnt(0) lgkmcnt(0)
    s_barrier
    v_mfma_f32_32x32x16_bf16 v[72:87], v[48:51], v[64:67], v[72:87]
    ds_read_b128 v[24:27], v18 offset:0
    v_mfma_f32_32x32x16_bf16 v[104:119], v[52:55], v[64:67], v[104:119]
    ds_read_b128 v[28:31], v18 offset:2048
    v_mfma_f32_32x32x16_bf16 v[136:151], v[56:59], v[64:67], v[136:151]
    ds_read_b128 v[32:35], v18 offset:4096
    v_mfma_f32_32x32x16_bf16 v[168:183], v[60:63], v[64:67], v[168:183]
    ds_read_b128 v[36:39], v18 offset:6144
    v_mfma_f32_32x32x16_bf16 v[88:103], v[48:51], v[68:71], v[88:103]
    ds_read_b128 v[40:43], v20 offset:0
    v_mfma_f32_32x32x16_bf16 v[120:135], v[52:55], v[68:71], v[120:135]
    ds_read_b128 v[44:47], v20 offset:2048
    v_mfma_f32_32x32x16_bf16 v[152:167], v[56:59], v[68:71], v[152:167]
    v_mfma_f32_32x32x16_bf16 v[184:199], v[60:63], v[68:71], v[184:199]
    s_waitcnt lgkmcnt(0)
    v_mfma_f32_32x32x16_bf16 v[72:87], v[24:27], v[40:43], v[72:87]
    ds_read_b128 v[48:51], v19 offset:0
    v_mfma_f32_32x32x16_bf16 v[104:119], v[28:31], v[40:43], v[104:119]
    ds_read_b128 v[52:55], v19 offset:2048
    v_mfma_f32_32x32x16_bf16 v[136:151], v[32:35], v[40:43], v[136:151]
    ds_read_b128 v[56:59], v19 offset:4096
    v_mfma_f32_32x32x16_bf16 v[168:183], v[36:39], v[40:43], v[168:183]
    ds_read_b128 v[60:63], v19 offset:6144
    v_mfma_f32_32x32x16_bf16 v[88:103], v[24:27], v[44:47], v[88:103]
    ds_read_b128 v[64:67], v21 offset:0
    v_mfma_f32_32x32x16_bf16 v[120:135], v[28:31], v[44:47], v[120:135]
    ds_read_b128 v[68:71], v21 offset:2048
    v_mfma_f32_32x32x16_bf16 v[152:167], v[32:35], v[44:47], v[152:167]
    v_mfma_f32_32x32x16_bf16 v[184:199], v[36:39], v[44:47], v[184:199]
    s_waitcnt lgkmcnt(0)
    v_mfma_f32_32x32x16_bf16 v[72:87], v[48:51], v[64:67], v[72:87]
    v_mfma_f32_32x32x16_bf16 v[104:119], v[52:55], v[64:67], v[104:119]
    v_mfma_f32_32x32x16_bf16 v[136:151], v[56:59], v[64:67], v[136:151]
    v_mfma_f32_32x32x16_bf16 v[168:183], v[60:63], v[64:67], v[168:183]
    v_mfma_f32_32x32x16_bf16 v[88:103], v[48:51], v[68:71], v[88:103]
    v_mfma_f32_32x32x16_bf16 v[120:135], v[52:55], v[68:71], v[120:135]
    v_mfma_f32_32x32x16_bf16 v[152:167], v[56:59], v[68:71], v[152:167]
    v_mfma_f32_32x32x16_bf16 v[184:199], v[60:63], v[68:71], v[184:199]
    s_mul_i32 s46, s20, 256
    s_add_u32 s46, s46, s44
    s_mul_i32 s47, s21, 128
    s_add_u32 s47, s47, s45
    s_mov_b32 s24, 16384
    v_add_u32 v4, s47, v2
    v_mul_lo_u32 v4, v4, s24
    v_lshlrev_b32 v5, 4, v3
    v_add_u32 v4, v4, v5
    s_lshl_b32 s49, s46, 1
    s_add_u32 s49, s49, 33562624
    v_add_u32 v4, s49, v4
    s_nop 15

    v_cvt_pk_bf16_f32 v24, v72, v73
    v_cvt_pk_bf16_f32 v25, v74, v75
    v_cvt_pk_bf16_f32 v26, v76, v77
    v_cvt_pk_bf16_f32 v27, v78, v79
    v_cvt_pk_bf16_f32 v28, v80, v81
    v_cvt_pk_bf16_f32 v29, v82, v83
    v_cvt_pk_bf16_f32 v30, v84, v85
    v_cvt_pk_bf16_f32 v31, v86, v87
    s_nop 1
    v_permlane32_swap_b32 v24, v26
    v_permlane32_swap_b32 v25, v27
    v_permlane32_swap_b32 v28, v30
    v_permlane32_swap_b32 v29, v31
    s_nop 1
    buffer_store_dwordx4 v[24:27], v4, s[40:43], 0 offen offset:0 sc1
    buffer_store_dwordx4 v[28:31], v4, s[40:43], 0 offen offset:32 sc1
    v_cvt_pk_bf16_f32 v32, v104, v105
    v_cvt_pk_bf16_f32 v33, v106, v107
    v_cvt_pk_bf16_f32 v34, v108, v109
    v_cvt_pk_bf16_f32 v35, v110, v111
    v_cvt_pk_bf16_f32 v36, v112, v113
    v_cvt_pk_bf16_f32 v37, v114, v115
    v_cvt_pk_bf16_f32 v38, v116, v117
    v_cvt_pk_bf16_f32 v39, v118, v119
    s_nop 1
    v_permlane32_swap_b32 v32, v34
    v_permlane32_swap_b32 v33, v35
    v_permlane32_swap_b32 v36, v38
    v_permlane32_swap_b32 v37, v39
    s_nop 1
    buffer_store_dwordx4 v[32:35], v4, s[40:43], 0 offen offset:64 sc1
    buffer_store_dwordx4 v[36:39], v4, s[40:43], 0 offen offset:96 sc1
    v_cvt_pk_bf16_f32 v40, v136, v137
    v_cvt_pk_bf16_f32 v41, v138, v139
    v_cvt_pk_bf16_f32 v42, v140, v141
    v_cvt_pk_bf16_f32 v43, v142, v143
    v_cvt_pk_bf16_f32 v44, v144, v145
    v_cvt_pk_bf16_f32 v45, v146, v147
    v_cvt_pk_bf16_f32 v46, v148, v149
    v_cvt_pk_bf16_f32 v47, v150, v151
    s_nop 1
    v_permlane32_swap_b32 v40, v42
    v_permlane32_swap_b32 v41, v43
    v_permlane32_swap_b32 v44, v46
    v_permlane32_swap_b32 v45, v47
    s_nop 1
    buffer_store_dwordx4 v[40:43], v4, s[40:43], 0 offen offset:128 sc1
    buffer_store_dwordx4 v[44:47], v4, s[40:43], 0 offen offset:160 sc1
    v_cvt_pk_bf16_f32 v24, v168, v169
    v_cvt_pk_bf16_f32 v25, v170, v171
    v_cvt_pk_bf16_f32 v26, v172, v173
    v_cvt_pk_bf16_f32 v27, v174, v175
    v_cvt_pk_bf16_f32 v28, v176, v177
    v_cvt_pk_bf16_f32 v29, v178, v179
    v_cvt_pk_bf16_f32 v30, v180, v181
    v_cvt_pk_bf16_f32 v31, v182, v183
    s_nop 1
    v_permlane32_swap_b32 v24, v26
    v_permlane32_swap_b32 v25, v27
    v_permlane32_swap_b32 v28, v30
    v_permlane32_swap_b32 v29, v31
    s_nop 1
    buffer_store_dwordx4 v[24:27], v4, s[40:43], 0 offen offset:192 sc1
    buffer_store_dwordx4 v[28:31], v4, s[40:43], 0 offen offset:224 sc1
    v_add_u32 v4, 524288, v4
    v_cvt_pk_bf16_f32 v32, v88, v89
    v_cvt_pk_bf16_f32 v33, v90, v91
    v_cvt_pk_bf16_f32 v34, v92, v93
    v_cvt_pk_bf16_f32 v35, v94, v95
    v_cvt_pk_bf16_f32 v36, v96, v97
    v_cvt_pk_bf16_f32 v37, v98, v99
    v_cvt_pk_bf16_f32 v38, v100, v101
    v_cvt_pk_bf16_f32 v39, v102, v103
    s_nop 1
    v_permlane32_swap_b32 v32, v34
    v_permlane32_swap_b32 v33, v35
    v_permlane32_swap_b32 v36, v38
    v_permlane32_swap_b32 v37, v39
    s_nop 1
    buffer_store_dwordx4 v[32:35], v4, s[40:43], 0 offen offset:0 sc1
    buffer_store_dwordx4 v[36:39], v4, s[40:43], 0 offen offset:32 sc1
    v_cvt_pk_bf16_f32 v40, v120, v121
    v_cvt_pk_bf16_f32 v41, v122, v123
    v_cvt_pk_bf16_f32 v42, v124, v125
    v_cvt_pk_bf16_f32 v43, v126, v127
    v_cvt_pk_bf16_f32 v44, v128, v129
    v_cvt_pk_bf16_f32 v45, v130, v131
    v_cvt_pk_bf16_f32 v46, v132, v133
    v_cvt_pk_bf16_f32 v47, v134, v135
    s_nop 1
    v_permlane32_swap_b32 v40, v42
    v_permlane32_swap_b32 v41, v43
    v_permlane32_swap_b32 v44, v46
    v_permlane32_swap_b32 v45, v47
    s_nop 1
    buffer_store_dwordx4 v[40:43], v4, s[40:43], 0 offen offset:64 sc1
    buffer_store_dwordx4 v[44:47], v4, s[40:43], 0 offen offset:96 sc1
    v_cvt_pk_bf16_f32 v24, v152, v153
    v_cvt_pk_bf16_f32 v25, v154, v155
    v_cvt_pk_bf16_f32 v26, v156, v157
    v_cvt_pk_bf16_f32 v27, v158, v159
    v_cvt_pk_bf16_f32 v28, v160, v161
    v_cvt_pk_bf16_f32 v29, v162, v163
    v_cvt_pk_bf16_f32 v30, v164, v165
    v_cvt_pk_bf16_f32 v31, v166, v167
    s_nop 1
    v_permlane32_swap_b32 v24, v26
    v_permlane32_swap_b32 v25, v27
    v_permlane32_swap_b32 v28, v30
    v_permlane32_swap_b32 v29, v31
    s_nop 1
    buffer_store_dwordx4 v[24:27], v4, s[40:43], 0 offen offset:128 sc1
    buffer_store_dwordx4 v[28:31], v4, s[40:43], 0 offen offset:160 sc1
    v_cvt_pk_bf16_f32 v32, v184, v185
    v_cvt_pk_bf16_f32 v33, v186, v187
    v_cvt_pk_bf16_f32 v34, v188, v189
    v_cvt_pk_bf16_f32 v35, v190, v191
    v_cvt_pk_bf16_f32 v36, v192, v193
    v_cvt_pk_bf16_f32 v37, v194, v195
    v_cvt_pk_bf16_f32 v38, v196, v197
    v_cvt_pk_bf16_f32 v39, v198, v199
    s_nop 1
    v_permlane32_swap_b32 v32, v34
    v_permlane32_swap_b32 v33, v35
    v_permlane32_swap_b32 v36, v38
    v_permlane32_swap_b32 v37, v39
    s_nop 1
    buffer_store_dwordx4 v[32:35], v4, s[40:43], 0 offen offset:192 sc1
    buffer_store_dwordx4 v[36:39], v4, s[40:43], 0 offen offset:224 sc1
    s_branch .k2_wloop
.k2w_j1:
    s_cmp_ge_u32 s5, 64
    s_cbranch_scc1 .k2w_j2
    s_sub_u32 s7, s5, 32
    s_load_dwordx2 s[8:9], s[0:1], 0
    s_load_dwordx2 s[10:11], s[0:1], 96
    s_load_dwordx2 s[12:13], s[0:1], 96
    s_lshr_b32 s20, s7, 2
    s_mul_i32 s21, s20, 4
    s_sub_u32 s21, s7, s21
    s_mul_i32 s6, s4, 4
    s_add_u32 s21, s21, s6
    s_lshl_b32 s90, s20, 7
    s_add_u32 s90, s90, 136183808
    v_lshrrev_b32 v2, 2, v1
    v_lshrrev_b32 v3, 4, v1
    v_xor_b32 v3, v3, v1
    v_and_b32 v3, 3, v3
    v_lshlrev_b32 v3, 4, v3
    s_lshl_b32 s6, s3, 4
    s_mul_i32 s22, s20, 256
    s_add_u32 s22, s22, s6
    s_mul_i32 s23, s21, 128
    s_add_u32 s23, s23, s6
    s_mov_b32 s24, 1280
    s_mov_b32 s25, 1280

    v_add_u32 v4, s22, v2
    v_mul_lo_u32 v4, v4, s24
    v_add_u32 v4, v4, v3
    v_add_u32 v5, s22, v2
    v_add_u32 v5, 64, v5
    v_mul_lo_u32 v5, v5, s24
    v_add_u32 v5, v5, v3
    v_add_u32 v6, s22, v2
    v_add_u32 v6, 128, v6
    v_mul_lo_u32 v6, v6, s24
    v_add_u32 v6, v6, v3
    v_add_u32 v7, s22, v2
    v_add_u32 v7, 192, v7
    v_mul_lo_u32 v7, v7, s24
    v_add_u32 v7, v7, v3
    v_add_u32 v8, s23, v2
    v_mul_lo_u32 v8, v8, s25
    v_add_u32 v8, v8, v3
    v_add_u32 v8, 10485760, v8
    v_add_u32 v9, s23, v2
    v_add_u32 v9, 64, v9
    v_mul_lo_u32 v9, v9, s25
    v_add_u32 v9, v9, v3
    v_add_u32 v9, 10485760, v9
    s_waitcnt lgkmcnt(0)
    s_mov_b32 s32, s8
    s_mov_b32 s33, s9
    s_mov_b32 s34, 2621440
    s_mov_b32 s35, 0x00020000
    s_mov_b32 s36, s10
    s_mov_b32 s37, s11
    s_mov_b32 s38, 268435456
    s_mov_b32 s39, 0x00020000
    s_mov_b32 s40, s12
    s_mov_b32 s41, s13
    s_mov_b32 s42, 268435456
    s_mov_b32 s43, 0x00020000
    s_mov_b32 s48, 0
    s_add_u32 m0, s50, 0
    s_nop 0
    buffer_load_dwordx4 v4, s[32:35], s48 offen lds
    s_add_u32 m0, s50, 4096
    s_nop 0
    buffer_load_dwordx4 v5, s[32:35], s48 offen lds
    s_add_u32 m0, s50, 8192
    s_nop 0
    buffer_load_dwordx4 v6, s[32:35], s48 offen lds
    s_add_u32 m0, s50, 12288
    s_nop 0
    buffer_load_dwordx4 v7, s[32:35], s48 offen lds
    s_add_u32 m0, s50, 16384
    s_nop 0
    buffer_load_dwordx4 v8, s[36:39], s48 offen lds
    s_add_u32 m0, s50, 20480
    s_nop 0
    buffer_load_dwordx4 v9, s[36:39], s48 offen lds
    s_add_u32 s48, s48, 64
    s_add_u32 m0, s50, 24576
    s_nop 0
    buffer_load_dwordx4 v4, s[32:35], s48 offen lds
    s_add_u32 m0, s50, 28672
    s_nop 0
    buffer_load_dwordx4 v5, s[32:35], s48 offen lds
    s_add_u32 m0, s50, 32768
    s_nop 0
    buffer_load_dwordx4 v6, s[32:35], s48 offen lds
    s_add_u32 m0, s50, 36864
    s_nop 0
    buffer_load_dwordx4 v7, s[32:35], s48 offen lds
    s_add_u32 m0, s50, 40960
    s_nop 0
    buffer_load_dwordx4 v8, s[36:39], s48 offen lds
    s_add_u32 m0, s50, 45056
    s_nop 0
    buffer_load_dwordx4 v9, s[36:39], s48 offen lds
    s_add_u32 s48, s48, 64
    s_add_u32 m0, s50, 49152
    s_nop 0
    buffer_load_dwordx4 v4, s[32:35], s48 offen lds
    s_add_u32 m0, s50, 53248
    s_nop 0
    buffer_load_dwordx4 v5, s[32:35], s48 offen lds
    s_add_u32 m0, s50, 57344
    s_nop 0
    buffer_load_dwordx4 v6, s[32:35], s48 offen lds
    s_add_u32 m0, s50, 61440
    s_nop 0
    buffer_load_dwordx4 v7, s[32:35], s48 offen lds
    s_add_u32 m0, s50, 65536
    s_nop 0
    buffer_load_dwordx4 v8, s[36:39], s48 offen lds
    s_add_u32 m0, s50, 69632
    s_nop 0
    buffer_load_dwordx4 v9, s[36:39], s48 offen lds
    s_add_u32 s48, s48, 64
    s_add_u32 m0, s50, 73728
    s_nop 0
    buffer_load_dwordx4 v4, s[32:35], s48 offen lds
    s_add_u32 m0, s50, 77824
    s_nop 0
    buffer_load_dwordx4 v5, s[32:35], s48 offen lds
    s_add_u32 m0, s50, 81920
    s_nop 0
    buffer_load_dwordx4 v6, s[32:35], s48 offen lds
    s_add_u32 m0, s50, 86016
    s_nop 0
    buffer_load_dwordx4 v7, s[32:35], s48 offen lds
    s_add_u32 m0, s50, 90112
    s_nop 0
    buffer_load_dwordx4 v8, s[36:39], s48 offen lds
    s_add_u32 m0, s50, 94208
    s_nop 0
    buffer_load_dwordx4 v9, s[36:39], s48 offen lds
    s_add_u32 s48, s48, 64
    s_add_u32 m0, s50, 98304
    s_nop 0
    buffer_load_dwordx4 v4, s[32:35], s48 offen lds
    s_add_u32 m0, s50, 102400
    s_nop 0
    buffer_load_dwordx4 v5, s[32:35], s48 offen lds
    s_add_u32 m0, s50, 106496
    s_nop 0
    buffer_load_dwordx4 v6, s[32:35], s48 offen lds
    s_add_u32 m0, s50, 110592
    s_nop 0
    buffer_load_dwordx4 v7, s[32:35], s48 offen lds
    s_add_u32 m0, s50, 114688
    s_nop 0
    buffer_load_dwordx4 v8, s[36:39], s48 offen lds
    s_add_u32 m0, s50, 118784
    s_nop 0
    buffer_load_dwordx4 v9, s[36:39], s48 offen lds
    s_add_u32 s48, s48, 64
    s_and_b32 s44, s3, 1
    s_lshr_b32 s45, s3, 1
    s_mul_i32 s44, s44, 128
    s_mul_i32 s45, s45, 64
    v_and_b32 v2, 31, v1
    v_lshrrev_b32 v3, 5, v1
    v_lshrrev_b32 v24, 2, v1
    v_xor_b32 v24, v24, v3
    v_and_b32 v24, 3, v24
    v_lshlrev_b32 v24, 4, v24
    v_add_u32 v10, s44, v2
    v_lshlrev_b32 v10, 6, v10
    v_add_u32 v10, v10, v24
    v_xor_b32 v11, 32, v10
    v_add_u32 v12, s45, v2
    v_lshlrev_b32 v12, 6, v12
    v_add_u32 v12, v12, v24
    v_add_u32 v12, 16384, v12
    v_xor_b32 v13, 32, v12

    v_add_u32 v14, 49152, v10
    v_add_u32 v15, 49152, v11
    v_add_u32 v16, 49152, v12
    v_add_u32 v17, 49152, v13
    v_add_u32 v18, 98304, v10
    v_add_u32 v19, 98304, v11
    v_add_u32 v20, 98304, v12
    v_add_u32 v21, 98304, v13
    v_mov_b32 v72, 0
    v_mov_b32 v73, 0
    v_mov_b32 v74, 0
    v_mov_b32 v75, 0
    v_mov_b32 v76, 0
    v_mov_b32 v77, 0
    v_mov_b32 v78, 0
    v_mov_b32 v79, 0
    v_mov_b32 v80, 0
    v_mov_b32 v81, 0
    v_mov_b32 v82, 0
    v_mov_b32 v83, 0
    v_mov_b32 v84, 0
    v_mov_b32 v85, 0
    v_mov_b32 v86, 0
    v_mov_b32 v87, 0
    v_mov_b32 v88, 0
    v_mov_b32 v89, 0
    v_mov_b32 v90, 0
    v_mov_b32 v91, 0
    v_mov_b32 v92, 0
    v_mov_b32 v93, 0
    v_mov_b32 v94, 0
    v_mov_b32 v95, 0
    v_mov_b32 v96, 0
    v_mov_b32 v97, 0
    v_mov_b32 v98, 0
    v_mov_b32 v99, 0
    v_mov_b32 v100, 0
    v_mov_b32 v101, 0
    v_mov_b32 v102, 0
    v_mov_b32 v103, 0
    v_mov_b32 v104, 0
    v_mov_b32 v105, 0
    v_mov_b32 v106, 0
    v_mov_b32 v107, 0
    v_mov_b32 v108, 0
    v_mov_b32 v109, 0
    v_mov_b32 v110, 0
    v_mov_b32 v111, 0
    v_mov_b32 v112, 0
    v_mov_b32 v113, 0
    v_mov_b32 v114, 0
    v_mov_b32 v115, 0
    v_mov_b32 v116, 0
    v_mov_b32 v117, 0
    v_mov_b32 v118, 0
    v_mov_b32 v119, 0
    v_mov_b32 v120, 0
    v_mov_b32 v121, 0
    v_mov_b32 v122, 0
    v_mov_b32 v123, 0
    v_mov_b32 v124, 0
    v_mov_b32 v125, 0
    v_mov_b32 v126, 0
    v_mov_b32 v127, 0
    v_mov_b32 v128, 0
    v_mov_b32 v129, 0
    v_mov_b32 v130, 0
    v_mov_b32 v131, 0
    v_mov_b32 v132, 0
    v_mov_b32 v133, 0
    v_mov_b32 v134, 0
    v_mov_b32 v135, 0
    v_mov_b32 v136, 0
    v_mov_b32 v137, 0
    v_mov_b32 v138, 0
    v_mov_b32 v139, 0
    v_mov_b32 v140, 0
    v_mov_b32 v141, 0
    v_mov_b32 v142, 0
    v_mov_b32 v143, 0
    v_mov_b32 v144, 0
    v_mov_b32 v145, 0
    v_mov_b32 v146, 0
    v_mov_b32 v147, 0
    v_mov_b32 v148, 0
    v_mov_b32 v149, 0
    v_mov_b32 v150, 0
    v_mov_b32 v151, 0
    v_mov_b32 v152, 0
    v_mov_b32 v153, 0
    v_mov_b32 v154, 0
    v_mov_b32 v155, 0
    v_mov_b32 v156, 0
    v_mov_b32 v157, 0
    v_mov_b32 v158, 0
    v_mov_b32 v159, 0
    v_mov_b32 v160, 0
    v_mov_b32 v161, 0
    v_mov_b32 v162, 0
    v_mov_b32 v163, 0
    v_mov_b32 v164, 0
    v_mov_b32 v165, 0
    v_mov_b32 v166, 0
    v_mov_b32 v167, 0
    v_mov_b32 v168, 0
    v_mov_b32 v169, 0
    v_mov_b32 v170, 0
    v_mov_b32 v171, 0
    v_mov_b32 v172, 0
    v_mov_b32 v173, 0
    v_mov_b32 v174, 0
    v_mov_b32 v175, 0
    v_mov_b32 v176, 0
    v_mov_b32 v177, 0
    v_mov_b32 v178, 0
    v_mov_b32 v179, 0
    v_mov_b32 v180, 0
    v_mov_b32 v181, 0
    v_mov_b32 v182, 0
    v_mov_b32 v183, 0
    v_mov_b32 v184, 0
    v_mov_b32 v185, 0
    v_mov_b32 v186, 0
    v_mov_b32 v187, 0
    v_mov_b32 v188, 0
    v_mov_b32 v189, 0
    v_mov_b32 v190, 0
    v_mov_b32 v191, 0
    v_mov_b32 v192, 0
    v_mov_b32 v193, 0
    v_mov_b32 v194, 0
    v_mov_b32 v195, 0
    v_mov_b32 v196, 0
    v_mov_b32 v197, 0
    v_mov_b32 v198, 0
    v_mov_b32 v199, 0
    s_waitcnt vmcnt(24)
    s_barrier
    ds_read_b128 v[24:27], v10 offset:0
    ds_read_b128 v[28:31], v10 offset:2048
    ds_read_b128 v[32:35], v10 offset:4096
    ds_read_b128 v[36:39], v10 offset:6144
    ds_read_b128 v[40:43], v12 offset:0
    ds_read_b128 v[44:47], v12 offset:2048
    s_mov_b32 s49, 3
.k2w_b1_loop:
    s_waitcnt lgkmcnt(0)
    v_mfma_f32_32x32x16_bf16 v[72:87], v[24:27], v[40:43], v[72:87]
    ds_read_b128 v[48:51], v11 offset:0
    v_mfma_f32_32x32x16_bf16 v[104:119], v[28:31], v[40:43], v[104:119]
    ds_read_b128 v[52:55], v11 offset:2048
    v_mfma_f32_32x32x16_bf16 v[136:151], v[32:35], v[40:43], v[136:151]
    ds_read_b128 v[56:59], v11 offset:4096
    v_mfma_f32_32x32x16_bf16 v[168:183], v[36:39], v[40:43], v[168:183]
    ds_read_b128 v[60:63], v11 offset:6144
    v_mfma_f32_32x32x16_bf16 v[88:103], v[24:27], v[44:47], v[88:103]
    ds_read_b128 v[64:67], v13 offset:0
    v_mfma_f32_32x32x16_bf16 v[120:135], v[28:31], v[44:47], v[120:135]
    ds_read_b128 v[68:71], v13 offset:2048
    v_mfma_f32_32x32x16_bf16 v[152:167], v[32:35], v[44:47], v[152:167]
    v_mfma_f32_32x32x16_bf16 v[184:199], v[36:39], v[44:47], v[184:199]
    s_waitcnt vmcnt(18) lgkmcnt(0)
    s_barrier
    v_mfma_f32_32x32x16_bf16 v[72:87], v[48:51], v[64:67], v[72:87]
    ds_read_b128 v[24:27], v10 offset:24576
    ds_read_b128 v[28:31], v10 offset:26624
    v_mfma_f32_32x32x16_bf16 v[104:119], v[52:55], v[64:67], v[104:119]
    ds_read_b128 v[32:35], v10 offset:28672
    ds_read_b128 v[36:39], v10 offset:30720
    v_mfma_f32_32x32x16_bf16 v[136:151], v[56:59], v[64:67], v[136:151]
    ds_read_b128 v[40:43], v12 offset:24576
    ds_read_b128 v[44:47], v12 offset:26624
    v_mfma_f32_32x32x16_bf16 v[168:183], v[60:63], v[64:67], v[168:183]
    s_add_u32 m0, s50, 0
    s_nop 0
    buffer_load_dwordx4 v4, s[32:35], s48 offen lds
    s_add_u32 m0, s50, 4096
    s_nop 0
    buffer_load_dwordx4 v5, s[32:35], s48 offen lds
    v_mfma_f32_32x32x16_bf16 v[88:103], v[48:51], v[68:71], v[88:103]
    s_add_u32 m0, s50, 8192
    s_nop 0
    buffer_load_dwordx4 v6, s[32:35], s48 offen lds
    s_add_u32 m0, s50, 12288
    s_nop 0
    buffer_load_dwordx4 v7, s[32:35], s48 offen lds
    v_mfma_f32_32x32x16_bf16 v[120:135], v[52:55], v[68:71], v[120:135]
    s_add_u32 m0, s50, 16384
    s_nop 0
    buffer_load_dwordx4 v8, s[36:39], s48 offen lds
    s_add_u32 m0, s50, 20480
    s_nop 0
    buffer_load_dwordx4 v9, s[36:39], s48 offen lds
    v_mfma_f32_32x32x16_bf16 v[152:167], v[56:59], v[68:71], v[152:167]
    v_mfma_f32_32x32x16_bf16 v[184:199], v[60:63], v[68:71], v[184:199]
    s_add_u32 s48, s48, 64
    s_waitcnt lgkmcnt(0)
    v_mfma_f32_32x32x16_bf16 v[72:87], v[24:27], v[40:43], v[72:87]
    ds_read_b128 v[48:51], v11 offset:24576
    v_mfma_f32_32x32x16_bf16 v[104:119], v[28:31], v[40:43], v[104:119]
    ds_read_b128 v[52:55], v11 offset:26624
    v_mfma_f32_32x32x16_bf16 v[136:151], v[32:35], v[40:43], v[136:151]
    ds_read_b128 v[56:59], v11 offset:28672
    v_mfma_f32_32x32x16_bf16 v[168:183], v[36:39], v[40:43], v[168:183]
    ds_read_b128 v[60:63], v11 offset:30720
    v_mfma_f32_32x32x16_bf16 v[88:103], v[24:27], v[44:47], v[88:103]
    ds_read_b128 v[64:67], v13 offset:24576
    v_mfma_f32_32x32x16_bf16 v[120:135], v[28:31], v[44:47], v[120:135]
    ds_read_b128 v[68:71], v13 offset:26624
    v_mfma_f32_32x32x16_bf16 v[152:167], v[32:35], v[44:47], v[152:167]
    v_mfma_f32_32x32x16_bf16 v[184:199], v[36:39], v[44:47], v[184:199]
    s_waitcnt vmcnt(18) lgkmcnt(0)
    s_barrier
    v_mfma_f32_32x32x16_bf16 v[72:87], v[48:51], v[64:67], v[72:87]
    ds_read_b128 v[24:27], v14 offset:0
    ds_read_b128 v[28:31], v14 offset:2048
    v_mfma_f32_32x32x16_bf16 v[104:119], v[52:55], v[64:67], v[104:119]
    ds_read_b128 v[32:35], v14 offset:4096
    ds_read_b128 v[36:39], v14 offset:6144
    v_mfma_f32_32x32x16_bf16 v[136:151], v[56:59], v[64:67], v[136:151]
    ds_read_b128 v[40:43], v16 offset:0
    ds_read_b128 v[44:47], v16 offset:2048
    v_mfma_f32_32x32x16_bf16 v[168:183], v[60:63], v[64:67], v[168:183]
    s_add_u32 m0, s50, 24576
    s_nop 0
    buffer_load_dwordx4 v4, s[32:35], s48 offen lds
    s_add_u32 m0, s50, 28672
    s_nop 0
    buffer_load_dwordx4 v5, s[32:35], s48 offen lds
    v_mfma_f32_32x32x16_bf16 v[88:103], v[48:51], v[68:71], v[88:103]
    s_add_u32 m0, s50, 32768
    s_nop 0
    buffer_load_dwordx4 v6, s[32:35], s48 offen lds
    s_add_u32 m0, s50, 36864
    s_nop 0
    buffer_load_dwordx4 v7, s[32:35], s48 offen lds
    v_mfma_f32_32x32x16_bf16 v[120:135], v[52:55], v[68:71], v[120:135]
    s_add_u32 m0, s50, 40960
    s_nop 0
    buffer_load_dwordx4 v8, s[36:39], s48 offen lds
    s_add_u32 m0, s50, 45056
    s_nop 0
    buffer_load_dwordx4 v9, s[36:39], s48 offen lds
    v_mfma_f32_32x32x16_bf16 v[152:167], v[56:59], v[68:71], v[152:167]
    v_mfma_f32_32x32x16_bf16 v[184:199], v[60:63], v[68:71], v[184:199]
    s_add_u32 s48, s48, 64
    s_waitcnt lgkmcnt(0)
    v_mfma_f32_32x32x16_bf16 v[72:87], v[24:27], v[40:43], v[72:87]
    ds_read_b128 v[48:51], v15 offset:0
    v_mfma_f32_32x32x16_bf16 v[104:119], v[28:31], v[40:43], v[104:119]
    ds_read_b128 v[52:55], v15 offset:2048
    v_mfma_f32_32x32x16_bf16 v[136:151], v[32:35], v[40:43], v[136:151]
    ds_read_b128 v[56:59], v15 offset:4096
    v_mfma_f32_32x32x16_bf16 v[168:183], v[36:39], v[40:43], v[168:183]
    ds_read_b128 v[60:63], v15 offset:6144
    v_mfma_f32_32x32x16_bf16 v[88:103], v[24:27], v[44:47], v[88:103]
    ds_read_b128 v[64:67], v17 offset:0
    v_mfma_f32_32x32x16_bf16 v[120:135], v[28:31], v[44:47], v[120:135]
    ds_read_b128 v[68:71], v17 offset:2048
    v_mfma_f32_32x32x16_bf16 v[152:167], v[32:35], v[44:47], v[152:167]
    v_mfma_f32_32x32x16_bf16 v[184:199], v[36:39], v[44:47], v[184:199]
    s_waitcnt vmcnt(18) lgkmcnt(0)
    s_barrier
    v_mfma_f32_32x32x16_bf16 v[72:87], v[48:51], v[64:67], v[72:87]
    ds_read_b128 v[24:27], v14 offset:24576
    ds_read_b128 v[28:31], v14 offset:26624
    v_mfma_f32_32x32x16_bf16 v[104:119], v[52:55], v[64:67], v[104:119]
    ds_read_b128 v[32:35], v14 offset:28672
    ds_read_b128 v[36:39], v14 offset:30720
    v_mfma_f32_32x32x16_bf16 v[136:151], v[56:59], v[64:67], v[136:151]
    ds_read_b128 v[40:43], v16 offset:24576
    ds_read_b128 v[44:47], v16 offset:26624
    v_mfma_f32_32x32x16_bf16 v[168:183], v[60:63], v[64:67], v[168:183]
    s_add_u32 m0, s50, 49152
    s_nop 0
    buffer_load_dwordx4 v4, s[32:35], s48 offen lds
    s_add_u32 m0, s50, 53248
    s_nop 0
    buffer_load_dwordx4 v5, s[32:35], s48 offen lds
    v_mfma_f32_32x32x16_bf16 v[88:103], v[48:51], v[68:71], v[88:103]
    s_add_u32 m0, s50, 57344
    s_nop 0
    buffer_load_dwordx4 v6, s[32:35], s48 offen lds
    s_add_u32 m0, s50, 61440
    s_nop 0
    buffer_load_dwordx4 v7, s[32:35], s48 offen lds
    v_mfma_f32_32x32x16_bf16 v[120:135], v[52:55], v[68:71], v[120:135]
    s_add_u32 m0, s50, 65536
    s_nop 0
    buffer_load_dwordx4 v8, s[36:39], s48 offen lds
    s_add_u32 m0, s50, 69632
    s_nop 0
    buffer_load_dwordx4 v9, s[36:39], s48 offen lds
    v_mfma_f32_32x32x16_bf16 v[152:167], v[56:59], v[68:71], v[152:167]
    v_mfma_f32_32x32x16_bf16 v[184:199], v[60:63], v[68:71], v[184:199]
    s_add_u32 s48, s48, 64
    s_waitcnt lgkmcnt(0)
    v_mfma_f32_32x32x16_bf16 v[72:87], v[24:27], v[40:43], v[72:87]
    ds_read_b128 v[48:51], v15 offset:24576
    v_mfma_f32_32x32x16_bf16 v[104:119], v[28:31], v[40:43], v[104:119]
    ds_read_b128 v[52:55], v15 offset:26624
    v_mfma_f32_32x32x16_bf16 v[136:151], v[32:35], v[40:43], v[136:151]
    ds_read_b128 v[56:59], v15 offset:28672
    v_mfma_f32_32x32x16_bf16 v[168:183], v[36:39], v[40:43], v[168:183]
    ds_read_b128 v[60:63], v15 offset:30720
    v_mfma_f32_32x32x16_bf16 v[88:103], v[24:27], v[44:47], v[88:103]
    ds_read_b128 v[64:67], v17 offset:24576
    v_mfma_f32_32x32x16_bf16 v[120:135], v[28:31], v[44:47], v[120:135]
    ds_read_b128 v[68:71], v17 offset:26624
    v_mfma_f32_32x32x16_bf16 v[152:167], v[32:35], v[44:47], v[152:167]
    v_mfma_f32_32x32x16_bf16 v[184:199], v[36:39], v[44:47], v[184:199]
    s_waitcnt vmcnt(18) lgkmcnt(0)
    s_barrier
    v_mfma_f32_32x32x16_bf16 v[72:87], v[48:51], v[64:67], v[72:87]
    ds_read_b128 v[24:27], v18 offset:0
    ds_read_b128 v[28:31], v18 offset:2048
    v_mfma_f32_32x32x16_bf16 v[104:119], v[52:55], v[64:67], v[104:119]
    ds_read_b128 v[32:35], v18 offset:4096
    ds_read_b128 v[36:39], v18 offset:6144
    v_mfma_f32_32x32x16_bf16 v[136:151], v[56:59], v[64:67], v[136:151]
    ds_read_b128 v[40:43], v20 offset:0
    ds_read_b128 v[44:47], v20 offset:2048
    v_mfma_f32_32x32x16_bf16 v[168:183], v[60:63], v[64:67], v[168:183]
    s_add_u32 m0, s50, 73728
    s_nop 0
    buffer_load_dwordx4 v4, s[32:35], s48 offen lds
    s_add_u32 m0, s50, 77824
    s_nop 0
    buffer_load_dwordx4 v5, s[32:35], s48 offen lds
    v_mfma_f32_32x32x16_bf16 v[88:103], v[48:51], v[68:71], v[88:103]
    s_add_u32 m0, s50, 81920
    s_nop 0
    buffer_load_dwordx4 v6, s[32:35], s48 offen lds
    s_add_u32 m0, s50, 86016
    s_nop 0
    buffer_load_dwordx4 v7, s[32:35], s48 offen lds
    v_mfma_f32_32x32x16_bf16 v[120:135], v[52:55], v[68:71], v[120:135]
    s_add_u32 m0, s50, 90112
    s_nop 0
    buffer_load_dwordx4 v8, s[36:39], s48 offen lds
    s_add_u32 m0, s50, 94208
    s_nop 0
    buffer_load_dwordx4 v9, s[36:39], s48 offen lds
    v_mfma_f32_32x32x16_bf16 v[152:167], v[56:59], v[68:71], v[152:167]
    v_mfma_f32_32x32x16_bf16 v[184:199], v[60:63], v[68:71], v[184:199]
    s_add_u32 s48, s48, 64
    s_waitcnt lgkmcnt(0)
    v_mfma_f32_32x32x16_bf16 v[72:87], v[24:27], v[40:43], v[72:87]
    ds_read_b128 v[48:51], v19 offset:0
    v_mfma_f32_32x32x16_bf16 v[104:119], v[28:31], v[40:43], v[104:119]
    ds_read_b128 v[52:55], v19 offset:2048
    v_mfma_f32_32x32x16_bf16 v[136:151], v[32:35], v[40:43], v[136:151]
    ds_read_b128 v[56:59], v19 offset:4096
    v_mfma_f32_32x32x16_bf16 v[168:183], v[36:39], v[40:43], v[168:183]
    ds_read_b128 v[60:63], v19 offset:6144
    v_mfma_f32_32x32x16_bf16 v[88:103], v[24:27], v[44:47], v[88:103]
    ds_read_b128 v[64:67], v21 offset:0
    v_mfma_f32_32x32x16_bf16 v[120:135], v[28:31], v[44:47], v[120:135]
    ds_read_b128 v[68:71], v21 offset:2048
    v_mfma_f32_32x32x16_bf16 v[152:167], v[32:35], v[44:47], v[152:167]
    v_mfma_f32_32x32x16_bf16 v[184:199], v[36:39], v[44:47], v[184:199]
    s_waitcnt vmcnt(18) lgkmcnt(0)
    s_barrier
    v_mfma_f32_32x32x16_bf16 v[72:87], v[48:51], v[64:67], v[72:87]
    ds_read_b128 v[24:27], v10 offset:0
    ds_read_b128 v[28:31], v10 offset:2048
    v_mfma_f32_32x32x16_bf16 v[104:119], v[52:55], v[64:67], v[104:119]
    ds_read_b128 v[32:35], v10 offset:4096
    ds_read_b128 v[36:39], v10 offset:6144
    v_mfma_f32_32x32x16_bf16 v[136:151], v[56:59], v[64:67], v[136:151]
    ds_read_b128 v[40:43], v12 offset:0
    ds_read_b128 v[44:47], v12 offset:2048
    v_mfma_f32_32x32x16_bf16 v[168:183], v[60:63], v[64:67], v[168:183]
    s_add_u32 m0, s50, 98304
    s_nop 0
    buffer_load_dwordx4 v4, s[32:35], s48 offen lds
    s_add_u32 m0, s50, 102400
    s_nop 0
    buffer_load_dwordx4 v5, s[32:35], s48 offen lds
    v_mfma_f32_32x32x16_bf16 v[88:103], v[48:51], v[68:71], v[88:103]
    s_add_u32 m0, s50, 106496
    s_nop 0
    buffer_load_dwordx4 v6, s[32:35], s48 offen lds
    s_add_u32 m0, s50, 110592
    s_nop 0
    buffer_load_dwordx4 v7, s[32:35], s48 offen lds
    v_mfma_f32_32x32x16_bf16 v[120:135], v[52:55], v[68:71], v[120:135]
    s_add_u32 m0, s50, 114688
    s_nop 0
    buffer_load_dwordx4 v8, s[36:39], s48 offen lds
    s_add_u32 m0, s50, 118784
    s_nop 0
    buffer_load_dwordx4 v9, s[36:39], s48 offen lds
    v_mfma_f32_32x32x16_bf16 v[152:167], v[56:59], v[68:71], v[152:167]
    v_mfma_f32_32x32x16_bf16 v[184:199], v[60:63], v[68:71], v[184:199]
    s_add_u32 s48, s48, 64
    s_sub_u32 s49, s49, 1
    s_cmp_lg_u32 s49, 0
    s_cbranch_scc1 .k2w_b1_loop
    s_waitcnt lgkmcnt(0)
    v_mfma_f32_32x32x16_bf16 v[72:87], v[24:27], v[40:43], v[72:87]
    ds_read_b128 v[48:51], v11 offset:0
    v_mfma_f32_32x32x16_bf16 v[104:119], v[28:31], v[40:43], v[104:119]
    ds_read_b128 v[52:55], v11 offset:2048
    v_mfma_f32_32x32x16_bf16 v[136:151], v[32:35], v[40:43], v[136:151]
    ds_read_b128 v[56:59], v11 offset:4096
    v_mfma_f32_32x32x16_bf16 v[168:183], v[36:39], v[40:43], v[168:183]
    ds_read_b128 v[60:63], v11 offset:6144
    v_mfma_f32_32x32x16_bf16 v[88:103], v[24:27], v[44:47], v[88:103]
    ds_read_b128 v[64:67], v13 offset:0
    v_mfma_f32_32x32x16_bf16 v[120:135], v[28:31], v[44:47], v[120:135]
    ds_read_b128 v[68:71], v13 offset:2048
    v_mfma_f32_32x32x16_bf16 v[152:167], v[32:35], v[44:47], v[152:167]
    v_mfma_f32_32x32x16_bf16 v[184:199], v[36:39], v[44:47], v[184:199]
    s_waitcnt vmcnt(18) lgkmcnt(0)
    s_barrier
    v_mfma_f32_32x32x16_bf16 v[72:87], v[48:51], v[64:67], v[72:87]
    ds_read_b128 v[24:27], v10 offset:24576
    v_mfma_f32_32x32x16_bf16 v[104:119], v[52:55], v[64:67], v[104:119]
    ds_read_b128 v[28:31], v10 offset:26624
    v_mfma_f32_32x32x16_bf16 v[136:151], v[56:59], v[64:67], v[136:151]
    ds_read_b128 v[32:35], v10 offset:28672
    v_mfma_f32_32x32x16_bf16 v[168:183], v[60:63], v[64:67], v[168:183]
    ds_read_b128 v[36:39], v10 offset:30720
    v_mfma_f32_32x32x16_bf16 v[88:103], v[48:51], v[68:71], v[88:103]
    ds_read_b128 v[40:43], v12 offset:24576
    v_mfma_f32_32x32x16_bf16 v[120:135], v[52:55], v[68:71], v[120:135]
    ds_read_b128 v[44:47], v12 offset:26624
    v_mfma_f32_32x32x16_bf16 v[152:167], v[56:59], v[68:71], v[152:167]
    v_mfma_f32_32x32x16_bf16 v[184:199], v[60:63], v[68:71], v[184:199]
    s_waitcnt lgkmcnt(0)
    v_mfma_f32_32x32x16_bf16 v[72:87], v[24:27], v[40:43], v[72:87]
    ds_read_b128 v[48:51], v11 offset:24576
    v_mfma_f32_32x32x16_bf16 v[104:119], v[28:31], v[40:43], v[104:119]
    ds_read_b128 v[52:55], v11 offset:26624
    v_mfma_f32_32x32x16_bf16 v[136:151], v[32:35], v[40:43], v[136:151]
    ds_read_b128 v[56:59], v11 offset:28672
    v_mfma_f32_32x32x16_bf16 v[168:183], v[36:39], v[40:43], v[168:183]
    ds_read_b128 v[60:63], v11 offset:30720
    v_mfma_f32_32x32x16_bf16 v[88:103], v[24:27], v[44:47], v[88:103]
    ds_read_b128 v[64:67], v13 offset:24576
    v_mfma_f32_32x32x16_bf16 v[120:135], v[28:31], v[44:47], v[120:135]
    ds_read_b128 v[68:71], v13 offset:26624
    v_mfma_f32_32x32x16_bf16 v[152:167], v[32:35], v[44:47], v[152:167]
    v_mfma_f32_32x32x16_bf16 v[184:199], v[36:39], v[44:47], v[184:199]
    s_waitcnt vmcnt(12) lgkmcnt(0)
    s_barrier
    v_mfma_f32_32x32x16_bf16 v[72:87], v[48:51], v[64:67], v[72:87]
    ds_read_b128 v[24:27], v14 offset:0
    v_mfma_f32_32x32x16_bf16 v[104:119], v[52:55], v[64:67], v[104:119]
    ds_read_b128 v[28:31], v14 offset:2048
    v_mfma_f32_32x32x16_bf16 v[136:151], v[56:59], v[64:67], v[136:151]
    ds_read_b128 v[32:35], v14 offset:4096
    v_mfma_f32_32x32x16_bf16 v[168:183], v[60:63], v[64:67], v[168:183]
    ds_read_b128 v[36:39], v14 offset:6144
    v_mfma_f32_32x32x16_bf16 v[88:103], v[48:51], v[68:71], v[88:103]
    ds_read_b128 v[40:43], v16 offset:0
    v_mfma_f32_32x32x16_bf16 v[120:135], v[52:55], v[68:71], v[120:135]
    ds_read_b128 v[44:47], v16 offset:2048
    v_mfma_f32_32x32x16_bf16 v[152:167], v[56:59], v[68:71], v[152:167]
    v_mfma_f32_32x32x16_bf16 v[184:199], v[60:63], v[68:71], v[184:199]
    s_waitcnt lgkmcnt(0)
    v_mfma_f32_32x32x16_bf16 v[72:87], v[24:27], v[40:43], v[72:87]
    ds_read_b128 v[48:51], v15 offset:0
    v_mfma_f32_32x32x16_bf16 v[104:119], v[28:31], v[40:43], v[104:119]
    ds_read_b128 v[52:55], v15 offset:2048
    v_mfma_f32_32x32x16_bf16 v[136:151], v[32:35], v[40:43], v[136:151]
    ds_read_b128 v[56:59], v15 offset:4096
    v_mfma_f32_32x32x16_bf16 v[168:183], v[36:39], v[40:43], v[168:183]
    ds_read_b128 v[60:63], v15 offset:6144
    v_mfma_f32_32x32x16_bf16 v[88:103], v[24:27], v[44:47], v[88:103]
    ds_read_b128 v[64:67], v17 offset:0
    v_mfma_f32_32x32x16_bf16 v[120:135], v[28:31], v[44:47], v[120:135]
    ds_read_b128 v[68:71], v17 offset:2048
    v_mfma_f32_32x32x16_bf16 v[152:167], v[32:35], v[44:47], v[152:167]
    v_mfma_f32_32x32x16_bf16 v[184:199], v[36:39], v[44:47], v[184:199]
    s_waitcnt vmcnt(6) lgkmcnt(0)
    s_barrier
    v_mfma_f32_32x32x16_bf16 v[72:87], v[48:51], v[64:67], v[72:87]
    ds_read_b128 v[24:27], v14 offset:24576
    v_mfma_f32_32x32x16_bf16 v[104:119], v[52:55], v[64:67], v[104:119]
    ds_read_b128 v[28:31], v14 offset:26624
    v_mfma_f32_32x32x16_bf16 v[136:151], v[56:59], v[64:67], v[136:151]
    ds_read_b128 v[32:35], v14 offset:28672
    v_mfma_f32_32x32x16_bf16 v[168:183], v[60:63], v[64:67], v[168:183]
    ds_read_b128 v[36:39], v14 offset:30720
    v_mfma_f32_32x32x16_bf16 v[88:103], v[48:51], v[68:71], v[88:103]
    ds_read_b128 v[40:43], v16 offset:24576
    v_mfma_f32_32x32x16_bf16 v[120:135], v[52:55], v[68:71], v[120:135]
    ds_read_b128 v[44:47], v16 offset:26624
    v_mfma_f32_32x32x16_bf16 v[152:167], v[56:59], v[68:71], v[152:167]
    v_mfma_f32_32x32x16_bf16 v[184:199], v[60:63], v[68:71], v[184:199]
    s_waitcnt lgkmcnt(0)
    v_mfma_f32_32x32x16_bf16 v[72:87], v[24:27], v[40:43], v[72:87]
    ds_read_b128 v[48:51], v15 offset:24576
    v_mfma_f32_32x32x16_bf16 v[104:119], v[28:31], v[40:43], v[104:119]
    ds_read_b128 v[52:55], v15 offset:26624
    v_mfma_f32_32x32x16_bf16 v[136:151], v[32:35], v[40:43], v[136:151]
    ds_read_b128 v[56:59], v15 offset:28672
    v_mfma_f32_32x32x16_bf16 v[168:183], v[36:39], v[40:43], v[168:183]
    ds_read_b128 v[60:63], v15 offset:30720
    v_mfma_f32_32x32x16_bf16 v[88:103], v[24:27], v[44:47], v[88:103]
    ds_read_b128 v[64:67], v17 offset:24576
    v_mfma_f32_32x32x16_bf16 v[120:135], v[28:31], v[44:47], v[120:135]
    ds_read_b128 v[68:71], v17 offset:26624
    v_mfma_f32_32x32x16_bf16 v[152:167], v[32:35], v[44:47], v[152:167]
    v_mfma_f32_32x32x16_bf16 v[184:199], v[36:39], v[44:47], v[184:199]
    s_waitcnt vmcnt(0) lgkmcnt(0)
    s_barrier
    v_mfma_f32_32x32x16_bf16 v[72:87], v[48:51], v[64:67], v[72:87]
    ds_read_b128 v[24:27], v18 offset:0
    v_mfma_f32_32x32x16_bf16 v[104:119], v[52:55], v[64:67], v[104:119]
    ds_read_b128 v[28:31], v18 offset:2048
    v_mfma_f32_32x32x16_bf16 v[136:151], v[56:59], v[64:67], v[136:151]
    ds_read_b128 v[32:35], v18 offset:4096
    v_mfma_f32_32x32x16_bf16 v[168:183], v[60:63], v[64:67], v[168:183]
    ds_read_b128 v[36:39], v18 offset:6144
    v_mfma_f32_32x32x16_bf16 v[88:103], v[48:51], v[68:71], v[88:103]
    ds_read_b128 v[40:43], v20 offset:0
    v_mfma_f32_32x32x16_bf16 v[120:135], v[52:55], v[68:71], v[120:135]
    ds_read_b128 v[44:47], v20 offset:2048
    v_mfma_f32_32x32x16_bf16 v[152:167], v[56:59], v[68:71], v[152:167]
    v_mfma_f32_32x32x16_bf16 v[184:199], v[60:63], v[68:71], v[184:199]
    s_waitcnt lgkmcnt(0)
    v_mfma_f32_32x32x16_bf16 v[72:87], v[24:27], v[40:43], v[72:87]
    ds_read_b128 v[48:51], v19 offset:0
    v_mfma_f32_32x32x16_bf16 v[104:119], v[28:31], v[40:43], v[104:119]
    ds_read_b128 v[52:55], v19 offset:2048
    v_mfma_f32_32x32x16_bf16 v[136:151], v[32:35], v[40:43], v[136:151]
    ds_read_b128 v[56:59], v19 offset:4096
    v_mfma_f32_32x32x16_bf16 v[168:183], v[36:39], v[40:43], v[168:183]
    ds_read_b128 v[60:63], v19 offset:6144
    v_mfma_f32_32x32x16_bf16 v[88:103], v[24:27], v[44:47], v[88:103]
    ds_read_b128 v[64:67], v21 offset:0
    v_mfma_f32_32x32x16_bf16 v[120:135], v[28:31], v[44:47], v[120:135]
    ds_read_b128 v[68:71], v21 offset:2048
    v_mfma_f32_32x32x16_bf16 v[152:167], v[32:35], v[44:47], v[152:167]
    v_mfma_f32_32x32x16_bf16 v[184:199], v[36:39], v[44:47], v[184:199]
    s_waitcnt lgkmcnt(0)
    v_mfma_f32_32x32x16_bf16 v[72:87], v[48:51], v[64:67], v[72:87]
    v_mfma_f32_32x32x16_bf16 v[104:119], v[52:55], v[64:67], v[104:119]
    v_mfma_f32_32x32x16_bf16 v[136:151], v[56:59], v[64:67], v[136:151]
    v_mfma_f32_32x32x16_bf16 v[168:183], v[60:63], v[64:67], v[168:183]
    v_mfma_f32_32x32x16_bf16 v[88:103], v[48:51], v[68:71], v[88:103]
    v_mfma_f32_32x32x16_bf16 v[120:135], v[52:55], v[68:71], v[120:135]
    v_mfma_f32_32x32x16_bf16 v[152:167], v[56:59], v[68:71], v[152:167]
    v_mfma_f32_32x32x16_bf16 v[184:199], v[60:63], v[68:71], v[184:199]
    s_mul_i32 s46, s20, 256
    s_add_u32 s46, s46, s44
    s_mul_i32 s47, s21, 128
    s_add_u32 s47, s47, s45
    s_mov_b32 s24, 4096
    v_add_u32 v4, s47, v2
    v_mul_lo_u32 v4, v4, s24
    v_lshlrev_b32 v5, 4, v3
    v_add_u32 v4, v4, v5
    s_lshl_b32 s49, s46, 1
    s_add_u32 s49, s49, 67108864
    v_add_u32 v4, s49, v4
    s_nop 15

    v_cvt_pk_bf16_f32 v24, v72, v73
    v_cvt_pk_bf16_f32 v25, v74, v75
    v_cvt_pk_bf16_f32 v26, v76, v77
    v_cvt_pk_bf16_f32 v27, v78, v79
    v_cvt_pk_bf16_f32 v28, v80, v81
    v_cvt_pk_bf16_f32 v29, v82, v83
    v_cvt_pk_bf16_f32 v30, v84, v85
    v_cvt_pk_bf16_f32 v31, v86, v87
    s_nop 1
    v_permlane32_swap_b32 v24, v26
    v_permlane32_swap_b32 v25, v27
    v_permlane32_swap_b32 v28, v30
    v_permlane32_swap_b32 v29, v31
    s_nop 1
    buffer_store_dwordx4 v[24:27], v4, s[40:43], 0 offen offset:0 sc1
    buffer_store_dwordx4 v[28:31], v4, s[40:43], 0 offen offset:32 sc1
    v_cvt_pk_bf16_f32 v32, v104, v105
    v_cvt_pk_bf16_f32 v33, v106, v107
    v_cvt_pk_bf16_f32 v34, v108, v109
    v_cvt_pk_bf16_f32 v35, v110, v111
    v_cvt_pk_bf16_f32 v36, v112, v113
    v_cvt_pk_bf16_f32 v37, v114, v115
    v_cvt_pk_bf16_f32 v38, v116, v117
    v_cvt_pk_bf16_f32 v39, v118, v119
    s_nop 1
    v_permlane32_swap_b32 v32, v34
    v_permlane32_swap_b32 v33, v35
    v_permlane32_swap_b32 v36, v38
    v_permlane32_swap_b32 v37, v39
    s_nop 1
    buffer_store_dwordx4 v[32:35], v4, s[40:43], 0 offen offset:64 sc1
    buffer_store_dwordx4 v[36:39], v4, s[40:43], 0 offen offset:96 sc1
    v_cvt_pk_bf16_f32 v40, v136, v137
    v_cvt_pk_bf16_f32 v41, v138, v139
    v_cvt_pk_bf16_f32 v42, v140, v141
    v_cvt_pk_bf16_f32 v43, v142, v143
    v_cvt_pk_bf16_f32 v44, v144, v145
    v_cvt_pk_bf16_f32 v45, v146, v147
    v_cvt_pk_bf16_f32 v46, v148, v149
    v_cvt_pk_bf16_f32 v47, v150, v151
    s_nop 1
    v_permlane32_swap_b32 v40, v42
    v_permlane32_swap_b32 v41, v43
    v_permlane32_swap_b32 v44, v46
    v_permlane32_swap_b32 v45, v47
    s_nop 1
    buffer_store_dwordx4 v[40:43], v4, s[40:43], 0 offen offset:128 sc1
    buffer_store_dwordx4 v[44:47], v4, s[40:43], 0 offen offset:160 sc1
    v_cvt_pk_bf16_f32 v24, v168, v169
    v_cvt_pk_bf16_f32 v25, v170, v171
    v_cvt_pk_bf16_f32 v26, v172, v173
    v_cvt_pk_bf16_f32 v27, v174, v175
    v_cvt_pk_bf16_f32 v28, v176, v177
    v_cvt_pk_bf16_f32 v29, v178, v179
    v_cvt_pk_bf16_f32 v30, v180, v181
    v_cvt_pk_bf16_f32 v31, v182, v183
    s_nop 1
    v_permlane32_swap_b32 v24, v26
    v_permlane32_swap_b32 v25, v27
    v_permlane32_swap_b32 v28, v30
    v_permlane32_swap_b32 v29, v31
    s_nop 1
    buffer_store_dwordx4 v[24:27], v4, s[40:43], 0 offen offset:192 sc1
    buffer_store_dwordx4 v[28:31], v4, s[40:43], 0 offen offset:224 sc1
    v_add_u32 v4, 131072, v4
    v_cvt_pk_bf16_f32 v32, v88, v89
    v_cvt_pk_bf16_f32 v33, v90, v91
    v_cvt_pk_bf16_f32 v34, v92, v93
    v_cvt_pk_bf16_f32 v35, v94, v95
    v_cvt_pk_bf16_f32 v36, v96, v97
    v_cvt_pk_bf16_f32 v37, v98, v99
    v_cvt_pk_bf16_f32 v38, v100, v101
    v_cvt_pk_bf16_f32 v39, v102, v103
    s_nop 1
    v_permlane32_swap_b32 v32, v34
    v_permlane32_swap_b32 v33, v35
    v_permlane32_swap_b32 v36, v38
    v_permlane32_swap_b32 v37, v39
    s_nop 1
    buffer_store_dwordx4 v[32:35], v4, s[40:43], 0 offen offset:0 sc1
    buffer_store_dwordx4 v[36:39], v4, s[40:43], 0 offen offset:32 sc1
    v_cvt_pk_bf16_f32 v40, v120, v121
    v_cvt_pk_bf16_f32 v41, v122, v123
    v_cvt_pk_bf16_f32 v42, v124, v125
    v_cvt_pk_bf16_f32 v43, v126, v127
    v_cvt_pk_bf16_f32 v44, v128, v129
    v_cvt_pk_bf16_f32 v45, v130, v131
    v_cvt_pk_bf16_f32 v46, v132, v133
    v_cvt_pk_bf16_f32 v47, v134, v135
    s_nop 1
    v_permlane32_swap_b32 v40, v42
    v_permlane32_swap_b32 v41, v43
    v_permlane32_swap_b32 v44, v46
    v_permlane32_swap_b32 v45, v47
    s_nop 1
    buffer_store_dwordx4 v[40:43], v4, s[40:43], 0 offen offset:64 sc1
    buffer_store_dwordx4 v[44:47], v4, s[40:43], 0 offen offset:96 sc1
    v_cvt_pk_bf16_f32 v24, v152, v153
    v_cvt_pk_bf16_f32 v25, v154, v155
    v_cvt_pk_bf16_f32 v26, v156, v157
    v_cvt_pk_bf16_f32 v27, v158, v159
    v_cvt_pk_bf16_f32 v28, v160, v161
    v_cvt_pk_bf16_f32 v29, v162, v163
    v_cvt_pk_bf16_f32 v30, v164, v165
    v_cvt_pk_bf16_f32 v31, v166, v167
    s_nop 1
    v_permlane32_swap_b32 v24, v26
    v_permlane32_swap_b32 v25, v27
    v_permlane32_swap_b32 v28, v30
    v_permlane32_swap_b32 v29, v31
    s_nop 1
    buffer_store_dwordx4 v[24:27], v4, s[40:43], 0 offen offset:128 sc1
    buffer_store_dwordx4 v[28:31], v4, s[40:43], 0 offen offset:160 sc1
    v_cvt_pk_bf16_f32 v32, v184, v185
    v_cvt_pk_bf16_f32 v33, v186, v187
    v_cvt_pk_bf16_f32 v34, v188, v189
    v_cvt_pk_bf16_f32 v35, v190, v191
    v_cvt_pk_bf16_f32 v36, v192, v193
    v_cvt_pk_bf16_f32 v37, v194, v195
    v_cvt_pk_bf16_f32 v38, v196, v197
    v_cvt_pk_bf16_f32 v39, v198, v199
    s_nop 1
    v_permlane32_swap_b32 v32, v34
    v_permlane32_swap_b32 v33, v35
    v_permlane32_swap_b32 v36, v38
    v_permlane32_swap_b32 v37, v39
    s_nop 1
    buffer_store_dwordx4 v[32:35], v4, s[40:43], 0 offen offset:192 sc1
    buffer_store_dwordx4 v[36:39], v4, s[40:43], 0 offen offset:224 sc1
    s_branch .k2_wloop
.k2w_j2:
    s_cmp_ge_u32 s5, 96
    s_cbranch_scc1 .k2w_j3
    s_sub_u32 s7, s5, 64
    s_load_dwordx2 s[8:9], s[0:1], 96
    s_load_dwordx2 s[10:11], s[0:1], 0
    s_load_dwordx2 s[12:13], s[0:1], 96
    s_lshr_b32 s21, s7, 1
    s_mul_i32 s20, s21, 2
    s_sub_u32 s20, s7, s20
    s_mul_i32 s6, s4, 2
    s_add_u32 s20, s20, s6
    s_lshl_b32 s90, s21, 7
    s_add_u32 s90, s90, 136184832
    v_lshrrev_b32 v2, 2, v1
    v_lshrrev_b32 v3, 4, v1
    v_xor_b32 v3, v3, v1
    v_and_b32 v3, 3, v3
    v_lshlrev_b32 v3, 4, v3
    s_lshl_b32 s6, s3, 4
    s_mul_i32 s22, s20, 256
    s_add_u32 s22, s22, s6
    s_mul_i32 s23, s21, 128
    s_add_u32 s23, s23, s6
    s_mov_b32 s24, 1280
    s_mov_b32 s25, 1280

    v_add_u32 v4, s22, v2
    v_mul_lo_u32 v4, v4, s24
    v_add_u32 v4, v4, v3
    v_add_u32 v5, s22, v2
    v_add_u32 v5, 64, v5
    v_mul_lo_u32 v5, v5, s24
    v_add_u32 v5, v5, v3
    v_add_u32 v6, s22, v2
    v_add_u32 v6, 128, v6
    v_mul_lo_u32 v6, v6, s24
    v_add_u32 v6, v6, v3
    v_add_u32 v7, s22, v2
    v_add_u32 v7, 192, v7
    v_mul_lo_u32 v7, v7, s24
    v_add_u32 v7, v7, v3
    v_add_u32 v8, s23, v2
    v_mul_lo_u32 v8, v8, s25
    v_add_u32 v8, v8, v3
    v_add_u32 v9, s23, v2
    v_add_u32 v9, 64, v9
    v_mul_lo_u32 v9, v9, s25
    v_add_u32 v9, v9, v3
    s_waitcnt lgkmcnt(0)
    s_mov_b32 s32, s8
    s_mov_b32 s33, s9
    s_mov_b32 s34, 268435456
    s_mov_b32 s35, 0x00020000
    s_mov_b32 s36, s10
    s_mov_b32 s37, s11
    s_mov_b32 s38, 2621440
    s_mov_b32 s39, 0x00020000
    s_mov_b32 s40, s12
    s_mov_b32 s41, s13
    s_mov_b32 s42, 268435456
    s_mov_b32 s43, 0x00020000
    s_mov_b32 s48, 0
    s_add_u32 m0, s50, 0
    s_nop 0
    buffer_load_dwordx4 v4, s[32:35], s48 offen lds
    s_add_u32 m0, s50, 4096
    s_nop 0
    buffer_load_dwordx4 v5, s[32:35], s48 offen lds
    s_add_u32 m0, s50, 8192
    s_nop 0
    buffer_load_dwordx4 v6, s[32:35], s48 offen lds
    s_add_u32 m0, s50, 12288
    s_nop 0
    buffer_load_dwordx4 v7, s[32:35], s48 offen lds
    s_add_u32 m0, s50, 16384
    s_nop 0
    buffer_load_dwordx4 v8, s[36:39], s48 offen lds
    s_add_u32 m0, s50, 20480
    s_nop 0
    buffer_load_dwordx4 v9, s[36:39], s48 offen lds
    s_add_u32 s48, s48, 64
    s_add_u32 m0, s50, 24576
    s_nop 0
    buffer_load_dwordx4 v4, s[32:35], s48 offen lds
    s_add_u32 m0, s50, 28672
    s_nop 0
    buffer_load_dwordx4 v5, s[32:35], s48 offen lds
    s_add_u32 m0, s50, 32768
    s_nop 0
    buffer_load_dwordx4 v6, s[32:35], s48 offen lds
    s_add_u32 m0, s50, 36864
    s_nop 0
    buffer_load_dwordx4 v7, s[32:35], s48 offen lds
    s_add_u32 m0, s50, 40960
    s_nop 0
    buffer_load_dwordx4 v8, s[36:39], s48 offen lds
    s_add_u32 m0, s50, 45056
    s_nop 0
    buffer_load_dwordx4 v9, s[36:39], s48 offen lds
    s_add_u32 s48, s48, 64
    s_add_u32 m0, s50, 49152
    s_nop 0
    buffer_load_dwordx4 v4, s[32:35], s48 offen lds
    s_add_u32 m0, s50, 53248
    s_nop 0
    buffer_load_dwordx4 v5, s[32:35], s48 offen lds
    s_add_u32 m0, s50, 57344
    s_nop 0
    buffer_load_dwordx4 v6, s[32:35], s48 offen lds
    s_add_u32 m0, s50, 61440
    s_nop 0
    buffer_load_dwordx4 v7, s[32:35], s48 offen lds
    s_add_u32 m0, s50, 65536
    s_nop 0
    buffer_load_dwordx4 v8, s[36:39], s48 offen lds
    s_add_u32 m0, s50, 69632
    s_nop 0
    buffer_load_dwordx4 v9, s[36:39], s48 offen lds
    s_add_u32 s48, s48, 64
    s_add_u32 m0, s50, 73728
    s_nop 0
    buffer_load_dwordx4 v4, s[32:35], s48 offen lds
    s_add_u32 m0, s50, 77824
    s_nop 0
    buffer_load_dwordx4 v5, s[32:35], s48 offen lds
    s_add_u32 m0, s50, 81920
    s_nop 0
    buffer_load_dwordx4 v6, s[32:35], s48 offen lds
    s_add_u32 m0, s50, 86016
    s_nop 0
    buffer_load_dwordx4 v7, s[32:35], s48 offen lds
    s_add_u32 m0, s50, 90112
    s_nop 0
    buffer_load_dwordx4 v8, s[36:39], s48 offen lds
    s_add_u32 m0, s50, 94208
    s_nop 0
    buffer_load_dwordx4 v9, s[36:39], s48 offen lds
    s_add_u32 s48, s48, 64
    s_add_u32 m0, s50, 98304
    s_nop 0
    buffer_load_dwordx4 v4, s[32:35], s48 offen lds
    s_add_u32 m0, s50, 102400
    s_nop 0
    buffer_load_dwordx4 v5, s[32:35], s48 offen lds
    s_add_u32 m0, s50, 106496
    s_nop 0
    buffer_load_dwordx4 v6, s[32:35], s48 offen lds
    s_add_u32 m0, s50, 110592
    s_nop 0
    buffer_load_dwordx4 v7, s[32:35], s48 offen lds
    s_add_u32 m0, s50, 114688
    s_nop 0
    buffer_load_dwordx4 v8, s[36:39], s48 offen lds
    s_add_u32 m0, s50, 118784
    s_nop 0
    buffer_load_dwordx4 v9, s[36:39], s48 offen lds
    s_add_u32 s48, s48, 64
    s_and_b32 s44, s3, 1
    s_lshr_b32 s45, s3, 1
    s_mul_i32 s44, s44, 128
    s_mul_i32 s45, s45, 64
    v_and_b32 v2, 31, v1
    v_lshrrev_b32 v3, 5, v1
    v_lshrrev_b32 v24, 2, v1
    v_xor_b32 v24, v24, v3
    v_and_b32 v24, 3, v24
    v_lshlrev_b32 v24, 4, v24
    v_add_u32 v10, s44, v2
    v_lshlrev_b32 v10, 6, v10
    v_add_u32 v10, v10, v24
    v_xor_b32 v11, 32, v10
    v_add_u32 v12, s45, v2
    v_lshlrev_b32 v12, 6, v12
    v_add_u32 v12, v12, v24
    v_add_u32 v12, 16384, v12
    v_xor_b32 v13, 32, v12

    v_add_u32 v14, 49152, v10
    v_add_u32 v15, 49152, v11
    v_add_u32 v16, 49152, v12
    v_add_u32 v17, 49152, v13
    v_add_u32 v18, 98304, v10
    v_add_u32 v19, 98304, v11
    v_add_u32 v20, 98304, v12
    v_add_u32 v21, 98304, v13
    v_mov_b32 v72, 0
    v_mov_b32 v73, 0
    v_mov_b32 v74, 0
    v_mov_b32 v75, 0
    v_mov_b32 v76, 0
    v_mov_b32 v77, 0
    v_mov_b32 v78, 0
    v_mov_b32 v79, 0
    v_mov_b32 v80, 0
    v_mov_b32 v81, 0
    v_mov_b32 v82, 0
    v_mov_b32 v83, 0
    v_mov_b32 v84, 0
    v_mov_b32 v85, 0
    v_mov_b32 v86, 0
    v_mov_b32 v87, 0
    v_mov_b32 v88, 0
    v_mov_b32 v89, 0
    v_mov_b32 v90, 0
    v_mov_b32 v91, 0
    v_mov_b32 v92, 0
    v_mov_b32 v93, 0
    v_mov_b32 v94, 0
    v_mov_b32 v95, 0
    v_mov_b32 v96, 0
    v_mov_b32 v97, 0
    v_mov_b32 v98, 0
    v_mov_b32 v99, 0
    v_mov_b32 v100, 0
    v_mov_b32 v101, 0
    v_mov_b32 v102, 0
    v_mov_b32 v103, 0
    v_mov_b32 v104, 0
    v_mov_b32 v105, 0
    v_mov_b32 v106, 0
    v_mov_b32 v107, 0
    v_mov_b32 v108, 0
    v_mov_b32 v109, 0
    v_mov_b32 v110, 0
    v_mov_b32 v111, 0
    v_mov_b32 v112, 0
    v_mov_b32 v113, 0
    v_mov_b32 v114, 0
    v_mov_b32 v115, 0
    v_mov_b32 v116, 0
    v_mov_b32 v117, 0
    v_mov_b32 v118, 0
    v_mov_b32 v119, 0
    v_mov_b32 v120, 0
    v_mov_b32 v121, 0
    v_mov_b32 v122, 0
    v_mov_b32 v123, 0
    v_mov_b32 v124, 0
    v_mov_b32 v125, 0
    v_mov_b32 v126, 0
    v_mov_b32 v127, 0
    v_mov_b32 v128, 0
    v_mov_b32 v129, 0
    v_mov_b32 v130, 0
    v_mov_b32 v131, 0
    v_mov_b32 v132, 0
    v_mov_b32 v133, 0
    v_mov_b32 v134, 0
    v_mov_b32 v135, 0
    v_mov_b32 v136, 0
    v_mov_b32 v137, 0
    v_mov_b32 v138, 0
    v_mov_b32 v139, 0
    v_mov_b32 v140, 0
    v_mov_b32 v141, 0
    v_mov_b32 v142, 0
    v_mov_b32 v143, 0
    v_mov_b32 v144, 0
    v_mov_b32 v145, 0
    v_mov_b32 v146, 0
    v_mov_b32 v147, 0
    v_mov_b32 v148, 0
    v_mov_b32 v149, 0
    v_mov_b32 v150, 0
    v_mov_b32 v151, 0
    v_mov_b32 v152, 0
    v_mov_b32 v153, 0
    v_mov_b32 v154, 0
    v_mov_b32 v155, 0
    v_mov_b32 v156, 0
    v_mov_b32 v157, 0
    v_mov_b32 v158, 0
    v_mov_b32 v159, 0
    v_mov_b32 v160, 0
    v_mov_b32 v161, 0
    v_mov_b32 v162, 0
    v_mov_b32 v163, 0
    v_mov_b32 v164, 0
    v_mov_b32 v165, 0
    v_mov_b32 v166, 0
    v_mov_b32 v167, 0
    v_mov_b32 v168, 0
    v_mov_b32 v169, 0
    v_mov_b32 v170, 0
    v_mov_b32 v171, 0
    v_mov_b32 v172, 0
    v_mov_b32 v173, 0
    v_mov_b32 v174, 0
    v_mov_b32 v175, 0
    v_mov_b32 v176, 0
    v_mov_b32 v177, 0
    v_mov_b32 v178, 0
    v_mov_b32 v179, 0
    v_mov_b32 v180, 0
    v_mov_b32 v181, 0
    v_mov_b32 v182, 0
    v_mov_b32 v183, 0
    v_mov_b32 v184, 0
    v_mov_b32 v185, 0
    v_mov_b32 v186, 0
    v_mov_b32 v187, 0
    v_mov_b32 v188, 0
    v_mov_b32 v189, 0
    v_mov_b32 v190, 0
    v_mov_b32 v191, 0
    v_mov_b32 v192, 0
    v_mov_b32 v193, 0
    v_mov_b32 v194, 0
    v_mov_b32 v195, 0
    v_mov_b32 v196, 0
    v_mov_b32 v197, 0
    v_mov_b32 v198, 0
    v_mov_b32 v199, 0
    s_waitcnt vmcnt(24)
    s_barrier
    ds_read_b128 v[24:27], v10 offset:0
    ds_read_b128 v[28:31], v10 offset:2048
    ds_read_b128 v[32:35], v10 offset:4096
    ds_read_b128 v[36:39], v10 offset:6144
    ds_read_b128 v[40:43], v12 offset:0
    ds_read_b128 v[44:47], v12 offset:2048
    s_mov_b32 s49, 3
.k2w_b2_loop:
    s_waitcnt lgkmcnt(0)
    v_mfma_f32_32x32x16_bf16 v[72:87], v[24:27], v[40:43], v[72:87]
    ds_read_b128 v[48:51], v11 offset:0
    v_mfma_f32_32x32x16_bf16 v[104:119], v[28:31], v[40:43], v[104:119]
    ds_read_b128 v[52:55], v11 offset:2048
    v_mfma_f32_32x32x16_bf16 v[136:151], v[32:35], v[40:43], v[136:151]
    ds_read_b128 v[56:59], v11 offset:4096
    v_mfma_f32_32x32x16_bf16 v[168:183], v[36:39], v[40:43], v[168:183]
    ds_read_b128 v[60:63], v11 offset:6144
    v_mfma_f32_32x32x16_bf16 v[88:103], v[24:27], v[44:47], v[88:103]
    ds_read_b128 v[64:67], v13 offset:0
    v_mfma_f32_32x32x16_bf16 v[120:135], v[28:31], v[44:47], v[120:135]
    ds_read_b128 v[68:71], v13 offset:2048
    v_mfma_f32_32x32x16_bf16 v[152:167], v[32:35], v[44:47], v[152:167]
    v_mfma_f32_32x32x16_bf16 v[184:199], v[36:39], v[44:47], v[184:199]
    s_waitcnt vmcnt(18) lgkmcnt(0)
    s_barrier
    v_mfma_f32_32x32x16_bf16 v[72:87], v[48:51], v[64:67], v[72:87]
    ds_read_b128 v[24:27], v10 offset:24576
    ds_read_b128 v[28:31], v10 offset:26624
    v_mfma_f32_32x32x16_bf16 v[104:119], v[52:55], v[64:67], v[104:119]
    ds_read_b128 v[32:35], v10 offset:28672
    ds_read_b128 v[36:39], v10 offset:30720
    v_mfma_f32_32x32x16_bf16 v[136:151], v[56:59], v[64:67], v[136:151]
    ds_read_b128 v[40:43], v12 offset:24576
    ds_read_b128 v[44:47], v12 offset:26624
    v_mfma_f32_32x32x16_bf16 v[168:183], v[60:63], v[64:67], v[168:183]
    s_add_u32 m0, s50, 0
    s_nop 0
    buffer_load_dwordx4 v4, s[32:35], s48 offen lds
    s_add_u32 m0, s50, 4096
    s_nop 0
    buffer_load_dwordx4 v5, s[32:35], s48 offen lds
    v_mfma_f32_32x32x16_bf16 v[88:103], v[48:51], v[68:71], v[88:103]
    s_add_u32 m0, s50, 8192
    s_nop 0
    buffer_load_dwordx4 v6, s[32:35], s48 offen lds
    s_add_u32 m0, s50, 12288
    s_nop 0
    buffer_load_dwordx4 v7, s[32:35], s48 offen lds
    v_mfma_f32_32x32x16_bf16 v[120:135], v[52:55], v[68:71], v[120:135]
    s_add_u32 m0, s50, 16384
    s_nop 0
    buffer_load_dwordx4 v8, s[36:39], s48 offen lds
    s_add_u32 m0, s50, 20480
    s_nop 0
    buffer_load_dwordx4 v9, s[36:39], s48 offen lds
    v_mfma_f32_32x32x16_bf16 v[152:167], v[56:59], v[68:71], v[152:167]
    v_mfma_f32_32x32x16_bf16 v[184:199], v[60:63], v[68:71], v[184:199]
    s_add_u32 s48, s48, 64
    s_waitcnt lgkmcnt(0)
    v_mfma_f32_32x32x16_bf16 v[72:87], v[24:27], v[40:43], v[72:87]
    ds_read_b128 v[48:51], v11 offset:24576
    v_mfma_f32_32x32x16_bf16 v[104:119], v[28:31], v[40:43], v[104:119]
    ds_read_b128 v[52:55], v11 offset:26624
    v_mfma_f32_32x32x16_bf16 v[136:151], v[32:35], v[40:43], v[136:151]
    ds_read_b128 v[56:59], v11 offset:28672
    v_mfma_f32_32x32x16_bf16 v[168:183], v[36:39], v[40:43], v[168:183]
    ds_read_b128 v[60:63], v11 offset:30720
    v_mfma_f32_32x32x16_bf16 v[88:103], v[24:27], v[44:47], v[88:103]
    ds_read_b128 v[64:67], v13 offset:24576
    v_mfma_f32_32x32x16_bf16 v[120:135], v[28:31], v[44:47], v[120:135]
    ds_read_b128 v[68:71], v13 offset:26624
    v_mfma_f32_32x32x16_bf16 v[152:167], v[32:35], v[44:47], v[152:167]
    v_mfma_f32_32x32x16_bf16 v[184:199], v[36:39], v[44:47], v[184:199]
    s_waitcnt vmcnt(18) lgkmcnt(0)
    s_barrier
    v_mfma_f32_32x32x16_bf16 v[72:87], v[48:51], v[64:67], v[72:87]
    ds_read_b128 v[24:27], v14 offset:0
    ds_read_b128 v[28:31], v14 offset:2048
    v_mfma_f32_32x32x16_bf16 v[104:119], v[52:55], v[64:67], v[104:119]
    ds_read_b128 v[32:35], v14 offset:4096
    ds_read_b128 v[36:39], v14 offset:6144
    v_mfma_f32_32x32x16_bf16 v[136:151], v[56:59], v[64:67], v[136:151]
    ds_read_b128 v[40:43], v16 offset:0
    ds_read_b128 v[44:47], v16 offset:2048
    v_mfma_f32_32x32x16_bf16 v[168:183], v[60:63], v[64:67], v[168:183]
    s_add_u32 m0, s50, 24576
    s_nop 0
    buffer_load_dwordx4 v4, s[32:35], s48 offen lds
    s_add_u32 m0, s50, 28672
    s_nop 0
    buffer_load_dwordx4 v5, s[32:35], s48 offen lds
    v_mfma_f32_32x32x16_bf16 v[88:103], v[48:51], v[68:71], v[88:103]
    s_add_u32 m0, s50, 32768
    s_nop 0
    buffer_load_dwordx4 v6, s[32:35], s48 offen lds
    s_add_u32 m0, s50, 36864
    s_nop 0
    buffer_load_dwordx4 v7, s[32:35], s48 offen lds
    v_mfma_f32_32x32x16_bf16 v[120:135], v[52:55], v[68:71], v[120:135]
    s_add_u32 m0, s50, 40960
    s_nop 0
    buffer_load_dwordx4 v8, s[36:39], s48 offen lds
    s_add_u32 m0, s50, 45056
    s_nop 0
    buffer_load_dwordx4 v9, s[36:39], s48 offen lds
    v_mfma_f32_32x32x16_bf16 v[152:167], v[56:59], v[68:71], v[152:167]
    v_mfma_f32_32x32x16_bf16 v[184:199], v[60:63], v[68:71], v[184:199]
    s_add_u32 s48, s48, 64
    s_waitcnt lgkmcnt(0)
    v_mfma_f32_32x32x16_bf16 v[72:87], v[24:27], v[40:43], v[72:87]
    ds_read_b128 v[48:51], v15 offset:0
    v_mfma_f32_32x32x16_bf16 v[104:119], v[28:31], v[40:43], v[104:119]
    ds_read_b128 v[52:55], v15 offset:2048
    v_mfma_f32_32x32x16_bf16 v[136:151], v[32:35], v[40:43], v[136:151]
    ds_read_b128 v[56:59], v15 offset:4096
    v_mfma_f32_32x32x16_bf16 v[168:183], v[36:39], v[40:43], v[168:183]
    ds_read_b128 v[60:63], v15 offset:6144
    v_mfma_f32_32x32x16_bf16 v[88:103], v[24:27], v[44:47], v[88:103]
    ds_read_b128 v[64:67], v17 offset:0
    v_mfma_f32_32x32x16_bf16 v[120:135], v[28:31], v[44:47], v[120:135]
    ds_read_b128 v[68:71], v17 offset:2048
    v_mfma_f32_32x32x16_bf16 v[152:167], v[32:35], v[44:47], v[152:167]
    v_mfma_f32_32x32x16_bf16 v[184:199], v[36:39], v[44:47], v[184:199]
    s_waitcnt vmcnt(18) lgkmcnt(0)
    s_barrier
    v_mfma_f32_32x32x16_bf16 v[72:87], v[48:51], v[64:67], v[72:87]
    ds_read_b128 v[24:27], v14 offset:24576
    ds_read_b128 v[28:31], v14 offset:26624
    v_mfma_f32_32x32x16_bf16 v[104:119], v[52:55], v[64:67], v[104:119]
    ds_read_b128 v[32:35], v14 offset:28672
    ds_read_b128 v[36:39], v14 offset:30720
    v_mfma_f32_32x32x16_bf16 v[136:151], v[56:59], v[64:67], v[136:151]
    ds_read_b128 v[40:43], v16 offset:24576
    ds_read_b128 v[44:47], v16 offset:26624
    v_mfma_f32_32x32x16_bf16 v[168:183], v[60:63], v[64:67], v[168:183]
    s_add_u32 m0, s50, 49152
    s_nop 0
    buffer_load_dwordx4 v4, s[32:35], s48 offen lds
    s_add_u32 m0, s50, 53248
    s_nop 0
    buffer_load_dwordx4 v5, s[32:35], s48 offen lds
    v_mfma_f32_32x32x16_bf16 v[88:103], v[48:51], v[68:71], v[88:103]
    s_add_u32 m0, s50, 57344
    s_nop 0
    buffer_load_dwordx4 v6, s[32:35], s48 offen lds
    s_add_u32 m0, s50, 61440
    s_nop 0
    buffer_load_dwordx4 v7, s[32:35], s48 offen lds
    v_mfma_f32_32x32x16_bf16 v[120:135], v[52:55], v[68:71], v[120:135]
    s_add_u32 m0, s50, 65536
    s_nop 0
    buffer_load_dwordx4 v8, s[36:39], s48 offen lds
    s_add_u32 m0, s50, 69632
    s_nop 0
    buffer_load_dwordx4 v9, s[36:39], s48 offen lds
    v_mfma_f32_32x32x16_bf16 v[152:167], v[56:59], v[68:71], v[152:167]
    v_mfma_f32_32x32x16_bf16 v[184:199], v[60:63], v[68:71], v[184:199]
    s_add_u32 s48, s48, 64
    s_waitcnt lgkmcnt(0)
    v_mfma_f32_32x32x16_bf16 v[72:87], v[24:27], v[40:43], v[72:87]
    ds_read_b128 v[48:51], v15 offset:24576
    v_mfma_f32_32x32x16_bf16 v[104:119], v[28:31], v[40:43], v[104:119]
    ds_read_b128 v[52:55], v15 offset:26624
    v_mfma_f32_32x32x16_bf16 v[136:151], v[32:35], v[40:43], v[136:151]
    ds_read_b128 v[56:59], v15 offset:28672
    v_mfma_f32_32x32x16_bf16 v[168:183], v[36:39], v[40:43], v[168:183]
    ds_read_b128 v[60:63], v15 offset:30720
    v_mfma_f32_32x32x16_bf16 v[88:103], v[24:27], v[44:47], v[88:103]
    ds_read_b128 v[64:67], v17 offset:24576
    v_mfma_f32_32x32x16_bf16 v[120:135], v[28:31], v[44:47], v[120:135]
    ds_read_b128 v[68:71], v17 offset:26624
    v_mfma_f32_32x32x16_bf16 v[152:167], v[32:35], v[44:47], v[152:167]
    v_mfma_f32_32x32x16_bf16 v[184:199], v[36:39], v[44:47], v[184:199]
    s_waitcnt vmcnt(18) lgkmcnt(0)
    s_barrier
    v_mfma_f32_32x32x16_bf16 v[72:87], v[48:51], v[64:67], v[72:87]
    ds_read_b128 v[24:27], v18 offset:0
    ds_read_b128 v[28:31], v18 offset:2048
    v_mfma_f32_32x32x16_bf16 v[104:119], v[52:55], v[64:67], v[104:119]
    ds_read_b128 v[32:35], v18 offset:4096
    ds_read_b128 v[36:39], v18 offset:6144
    v_mfma_f32_32x32x16_bf16 v[136:151], v[56:59], v[64:67], v[136:151]
    ds_read_b128 v[40:43], v20 offset:0
    ds_read_b128 v[44:47], v20 offset:2048
    v_mfma_f32_32x32x16_bf16 v[168:183], v[60:63], v[64:67], v[168:183]
    s_add_u32 m0, s50, 73728
    s_nop 0
    buffer_load_dwordx4 v4, s[32:35], s48 offen lds
    s_add_u32 m0, s50, 77824
    s_nop 0
    buffer_load_dwordx4 v5, s[32:35], s48 offen lds
    v_mfma_f32_32x32x16_bf16 v[88:103], v[48:51], v[68:71], v[88:103]
    s_add_u32 m0, s50, 81920
    s_nop 0
    buffer_load_dwordx4 v6, s[32:35], s48 offen lds
    s_add_u32 m0, s50, 86016
    s_nop 0
    buffer_load_dwordx4 v7, s[32:35], s48 offen lds
    v_mfma_f32_32x32x16_bf16 v[120:135], v[52:55], v[68:71], v[120:135]
    s_add_u32 m0, s50, 90112
    s_nop 0
    buffer_load_dwordx4 v8, s[36:39], s48 offen lds
    s_add_u32 m0, s50, 94208
    s_nop 0
    buffer_load_dwordx4 v9, s[36:39], s48 offen lds
    v_mfma_f32_32x32x16_bf16 v[152:167], v[56:59], v[68:71], v[152:167]
    v_mfma_f32_32x32x16_bf16 v[184:199], v[60:63], v[68:71], v[184:199]
    s_add_u32 s48, s48, 64
    s_waitcnt lgkmcnt(0)
    v_mfma_f32_32x32x16_bf16 v[72:87], v[24:27], v[40:43], v[72:87]
    ds_read_b128 v[48:51], v19 offset:0
    v_mfma_f32_32x32x16_bf16 v[104:119], v[28:31], v[40:43], v[104:119]
    ds_read_b128 v[52:55], v19 offset:2048
    v_mfma_f32_32x32x16_bf16 v[136:151], v[32:35], v[40:43], v[136:151]
    ds_read_b128 v[56:59], v19 offset:4096
    v_mfma_f32_32x32x16_bf16 v[168:183], v[36:39], v[40:43], v[168:183]
    ds_read_b128 v[60:63], v19 offset:6144
    v_mfma_f32_32x32x16_bf16 v[88:103], v[24:27], v[44:47], v[88:103]
    ds_read_b128 v[64:67], v21 offset:0
    v_mfma_f32_32x32x16_bf16 v[120:135], v[28:31], v[44:47], v[120:135]
    ds_read_b128 v[68:71], v21 offset:2048
    v_mfma_f32_32x32x16_bf16 v[152:167], v[32:35], v[44:47], v[152:167]
    v_mfma_f32_32x32x16_bf16 v[184:199], v[36:39], v[44:47], v[184:199]
    s_waitcnt vmcnt(18) lgkmcnt(0)
    s_barrier
    v_mfma_f32_32x32x16_bf16 v[72:87], v[48:51], v[64:67], v[72:87]
    ds_read_b128 v[24:27], v10 offset:0
    ds_read_b128 v[28:31], v10 offset:2048
    v_mfma_f32_32x32x16_bf16 v[104:119], v[52:55], v[64:67], v[104:119]
    ds_read_b128 v[32:35], v10 offset:4096
    ds_read_b128 v[36:39], v10 offset:6144
    v_mfma_f32_32x32x16_bf16 v[136:151], v[56:59], v[64:67], v[136:151]
    ds_read_b128 v[40:43], v12 offset:0
    ds_read_b128 v[44:47], v12 offset:2048
    v_mfma_f32_32x32x16_bf16 v[168:183], v[60:63], v[64:67], v[168:183]
    s_add_u32 m0, s50, 98304
    s_nop 0
    buffer_load_dwordx4 v4, s[32:35], s48 offen lds
    s_add_u32 m0, s50, 102400
    s_nop 0
    buffer_load_dwordx4 v5, s[32:35], s48 offen lds
    v_mfma_f32_32x32x16_bf16 v[88:103], v[48:51], v[68:71], v[88:103]
    s_add_u32 m0, s50, 106496
    s_nop 0
    buffer_load_dwordx4 v6, s[32:35], s48 offen lds
    s_add_u32 m0, s50, 110592
    s_nop 0
    buffer_load_dwordx4 v7, s[32:35], s48 offen lds
    v_mfma_f32_32x32x16_bf16 v[120:135], v[52:55], v[68:71], v[120:135]
    s_add_u32 m0, s50, 114688
    s_nop 0
    buffer_load_dwordx4 v8, s[36:39], s48 offen lds
    s_add_u32 m0, s50, 118784
    s_nop 0
    buffer_load_dwordx4 v9, s[36:39], s48 offen lds
    v_mfma_f32_32x32x16_bf16 v[152:167], v[56:59], v[68:71], v[152:167]
    v_mfma_f32_32x32x16_bf16 v[184:199], v[60:63], v[68:71], v[184:199]
    s_add_u32 s48, s48, 64
    s_sub_u32 s49, s49, 1
    s_cmp_lg_u32 s49, 0
    s_cbranch_scc1 .k2w_b2_loop
    s_waitcnt lgkmcnt(0)
    v_mfma_f32_32x32x16_bf16 v[72:87], v[24:27], v[40:43], v[72:87]
    ds_read_b128 v[48:51], v11 offset:0
    v_mfma_f32_32x32x16_bf16 v[104:119], v[28:31], v[40:43], v[104:119]
    ds_read_b128 v[52:55], v11 offset:2048
    v_mfma_f32_32x32x16_bf16 v[136:151], v[32:35], v[40:43], v[136:151]
    ds_read_b128 v[56:59], v11 offset:4096
    v_mfma_f32_32x32x16_bf16 v[168:183], v[36:39], v[40:43], v[168:183]
    ds_read_b128 v[60:63], v11 offset:6144
    v_mfma_f32_32x32x16_bf16 v[88:103], v[24:27], v[44:47], v[88:103]
    ds_read_b128 v[64:67], v13 offset:0
    v_mfma_f32_32x32x16_bf16 v[120:135], v[28:31], v[44:47], v[120:135]
    ds_read_b128 v[68:71], v13 offset:2048
    v_mfma_f32_32x32x16_bf16 v[152:167], v[32:35], v[44:47], v[152:167]
    v_mfma_f32_32x32x16_bf16 v[184:199], v[36:39], v[44:47], v[184:199]
    s_waitcnt vmcnt(18) lgkmcnt(0)
    s_barrier
    v_mfma_f32_32x32x16_bf16 v[72:87], v[48:51], v[64:67], v[72:87]
    ds_read_b128 v[24:27], v10 offset:24576
    v_mfma_f32_32x32x16_bf16 v[104:119], v[52:55], v[64:67], v[104:119]
    ds_read_b128 v[28:31], v10 offset:26624
    v_mfma_f32_32x32x16_bf16 v[136:151], v[56:59], v[64:67], v[136:151]
    ds_read_b128 v[32:35], v10 offset:28672
    v_mfma_f32_32x32x16_bf16 v[168:183], v[60:63], v[64:67], v[168:183]
    ds_read_b128 v[36:39], v10 offset:30720
    v_mfma_f32_32x32x16_bf16 v[88:103], v[48:51], v[68:71], v[88:103]
    ds_read_b128 v[40:43], v12 offset:24576
    v_mfma_f32_32x32x16_bf16 v[120:135], v[52:55], v[68:71], v[120:135]
    ds_read_b128 v[44:47], v12 offset:26624
    v_mfma_f32_32x32x16_bf16 v[152:167], v[56:59], v[68:71], v[152:167]
    v_mfma_f32_32x32x16_bf16 v[184:199], v[60:63], v[68:71], v[184:199]
    s_waitcnt lgkmcnt(0)
    v_mfma_f32_32x32x16_bf16 v[72:87], v[24:27], v[40:43], v[72:87]
    ds_read_b128 v[48:51], v11 offset:24576
    v_mfma_f32_32x32x16_bf16 v[104:119], v[28:31], v[40:43], v[104:119]
    ds_read_b128 v[52:55], v11 offset:26624
    v_mfma_f32_32x32x16_bf16 v[136:151], v[32:35], v[40:43], v[136:151]
    ds_read_b128 v[56:59], v11 offset:28672
    v_mfma_f32_32x32x16_bf16 v[168:183], v[36:39], v[40:43], v[168:183]
    ds_read_b128 v[60:63], v11 offset:30720
    v_mfma_f32_32x32x16_bf16 v[88:103], v[24:27], v[44:47], v[88:103]
    ds_read_b128 v[64:67], v13 offset:24576
    v_mfma_f32_32x32x16_bf16 v[120:135], v[28:31], v[44:47], v[120:135]
    ds_read_b128 v[68:71], v13 offset:26624
    v_mfma_f32_32x32x16_bf16 v[152:167], v[32:35], v[44:47], v[152:167]
    v_mfma_f32_32x32x16_bf16 v[184:199], v[36:39], v[44:47], v[184:199]
    s_waitcnt vmcnt(12) lgkmcnt(0)
    s_barrier
    v_mfma_f32_32x32x16_bf16 v[72:87], v[48:51], v[64:67], v[72:87]
    ds_read_b128 v[24:27], v14 offset:0
    v_mfma_f32_32x32x16_bf16 v[104:119], v[52:55], v[64:67], v[104:119]
    ds_read_b128 v[28:31], v14 offset:2048
    v_mfma_f32_32x32x16_bf16 v[136:151], v[56:59], v[64:67], v[136:151]
    ds_read_b128 v[32:35], v14 offset:4096
    v_mfma_f32_32x32x16_bf16 v[168:183], v[60:63], v[64:67], v[168:183]
    ds_read_b128 v[36:39], v14 offset:6144
    v_mfma_f32_32x32x16_bf16 v[88:103], v[48:51], v[68:71], v[88:103]
    ds_read_b128 v[40:43], v16 offset:0
    v_mfma_f32_32x32x16_bf16 v[120:135], v[52:55], v[68:71], v[120:135]
    ds_read_b128 v[44:47], v16 offset:2048
    v_mfma_f32_32x32x16_bf16 v[152:167], v[56:59], v[68:71], v[152:167]
    v_mfma_f32_32x32x16_bf16 v[184:199], v[60:63], v[68:71], v[184:199]
    s_waitcnt lgkmcnt(0)
    v_mfma_f32_32x32x16_bf16 v[72:87], v[24:27], v[40:43], v[72:87]
    ds_read_b128 v[48:51], v15 offset:0
    v_mfma_f32_32x32x16_bf16 v[104:119], v[28:31], v[40:43], v[104:119]
    ds_read_b128 v[52:55], v15 offset:2048
    v_mfma_f32_32x32x16_bf16 v[136:151], v[32:35], v[40:43], v[136:151]
    ds_read_b128 v[56:59], v15 offset:4096
    v_mfma_f32_32x32x16_bf16 v[168:183], v[36:39], v[40:43], v[168:183]
    ds_read_b128 v[60:63], v15 offset:6144
    v_mfma_f32_32x32x16_bf16 v[88:103], v[24:27], v[44:47], v[88:103]
    ds_read_b128 v[64:67], v17 offset:0
    v_mfma_f32_32x32x16_bf16 v[120:135], v[28:31], v[44:47], v[120:135]
    ds_read_b128 v[68:71], v17 offset:2048
    v_mfma_f32_32x32x16_bf16 v[152:167], v[32:35], v[44:47], v[152:167]
    v_mfma_f32_32x32x16_bf16 v[184:199], v[36:39], v[44:47], v[184:199]
    s_waitcnt vmcnt(6) lgkmcnt(0)
    s_barrier
    v_mfma_f32_32x32x16_bf16 v[72:87], v[48:51], v[64:67], v[72:87]
    ds_read_b128 v[24:27], v14 offset:24576
    v_mfma_f32_32x32x16_bf16 v[104:119], v[52:55], v[64:67], v[104:119]
    ds_read_b128 v[28:31], v14 offset:26624
    v_mfma_f32_32x32x16_bf16 v[136:151], v[56:59], v[64:67], v[136:151]
    ds_read_b128 v[32:35], v14 offset:28672
    v_mfma_f32_32x32x16_bf16 v[168:183], v[60:63], v[64:67], v[168:183]
    ds_read_b128 v[36:39], v14 offset:30720
    v_mfma_f32_32x32x16_bf16 v[88:103], v[48:51], v[68:71], v[88:103]
    ds_read_b128 v[40:43], v16 offset:24576
    v_mfma_f32_32x32x16_bf16 v[120:135], v[52:55], v[68:71], v[120:135]
    ds_read_b128 v[44:47], v16 offset:26624
    v_mfma_f32_32x32x16_bf16 v[152:167], v[56:59], v[68:71], v[152:167]
    v_mfma_f32_32x32x16_bf16 v[184:199], v[60:63], v[68:71], v[184:199]
    s_waitcnt lgkmcnt(0)
    v_mfma_f32_32x32x16_bf16 v[72:87], v[24:27], v[40:43], v[72:87]
    ds_read_b128 v[48:51], v15 offset:24576
    v_mfma_f32_32x32x16_bf16 v[104:119], v[28:31], v[40:43], v[104:119]
    ds_read_b128 v[52:55], v15 offset:26624
    v_mfma_f32_32x32x16_bf16 v[136:151], v[32:35], v[40:43], v[136:151]
    ds_read_b128 v[56:59], v15 offset:28672
    v_mfma_f32_32x32x16_bf16 v[168:183], v[36:39], v[40:43], v[168:183]
    ds_read_b128 v[60:63], v15 offset:30720
    v_mfma_f32_32x32x16_bf16 v[88:103], v[24:27], v[44:47], v[88:103]
    ds_read_b128 v[64:67], v17 offset:24576
    v_mfma_f32_32x32x16_bf16 v[120:135], v[28:31], v[44:47], v[120:135]
    ds_read_b128 v[68:71], v17 offset:26624
    v_mfma_f32_32x32x16_bf16 v[152:167], v[32:35], v[44:47], v[152:167]
    v_mfma_f32_32x32x16_bf16 v[184:199], v[36:39], v[44:47], v[184:199]
    s_waitcnt vmcnt(0) lgkmcnt(0)
    s_barrier
    v_mfma_f32_32x32x16_bf16 v[72:87], v[48:51], v[64:67], v[72:87]
    ds_read_b128 v[24:27], v18 offset:0
    v_mfma_f32_32x32x16_bf16 v[104:119], v[52:55], v[64:67], v[104:119]
    ds_read_b128 v[28:31], v18 offset:2048
    v_mfma_f32_32x32x16_bf16 v[136:151], v[56:59], v[64:67], v[136:151]
    ds_read_b128 v[32:35], v18 offset:4096
    v_mfma_f32_32x32x16_bf16 v[168:183], v[60:63], v[64:67], v[168:183]
    ds_read_b128 v[36:39], v18 offset:6144
    v_mfma_f32_32x32x16_bf16 v[88:103], v[48:51], v[68:71], v[88:103]
    ds_read_b128 v[40:43], v20 offset:0
    v_mfma_f32_32x32x16_bf16 v[120:135], v[52:55], v[68:71], v[120:135]
    ds_read_b128 v[44:47], v20 offset:2048
    v_mfma_f32_32x32x16_bf16 v[152:167], v[56:59], v[68:71], v[152:167]
    v_mfma_f32_32x32x16_bf16 v[184:199], v[60:63], v[68:71], v[184:199]
    s_waitcnt lgkmcnt(0)
    v_mfma_f32_32x32x16_bf16 v[72:87], v[24:27], v[40:43], v[72:87]
    ds_read_b128 v[48:51], v19 offset:0
    v_mfma_f32_32x32x16_bf16 v[104:119], v[28:31], v[40:43], v[104:119]
    ds_read_b128 v[52:55], v19 offset:2048
    v_mfma_f32_32x32x16_bf16 v[136:151], v[32:35], v[40:43], v[136:151]
    ds_read_b128 v[56:59], v19 offset:4096
    v_mfma_f32_32x32x16_bf16 v[168:183], v[36:39], v[40:43], v[168:183]
    ds_read_b128 v[60:63], v19 offset:6144
    v_mfma_f32_32x32x16_bf16 v[88:103], v[24:27], v[44:47], v[88:103]
    ds_read_b128 v[64:67], v21 offset:0
    v_mfma_f32_32x32x16_bf16 v[120:135], v[28:31], v[44:47], v[120:135]
    ds_read_b128 v[68:71], v21 offset:2048
    v_mfma_f32_32x32x16_bf16 v[152:167], v[32:35], v[44:47], v[152:167]
    v_mfma_f32_32x32x16_bf16 v[184:199], v[36:39], v[44:47], v[184:199]
    s_waitcnt lgkmcnt(0)
    v_mfma_f32_32x32x16_bf16 v[72:87], v[48:51], v[64:67], v[72:87]
    v_mfma_f32_32x32x16_bf16 v[104:119], v[52:55], v[64:67], v[104:119]
    v_mfma_f32_32x32x16_bf16 v[136:151], v[56:59], v[64:67], v[136:151]
    v_mfma_f32_32x32x16_bf16 v[168:183], v[60:63], v[64:67], v[168:183]
    v_mfma_f32_32x32x16_bf16 v[88:103], v[48:51], v[68:71], v[88:103]
    v_mfma_f32_32x32x16_bf16 v[120:135], v[52:55], v[68:71], v[120:135]
    v_mfma_f32_32x32x16_bf16 v[152:167], v[56:59], v[68:71], v[152:167]
    v_mfma_f32_32x32x16_bf16 v[184:199], v[60:63], v[68:71], v[184:199]
    s_mul_i32 s46, s20, 256
    s_add_u32 s46, s46, s44
    s_mul_i32 s47, s21, 128
    s_add_u32 s47, s47, s45
    s_mov_b32 s24, 16384
    v_add_u32 v4, s47, v2
    v_mul_lo_u32 v4, v4, s24
    v_lshlrev_b32 v5, 4, v3
    v_add_u32 v4, v4, v5
    s_lshl_b32 s49, s46, 1
    s_add_u32 s49, s49, 33554432
    v_add_u32 v4, s49, v4
    s_nop 15

    v_cvt_pk_bf16_f32 v24, v72, v73
    v_cvt_pk_bf16_f32 v25, v74, v75
    v_cvt_pk_bf16_f32 v26, v76, v77
    v_cvt_pk_bf16_f32 v27, v78, v79
    v_cvt_pk_bf16_f32 v28, v80, v81
    v_cvt_pk_bf16_f32 v29, v82, v83
    v_cvt_pk_bf16_f32 v30, v84, v85
    v_cvt_pk_bf16_f32 v31, v86, v87
    s_nop 1
    v_permlane32_swap_b32 v24, v26
    v_permlane32_swap_b32 v25, v27
    v_permlane32_swap_b32 v28, v30
    v_permlane32_swap_b32 v29, v31
    s_nop 1
    buffer_store_dwordx4 v[24:27], v4, s[40:43], 0 offen offset:0 sc1
    buffer_store_dwordx4 v[28:31], v4, s[40:43], 0 offen offset:32 sc1
    v_cvt_pk_bf16_f32 v32, v104, v105
    v_cvt_pk_bf16_f32 v33, v106, v107
    v_cvt_pk_bf16_f32 v34, v108, v109
    v_cvt_pk_bf16_f32 v35, v110, v111
    v_cvt_pk_bf16_f32 v36, v112, v113
    v_cvt_pk_bf16_f32 v37, v114, v115
    v_cvt_pk_bf16_f32 v38, v116, v117
    v_cvt_pk_bf16_f32 v39, v118, v119
    s_nop 1
    v_permlane32_swap_b32 v32, v34
    v_permlane32_swap_b32 v33, v35
    v_permlane32_swap_b32 v36, v38
    v_permlane32_swap_b32 v37, v39
    s_nop 1
    buffer_store_dwordx4 v[32:35], v4, s[40:43], 0 offen offset:64 sc1
    buffer_store_dwordx4 v[36:39], v4, s[40:43], 0 offen offset:96 sc1
    v_cvt_pk_bf16_f32 v40, v136, v137
    v_cvt_pk_bf16_f32 v41, v138, v139
    v_cvt_pk_bf16_f32 v42, v140, v141
    v_cvt_pk_bf16_f32 v43, v142, v143
    v_cvt_pk_bf16_f32 v44, v144, v145
    v_cvt_pk_bf16_f32 v45, v146, v147
    v_cvt_pk_bf16_f32 v46, v148, v149
    v_cvt_pk_bf16_f32 v47, v150, v151
    s_nop 1
    v_permlane32_swap_b32 v40, v42
    v_permlane32_swap_b32 v41, v43
    v_permlane32_swap_b32 v44, v46
    v_permlane32_swap_b32 v45, v47
    s_nop 1
    buffer_store_dwordx4 v[40:43], v4, s[40:43], 0 offen offset:128 sc1
    buffer_store_dwordx4 v[44:47], v4, s[40:43], 0 offen offset:160 sc1
    v_cvt_pk_bf16_f32 v24, v168, v169
    v_cvt_pk_bf16_f32 v25, v170, v171
    v_cvt_pk_bf16_f32 v26, v172, v173
    v_cvt_pk_bf16_f32 v27, v174, v175
    v_cvt_pk_bf16_f32 v28, v176, v177
    v_cvt_pk_bf16_f32 v29, v178, v179
    v_cvt_pk_bf16_f32 v30, v180, v181
    v_cvt_pk_bf16_f32 v31, v182, v183
    s_nop 1
    v_permlane32_swap_b32 v24, v26
    v_permlane32_swap_b32 v25, v27
    v_permlane32_swap_b32 v28, v30
    v_permlane32_swap_b32 v29, v31
    s_nop 1
    buffer_store_dwordx4 v[24:27], v4, s[40:43], 0 offen offset:192 sc1
    buffer_store_dwordx4 v[28:31], v4, s[40:43], 0 offen offset:224 sc1
    v_add_u32 v4, 524288, v4
    v_cvt_pk_bf16_f32 v32, v88, v89
    v_cvt_pk_bf16_f32 v33, v90, v91
    v_cvt_pk_bf16_f32 v34, v92, v93
    v_cvt_pk_bf16_f32 v35, v94, v95
    v_cvt_pk_bf16_f32 v36, v96, v97
    v_cvt_pk_bf16_f32 v37, v98, v99
    v_cvt_pk_bf16_f32 v38, v100, v101
    v_cvt_pk_bf16_f32 v39, v102, v103
    s_nop 1
    v_permlane32_swap_b32 v32, v34
    v_permlane32_swap_b32 v33, v35
    v_permlane32_swap_b32 v36, v38
    v_permlane32_swap_b32 v37, v39
    s_nop 1
    buffer_store_dwordx4 v[32:35], v4, s[40:43], 0 offen offset:0 sc1
    buffer_store_dwordx4 v[36:39], v4, s[40:43], 0 offen offset:32 sc1
    v_cvt_pk_bf16_f32 v40, v120, v121
    v_cvt_pk_bf16_f32 v41, v122, v123
    v_cvt_pk_bf16_f32 v42, v124, v125
    v_cvt_pk_bf16_f32 v43, v126, v127
    v_cvt_pk_bf16_f32 v44, v128, v129
    v_cvt_pk_bf16_f32 v45, v130, v131
    v_cvt_pk_bf16_f32 v46, v132, v133
    v_cvt_pk_bf16_f32 v47, v134, v135
    s_nop 1
    v_permlane32_swap_b32 v40, v42
    v_permlane32_swap_b32 v41, v43
    v_permlane32_swap_b32 v44, v46
    v_permlane32_swap_b32 v45, v47
    s_nop 1
    buffer_store_dwordx4 v[40:43], v4, s[40:43], 0 offen offset:64 sc1
    buffer_store_dwordx4 v[44:47], v4, s[40:43], 0 offen offset:96 sc1
    v_cvt_pk_bf16_f32 v24, v152, v153
    v_cvt_pk_bf16_f32 v25, v154, v155
    v_cvt_pk_bf16_f32 v26, v156, v157
    v_cvt_pk_bf16_f32 v27, v158, v159
    v_cvt_pk_bf16_f32 v28, v160, v161
    v_cvt_pk_bf16_f32 v29, v162, v163
    v_cvt_pk_bf16_f32 v30, v164, v165
    v_cvt_pk_bf16_f32 v31, v166, v167
    s_nop 1
    v_permlane32_swap_b32 v24, v26
    v_permlane32_swap_b32 v25, v27
    v_permlane32_swap_b32 v28, v30
    v_permlane32_swap_b32 v29, v31
    s_nop 1
    buffer_store_dwordx4 v[24:27], v4, s[40:43], 0 offen offset:128 sc1
    buffer_store_dwordx4 v[28:31], v4, s[40:43], 0 offen offset:160 sc1
    v_cvt_pk_bf16_f32 v32, v184, v185
    v_cvt_pk_bf16_f32 v33, v186, v187
    v_cvt_pk_bf16_f32 v34, v188, v189
    v_cvt_pk_bf16_f32 v35, v190, v191
    v_cvt_pk_bf16_f32 v36, v192, v193
    v_cvt_pk_bf16_f32 v37, v194, v195
    v_cvt_pk_bf16_f32 v38, v196, v197
    v_cvt_pk_bf16_f32 v39, v198, v199
    s_nop 1
    v_permlane32_swap_b32 v32, v34
    v_permlane32_swap_b32 v33, v35
    v_permlane32_swap_b32 v36, v38
    v_permlane32_swap_b32 v37, v39
    s_nop 1
    buffer_store_dwordx4 v[32:35], v4, s[40:43], 0 offen offset:192 sc1
    buffer_store_dwordx4 v[36:39], v4, s[40:43], 0 offen offset:224 sc1
    s_branch .k2_wloop
.k2w_j3:
    s_sub_u32 s7, s5, 96
    s_load_dwordx2 s[8:9], s[0:1], 96
    s_load_dwordx2 s[10:11], s[0:1], 56
    s_load_dwordx2 s[12:13], s[0:1], 96
    s_lshr_b32 s21, s7, 0
    s_mul_i32 s20, s21, 1
    s_sub_u32 s20, s7, s20
    s_mul_i32 s6, s4, 1
    s_add_u32 s20, s20, s6
    s_mov_b32 s90, 136186880
    v_lshrrev_b32 v2, 2, v1
    v_lshrrev_b32 v3, 4, v1
    v_xor_b32 v3, v3, v1
    v_and_b32 v3, 3, v3
    v_lshlrev_b32 v3, 4, v3
    s_lshl_b32 s6, s3, 4
    s_mul_i32 s22, s20, 256
    s_add_u32 s22, s22, s6
    s_mul_i32 s23, s21, 128
    s_add_u32 s23, s23, s6
    s_mov_b32 s24, 1280
    s_mov_b32 s25, 1280

    v_add_u32 v4, s22, v2
    v_mul_lo_u32 v4, v4, s24
    v_add_u32 v4, v4, v3
    v_add_u32 v4, 23068672, v4
    v_add_u32 v5, s22, v2
    v_add_u32 v5, 64, v5
    v_mul_lo_u32 v5, v5, s24
    v_add_u32 v5, v5, v3
    v_add_u32 v5, 23068672, v5
    v_add_u32 v6, s22, v2
    v_add_u32 v6, 128, v6
    v_mul_lo_u32 v6, v6, s24
    v_add_u32 v6, v6, v3
    v_add_u32 v6, 23068672, v6
    v_add_u32 v7, s22, v2
    v_add_u32 v7, 192, v7
    v_mul_lo_u32 v7, v7, s24
    v_add_u32 v7, v7, v3
    v_add_u32 v7, 23068672, v7
    v_add_u32 v8, s23, v2
    v_mul_lo_u32 v8, v8, s25
    v_add_u32 v8, v8, v3
    v_add_u32 v9, s23, v2
    v_add_u32 v9, 64, v9
    v_mul_lo_u32 v9, v9, s25
    v_add_u32 v9, v9, v3
    s_waitcnt lgkmcnt(0)
    s_mov_b32 s32, s8
    s_mov_b32 s33, s9
    s_mov_b32 s34, 268435456
    s_mov_b32 s35, 0x00020000
    s_mov_b32 s36, s10
    s_mov_b32 s37, s11
    s_mov_b32 s38, 2621440
    s_mov_b32 s39, 0x00020000
    s_mov_b32 s40, s12
    s_mov_b32 s41, s13
    s_mov_b32 s42, 268435456
    s_mov_b32 s43, 0x00020000
    s_mov_b32 s48, 0
    s_add_u32 m0, s50, 0
    s_nop 0
    buffer_load_dwordx4 v4, s[32:35], s48 offen lds
    s_add_u32 m0, s50, 4096
    s_nop 0
    buffer_load_dwordx4 v5, s[32:35], s48 offen lds
    s_add_u32 m0, s50, 8192
    s_nop 0
    buffer_load_dwordx4 v6, s[32:35], s48 offen lds
    s_add_u32 m0, s50, 12288
    s_nop 0
    buffer_load_dwordx4 v7, s[32:35], s48 offen lds
    s_add_u32 m0, s50, 16384
    s_nop 0
    buffer_load_dwordx4 v8, s[36:39], s48 offen lds
    s_add_u32 m0, s50, 20480
    s_nop 0
    buffer_load_dwordx4 v9, s[36:39], s48 offen lds
    s_add_u32 s48, s48, 64
    s_add_u32 m0, s50, 24576
    s_nop 0
    buffer_load_dwordx4 v4, s[32:35], s48 offen lds
    s_add_u32 m0, s50, 28672
    s_nop 0
    buffer_load_dwordx4 v5, s[32:35], s48 offen lds
    s_add_u32 m0, s50, 32768
    s_nop 0
    buffer_load_dwordx4 v6, s[32:35], s48 offen lds
    s_add_u32 m0, s50, 36864
    s_nop 0
    buffer_load_dwordx4 v7, s[32:35], s48 offen lds
    s_add_u32 m0, s50, 40960
    s_nop 0
    buffer_load_dwordx4 v8, s[36:39], s48 offen lds
    s_add_u32 m0, s50, 45056
    s_nop 0
    buffer_load_dwordx4 v9, s[36:39], s48 offen lds
    s_add_u32 s48, s48, 64
    s_add_u32 m0, s50, 49152
    s_nop 0
    buffer_load_dwordx4 v4, s[32:35], s48 offen lds
    s_add_u32 m0, s50, 53248
    s_nop 0
    buffer_load_dwordx4 v5, s[32:35], s48 offen lds
    s_add_u32 m0, s50, 57344
    s_nop 0
    buffer_load_dwordx4 v6, s[32:35], s48 offen lds
    s_add_u32 m0, s50, 61440
    s_nop 0
    buffer_load_dwordx4 v7, s[32:35], s48 offen lds
    s_add_u32 m0, s50, 65536
    s_nop 0
    buffer_load_dwordx4 v8, s[36:39], s48 offen lds
    s_add_u32 m0, s50, 69632
    s_nop 0
    buffer_load_dwordx4 v9, s[36:39], s48 offen lds
    s_add_u32 s48, s48, 64
    s_add_u32 m0, s50, 73728
    s_nop 0
    buffer_load_dwordx4 v4, s[32:35], s48 offen lds
    s_add_u32 m0, s50, 77824
    s_nop 0
    buffer_load_dwordx4 v5, s[32:35], s48 offen lds
    s_add_u32 m0, s50, 81920
    s_nop 0
    buffer_load_dwordx4 v6, s[32:35], s48 offen lds
    s_add_u32 m0, s50, 86016
    s_nop 0
    buffer_load_dwordx4 v7, s[32:35], s48 offen lds
    s_add_u32 m0, s50, 90112
    s_nop 0
    buffer_load_dwordx4 v8, s[36:39], s48 offen lds
    s_add_u32 m0, s50, 94208
    s_nop 0
    buffer_load_dwordx4 v9, s[36:39], s48 offen lds
    s_add_u32 s48, s48, 64
    s_add_u32 m0, s50, 98304
    s_nop 0
    buffer_load_dwordx4 v4, s[32:35], s48 offen lds
    s_add_u32 m0, s50, 102400
    s_nop 0
    buffer_load_dwordx4 v5, s[32:35], s48 offen lds
    s_add_u32 m0, s50, 106496
    s_nop 0
    buffer_load_dwordx4 v6, s[32:35], s48 offen lds
    s_add_u32 m0, s50, 110592
    s_nop 0
    buffer_load_dwordx4 v7, s[32:35], s48 offen lds
    s_add_u32 m0, s50, 114688
    s_nop 0
    buffer_load_dwordx4 v8, s[36:39], s48 offen lds
    s_add_u32 m0, s50, 118784
    s_nop 0
    buffer_load_dwordx4 v9, s[36:39], s48 offen lds
    s_add_u32 s48, s48, 64
    s_and_b32 s44, s3, 1
    s_lshr_b32 s45, s3, 1
    s_mul_i32 s44, s44, 128
    s_mul_i32 s45, s45, 64
    v_and_b32 v2, 31, v1
    v_lshrrev_b32 v3, 5, v1
    v_lshrrev_b32 v24, 2, v1
    v_xor_b32 v24, v24, v3
    v_and_b32 v24, 3, v24
    v_lshlrev_b32 v24, 4, v24
    v_add_u32 v10, s44, v2
    v_lshlrev_b32 v10, 6, v10
    v_add_u32 v10, v10, v24
    v_xor_b32 v11, 32, v10
    v_add_u32 v12, s45, v2
    v_lshlrev_b32 v12, 6, v12
    v_add_u32 v12, v12, v24
    v_add_u32 v12, 16384, v12
    v_xor_b32 v13, 32, v12

    v_add_u32 v14, 49152, v10
    v_add_u32 v15, 49152, v11
    v_add_u32 v16, 49152, v12
    v_add_u32 v17, 49152, v13
    v_add_u32 v18, 98304, v10
    v_add_u32 v19, 98304, v11
    v_add_u32 v20, 98304, v12
    v_add_u32 v21, 98304, v13
    v_mov_b32 v72, 0
    v_mov_b32 v73, 0
    v_mov_b32 v74, 0
    v_mov_b32 v75, 0
    v_mov_b32 v76, 0
    v_mov_b32 v77, 0
    v_mov_b32 v78, 0
    v_mov_b32 v79, 0
    v_mov_b32 v80, 0
    v_mov_b32 v81, 0
    v_mov_b32 v82, 0
    v_mov_b32 v83, 0
    v_mov_b32 v84, 0
    v_mov_b32 v85, 0
    v_mov_b32 v86, 0
    v_mov_b32 v87, 0
    v_mov_b32 v88, 0
    v_mov_b32 v89, 0
    v_mov_b32 v90, 0
    v_mov_b32 v91, 0
    v_mov_b32 v92, 0
    v_mov_b32 v93, 0
    v_mov_b32 v94, 0
    v_mov_b32 v95, 0
    v_mov_b32 v96, 0
    v_mov_b32 v97, 0
    v_mov_b32 v98, 0
    v_mov_b32 v99, 0
    v_mov_b32 v100, 0
    v_mov_b32 v101, 0
    v_mov_b32 v102, 0
    v_mov_b32 v103, 0
    v_mov_b32 v104, 0
    v_mov_b32 v105, 0
    v_mov_b32 v106, 0
    v_mov_b32 v107, 0
    v_mov_b32 v108, 0
    v_mov_b32 v109, 0
    v_mov_b32 v110, 0
    v_mov_b32 v111, 0
    v_mov_b32 v112, 0
    v_mov_b32 v113, 0
    v_mov_b32 v114, 0
    v_mov_b32 v115, 0
    v_mov_b32 v116, 0
    v_mov_b32 v117, 0
    v_mov_b32 v118, 0
    v_mov_b32 v119, 0
    v_mov_b32 v120, 0
    v_mov_b32 v121, 0
    v_mov_b32 v122, 0
    v_mov_b32 v123, 0
    v_mov_b32 v124, 0
    v_mov_b32 v125, 0
    v_mov_b32 v126, 0
    v_mov_b32 v127, 0
    v_mov_b32 v128, 0
    v_mov_b32 v129, 0
    v_mov_b32 v130, 0
    v_mov_b32 v131, 0
    v_mov_b32 v132, 0
    v_mov_b32 v133, 0
    v_mov_b32 v134, 0
    v_mov_b32 v135, 0
    v_mov_b32 v136, 0
    v_mov_b32 v137, 0
    v_mov_b32 v138, 0
    v_mov_b32 v139, 0
    v_mov_b32 v140, 0
    v_mov_b32 v141, 0
    v_mov_b32 v142, 0
    v_mov_b32 v143, 0
    v_mov_b32 v144, 0
    v_mov_b32 v145, 0
    v_mov_b32 v146, 0
    v_mov_b32 v147, 0
    v_mov_b32 v148, 0
    v_mov_b32 v149, 0
    v_mov_b32 v150, 0
    v_mov_b32 v151, 0
    v_mov_b32 v152, 0
    v_mov_b32 v153, 0
    v_mov_b32 v154, 0
    v_mov_b32 v155, 0
    v_mov_b32 v156, 0
    v_mov_b32 v157, 0
    v_mov_b32 v158, 0
    v_mov_b32 v159, 0
    v_mov_b32 v160, 0
    v_mov_b32 v161, 0
    v_mov_b32 v162, 0
    v_mov_b32 v163, 0
    v_mov_b32 v164, 0
    v_mov_b32 v165, 0
    v_mov_b32 v166, 0
    v_mov_b32 v167, 0
    v_mov_b32 v168, 0
    v_mov_b32 v169, 0
    v_mov_b32 v170, 0
    v_mov_b32 v171, 0
    v_mov_b32 v172, 0
    v_mov_b32 v173, 0
    v_mov_b32 v174, 0
    v_mov_b32 v175, 0
    v_mov_b32 v176, 0
    v_mov_b32 v177, 0
    v_mov_b32 v178, 0
    v_mov_b32 v179, 0
    v_mov_b32 v180, 0
    v_mov_b32 v181, 0
    v_mov_b32 v182, 0
    v_mov_b32 v183, 0
    v_mov_b32 v184, 0
    v_mov_b32 v185, 0
    v_mov_b32 v186, 0
    v_mov_b32 v187, 0
    v_mov_b32 v188, 0
    v_mov_b32 v189, 0
    v_mov_b32 v190, 0
    v_mov_b32 v191, 0
    v_mov_b32 v192, 0
    v_mov_b32 v193, 0
    v_mov_b32 v194, 0
    v_mov_b32 v195, 0
    v_mov_b32 v196, 0
    v_mov_b32 v197, 0
    v_mov_b32 v198, 0
    v_mov_b32 v199, 0
    s_waitcnt vmcnt(24)
    s_barrier
    ds_read_b128 v[24:27], v10 offset:0
    ds_read_b128 v[28:31], v10 offset:2048
    ds_read_b128 v[32:35], v10 offset:4096
    ds_read_b128 v[36:39], v10 offset:6144
    ds_read_b128 v[40:43], v12 offset:0
    ds_read_b128 v[44:47], v12 offset:2048
    s_mov_b32 s49, 3
.k2w_b3_loop:
    s_waitcnt lgkmcnt(0)
    v_mfma_f32_32x32x16_bf16 v[72:87], v[24:27], v[40:43], v[72:87]
    ds_read_b128 v[48:51], v11 offset:0
    v_mfma_f32_32x32x16_bf16 v[104:119], v[28:31], v[40:43], v[104:119]
    ds_read_b128 v[52:55], v11 offset:2048
    v_mfma_f32_32x32x16_bf16 v[136:151], v[32:35], v[40:43], v[136:151]
    ds_read_b128 v[56:59], v11 offset:4096
    v_mfma_f32_32x32x16_bf16 v[168:183], v[36:39], v[40:43], v[168:183]
    ds_read_b128 v[60:63], v11 offset:6144
    v_mfma_f32_32x32x16_bf16 v[88:103], v[24:27], v[44:47], v[88:103]
    ds_read_b128 v[64:67], v13 offset:0
    v_mfma_f32_32x32x16_bf16 v[120:135], v[28:31], v[44:47], v[120:135]
    ds_read_b128 v[68:71], v13 offset:2048
    v_mfma_f32_32x32x16_bf16 v[152:167], v[32:35], v[44:47], v[152:167]
    v_mfma_f32_32x32x16_bf16 v[184:199], v[36:39], v[44:47], v[184:199]
    s_waitcnt vmcnt(18) lgkmcnt(0)
    s_barrier
    v_mfma_f32_32x32x16_bf16 v[72:87], v[48:51], v[64:67], v[72:87]
    ds_read_b128 v[24:27], v10 offset:24576
    ds_read_b128 v[28:31], v10 offset:26624
    v_mfma_f32_32x32x16_bf16 v[104:119], v[52:55], v[64:67], v[104:119]
    ds_read_b128 v[32:35], v10 offset:28672
    ds_read_b128 v[36:39], v10 offset:30720
    v_mfma_f32_32x32x16_bf16 v[136:151], v[56:59], v[64:67], v[136:151]
    ds_read_b128 v[40:43], v12 offset:24576
    ds_read_b128 v[44:47], v12 offset:26624
    v_mfma_f32_32x32x16_bf16 v[168:183], v[60:63], v[64:67], v[168:183]
    s_add_u32 m0, s50, 0
    s_nop 0
    buffer_load_dwordx4 v4, s[32:35], s48 offen lds
    s_add_u32 m0, s50, 4096
    s_nop 0
    buffer_load_dwordx4 v5, s[32:35], s48 offen lds
    v_mfma_f32_32x32x16_bf16 v[88:103], v[48:51], v[68:71], v[88:103]
    s_add_u32 m0, s50, 8192
    s_nop 0
    buffer_load_dwordx4 v6, s[32:35], s48 offen lds
    s_add_u32 m0, s50, 12288
    s_nop 0
    buffer_load_dwordx4 v7, s[32:35], s48 offen lds
    v_mfma_f32_32x32x16_bf16 v[120:135], v[52:55], v[68:71], v[120:135]
    s_add_u32 m0, s50, 16384
    s_nop 0
    buffer_load_dwordx4 v8, s[36:39], s48 offen lds
    s_add_u32 m0, s50, 20480
    s_nop 0
    buffer_load_dwordx4 v9, s[36:39], s48 offen lds
    v_mfma_f32_32x32x16_bf16 v[152:167], v[56:59], v[68:71], v[152:167]
    v_mfma_f32_32x32x16_bf16 v[184:199], v[60:63], v[68:71], v[184:199]
    s_add_u32 s48, s48, 64
    s_waitcnt lgkmcnt(0)
    v_mfma_f32_32x32x16_bf16 v[72:87], v[24:27], v[40:43], v[72:87]
    ds_read_b128 v[48:51], v11 offset:24576
    v_mfma_f32_32x32x16_bf16 v[104:119], v[28:31], v[40:43], v[104:119]
    ds_read_b128 v[52:55], v11 offset:26624
    v_mfma_f32_32x32x16_bf16 v[136:151], v[32:35], v[40:43], v[136:151]
    ds_read_b128 v[56:59], v11 offset:28672
    v_mfma_f32_32x32x16_bf16 v[168:183], v[36:39], v[40:43], v[168:183]
    ds_read_b128 v[60:63], v11 offset:30720
    v_mfma_f32_32x32x16_bf16 v[88:103], v[24:27], v[44:47], v[88:103]
    ds_read_b128 v[64:67], v13 offset:24576
    v_mfma_f32_32x32x16_bf16 v[120:135], v[28:31], v[44:47], v[120:135]
    ds_read_b128 v[68:71], v13 offset:26624
    v_mfma_f32_32x32x16_bf16 v[152:167], v[32:35], v[44:47], v[152:167]
    v_mfma_f32_32x32x16_bf16 v[184:199], v[36:39], v[44:47], v[184:199]
    s_waitcnt vmcnt(18) lgkmcnt(0)
    s_barrier
    v_mfma_f32_32x32x16_bf16 v[72:87], v[48:51], v[64:67], v[72:87]
    ds_read_b128 v[24:27], v14 offset:0
    ds_read_b128 v[28:31], v14 offset:2048
    v_mfma_f32_32x32x16_bf16 v[104:119], v[52:55], v[64:67], v[104:119]
    ds_read_b128 v[32:35], v14 offset:4096
    ds_read_b128 v[36:39], v14 offset:6144
    v_mfma_f32_32x32x16_bf16 v[136:151], v[56:59], v[64:67], v[136:151]
    ds_read_b128 v[40:43], v16 offset:0
    ds_read_b128 v[44:47], v16 offset:2048
    v_mfma_f32_32x32x16_bf16 v[168:183], v[60:63], v[64:67], v[168:183]
    s_add_u32 m0, s50, 24576
    s_nop 0
    buffer_load_dwordx4 v4, s[32:35], s48 offen lds
    s_add_u32 m0, s50, 28672
    s_nop 0
    buffer_load_dwordx4 v5, s[32:35], s48 offen lds
    v_mfma_f32_32x32x16_bf16 v[88:103], v[48:51], v[68:71], v[88:103]
    s_add_u32 m0, s50, 32768
    s_nop 0
    buffer_load_dwordx4 v6, s[32:35], s48 offen lds
    s_add_u32 m0, s50, 36864
    s_nop 0
    buffer_load_dwordx4 v7, s[32:35], s48 offen lds
    v_mfma_f32_32x32x16_bf16 v[120:135], v[52:55], v[68:71], v[120:135]
    s_add_u32 m0, s50, 40960
    s_nop 0
    buffer_load_dwordx4 v8, s[36:39], s48 offen lds
    s_add_u32 m0, s50, 45056
    s_nop 0
    buffer_load_dwordx4 v9, s[36:39], s48 offen lds
    v_mfma_f32_32x32x16_bf16 v[152:167], v[56:59], v[68:71], v[152:167]
    v_mfma_f32_32x32x16_bf16 v[184:199], v[60:63], v[68:71], v[184:199]
    s_add_u32 s48, s48, 64
    s_waitcnt lgkmcnt(0)
    v_mfma_f32_32x32x16_bf16 v[72:87], v[24:27], v[40:43], v[72:87]
    ds_read_b128 v[48:51], v15 offset:0
    v_mfma_f32_32x32x16_bf16 v[104:119], v[28:31], v[40:43], v[104:119]
    ds_read_b128 v[52:55], v15 offset:2048
    v_mfma_f32_32x32x16_bf16 v[136:151], v[32:35], v[40:43], v[136:151]
    ds_read_b128 v[56:59], v15 offset:4096
    v_mfma_f32_32x32x16_bf16 v[168:183], v[36:39], v[40:43], v[168:183]
    ds_read_b128 v[60:63], v15 offset:6144
    v_mfma_f32_32x32x16_bf16 v[88:103], v[24:27], v[44:47], v[88:103]
    ds_read_b128 v[64:67], v17 offset:0
    v_mfma_f32_32x32x16_bf16 v[120:135], v[28:31], v[44:47], v[120:135]
    ds_read_b128 v[68:71], v17 offset:2048
    v_mfma_f32_32x32x16_bf16 v[152:167], v[32:35], v[44:47], v[152:167]
    v_mfma_f32_32x32x16_bf16 v[184:199], v[36:39], v[44:47], v[184:199]
    s_waitcnt vmcnt(18) lgkmcnt(0)
    s_barrier
    v_mfma_f32_32x32x16_bf16 v[72:87], v[48:51], v[64:67], v[72:87]
    ds_read_b128 v[24:27], v14 offset:24576
    ds_read_b128 v[28:31], v14 offset:26624
    v_mfma_f32_32x32x16_bf16 v[104:119], v[52:55], v[64:67], v[104:119]
    ds_read_b128 v[32:35], v14 offset:28672
    ds_read_b128 v[36:39], v14 offset:30720
    v_mfma_f32_32x32x16_bf16 v[136:151], v[56:59], v[64:67], v[136:151]
    ds_read_b128 v[40:43], v16 offset:24576
    ds_read_b128 v[44:47], v16 offset:26624
    v_mfma_f32_32x32x16_bf16 v[168:183], v[60:63], v[64:67], v[168:183]
    s_add_u32 m0, s50, 49152
    s_nop 0
    buffer_load_dwordx4 v4, s[32:35], s48 offen lds
    s_add_u32 m0, s50, 53248
    s_nop 0
    buffer_load_dwordx4 v5, s[32:35], s48 offen lds
    v_mfma_f32_32x32x16_bf16 v[88:103], v[48:51], v[68:71], v[88:103]
    s_add_u32 m0, s50, 57344
    s_nop 0
    buffer_load_dwordx4 v6, s[32:35], s48 offen lds
    s_add_u32 m0, s50, 61440
    s_nop 0
    buffer_load_dwordx4 v7, s[32:35], s48 offen lds
    v_mfma_f32_32x32x16_bf16 v[120:135], v[52:55], v[68:71], v[120:135]
    s_add_u32 m0, s50, 65536
    s_nop 0
    buffer_load_dwordx4 v8, s[36:39], s48 offen lds
    s_add_u32 m0, s50, 69632
    s_nop 0
    buffer_load_dwordx4 v9, s[36:39], s48 offen lds
    v_mfma_f32_32x32x16_bf16 v[152:167], v[56:59], v[68:71], v[152:167]
    v_mfma_f32_32x32x16_bf16 v[184:199], v[60:63], v[68:71], v[184:199]
    s_add_u32 s48, s48, 64
    s_waitcnt lgkmcnt(0)
    v_mfma_f32_32x32x16_bf16 v[72:87], v[24:27], v[40:43], v[72:87]
    ds_read_b128 v[48:51], v15 offset:24576
    v_mfma_f32_32x32x16_bf16 v[104:119], v[28:31], v[40:43], v[104:119]
    ds_read_b128 v[52:55], v15 offset:26624
    v_mfma_f32_32x32x16_bf16 v[136:151], v[32:35], v[40:43], v[136:151]
    ds_read_b128 v[56:59], v15 offset:28672
    v_mfma_f32_32x32x16_bf16 v[168:183], v[36:39], v[40:43], v[168:183]
    ds_read_b128 v[60:63], v15 offset:30720
    v_mfma_f32_32x32x16_bf16 v[88:103], v[24:27], v[44:47], v[88:103]
    ds_read_b128 v[64:67], v17 offset:24576
    v_mfma_f32_32x32x16_bf16 v[120:135], v[28:31], v[44:47], v[120:135]
    ds_read_b128 v[68:71], v17 offset:26624
    v_mfma_f32_32x32x16_bf16 v[152:167], v[32:35], v[44:47], v[152:167]
    v_mfma_f32_32x32x16_bf16 v[184:199], v[36:39], v[44:47], v[184:199]
    s_waitcnt vmcnt(18) lgkmcnt(0)
    s_barrier
    v_mfma_f32_32x32x16_bf16 v[72:87], v[48:51], v[64:67], v[72:87]
    ds_read_b128 v[24:27], v18 offset:0
    ds_read_b128 v[28:31], v18 offset:2048
    v_mfma_f32_32x32x16_bf16 v[104:119], v[52:55], v[64:67], v[104:119]
    ds_read_b128 v[32:35], v18 offset:4096
    ds_read_b128 v[36:39], v18 offset:6144
    v_mfma_f32_32x32x16_bf16 v[136:151], v[56:59], v[64:67], v[136:151]
    ds_read_b128 v[40:43], v20 offset:0
    ds_read_b128 v[44:47], v20 offset:2048
    v_mfma_f32_32x32x16_bf16 v[168:183], v[60:63], v[64:67], v[168:183]
    s_add_u32 m0, s50, 73728
    s_nop 0
    buffer_load_dwordx4 v4, s[32:35], s48 offen lds
    s_add_u32 m0, s50, 77824
    s_nop 0
    buffer_load_dwordx4 v5, s[32:35], s48 offen lds
    v_mfma_f32_32x32x16_bf16 v[88:103], v[48:51], v[68:71], v[88:103]
    s_add_u32 m0, s50, 81920
    s_nop 0
    buffer_load_dwordx4 v6, s[32:35], s48 offen lds
    s_add_u32 m0, s50, 86016
    s_nop 0
    buffer_load_dwordx4 v7, s[32:35], s48 offen lds
    v_mfma_f32_32x32x16_bf16 v[120:135], v[52:55], v[68:71], v[120:135]
    s_add_u32 m0, s50, 90112
    s_nop 0
    buffer_load_dwordx4 v8, s[36:39], s48 offen lds
    s_add_u32 m0, s50, 94208
    s_nop 0
    buffer_load_dwordx4 v9, s[36:39], s48 offen lds
    v_mfma_f32_32x32x16_bf16 v[152:167], v[56:59], v[68:71], v[152:167]
    v_mfma_f32_32x32x16_bf16 v[184:199], v[60:63], v[68:71], v[184:199]
    s_add_u32 s48, s48, 64
    s_waitcnt lgkmcnt(0)
    v_mfma_f32_32x32x16_bf16 v[72:87], v[24:27], v[40:43], v[72:87]
    ds_read_b128 v[48:51], v19 offset:0
    v_mfma_f32_32x32x16_bf16 v[104:119], v[28:31], v[40:43], v[104:119]
    ds_read_b128 v[52:55], v19 offset:2048
    v_mfma_f32_32x32x16_bf16 v[136:151], v[32:35], v[40:43], v[136:151]
    ds_read_b128 v[56:59], v19 offset:4096
    v_mfma_f32_32x32x16_bf16 v[168:183], v[36:39], v[40:43], v[168:183]
    ds_read_b128 v[60:63], v19 offset:6144
    v_mfma_f32_32x32x16_bf16 v[88:103], v[24:27], v[44:47], v[88:103]
    ds_read_b128 v[64:67], v21 offset:0
    v_mfma_f32_32x32x16_bf16 v[120:135], v[28:31], v[44:47], v[120:135]
    ds_read_b128 v[68:71], v21 offset:2048
    v_mfma_f32_32x32x16_bf16 v[152:167], v[32:35], v[44:47], v[152:167]
    v_mfma_f32_32x32x16_bf16 v[184:199], v[36:39], v[44:47], v[184:199]
    s_waitcnt vmcnt(18) lgkmcnt(0)
    s_barrier
    v_mfma_f32_32x32x16_bf16 v[72:87], v[48:51], v[64:67], v[72:87]
    ds_read_b128 v[24:27], v10 offset:0
    ds_read_b128 v[28:31], v10 offset:2048
    v_mfma_f32_32x32x16_bf16 v[104:119], v[52:55], v[64:67], v[104:119]
    ds_read_b128 v[32:35], v10 offset:4096
    ds_read_b128 v[36:39], v10 offset:6144
    v_mfma_f32_32x32x16_bf16 v[136:151], v[56:59], v[64:67], v[136:151]
    ds_read_b128 v[40:43], v12 offset:0
    ds_read_b128 v[44:47], v12 offset:2048
    v_mfma_f32_32x32x16_bf16 v[168:183], v[60:63], v[64:67], v[168:183]
    s_add_u32 m0, s50, 98304
    s_nop 0
    buffer_load_dwordx4 v4, s[32:35], s48 offen lds
    s_add_u32 m0, s50, 102400
    s_nop 0
    buffer_load_dwordx4 v5, s[32:35], s48 offen lds
    v_mfma_f32_32x32x16_bf16 v[88:103], v[48:51], v[68:71], v[88:103]
    s_add_u32 m0, s50, 106496
    s_nop 0
    buffer_load_dwordx4 v6, s[32:35], s48 offen lds
    s_add_u32 m0, s50, 110592
    s_nop 0
    buffer_load_dwordx4 v7, s[32:35], s48 offen lds
    v_mfma_f32_32x32x16_bf16 v[120:135], v[52:55], v[68:71], v[120:135]
    s_add_u32 m0, s50, 114688
    s_nop 0
    buffer_load_dwordx4 v8, s[36:39], s48 offen lds
    s_add_u32 m0, s50, 118784
    s_nop 0
    buffer_load_dwordx4 v9, s[36:39], s48 offen lds
    v_mfma_f32_32x32x16_bf16 v[152:167], v[56:59], v[68:71], v[152:167]
    v_mfma_f32_32x32x16_bf16 v[184:199], v[60:63], v[68:71], v[184:199]
    s_add_u32 s48, s48, 64
    s_sub_u32 s49, s49, 1
    s_cmp_lg_u32 s49, 0
    s_cbranch_scc1 .k2w_b3_loop
    s_waitcnt lgkmcnt(0)
    v_mfma_f32_32x32x16_bf16 v[72:87], v[24:27], v[40:43], v[72:87]
    ds_read_b128 v[48:51], v11 offset:0
    v_mfma_f32_32x32x16_bf16 v[104:119], v[28:31], v[40:43], v[104:119]
    ds_read_b128 v[52:55], v11 offset:2048
    v_mfma_f32_32x32x16_bf16 v[136:151], v[32:35], v[40:43], v[136:151]
    ds_read_b128 v[56:59], v11 offset:4096
    v_mfma_f32_32x32x16_bf16 v[168:183], v[36:39], v[40:43], v[168:183]
    ds_read_b128 v[60:63], v11 offset:6144
    v_mfma_f32_32x32x16_bf16 v[88:103], v[24:27], v[44:47], v[88:103]
    ds_read_b128 v[64:67], v13 offset:0
    v_mfma_f32_32x32x16_bf16 v[120:135], v[28:31], v[44:47], v[120:135]
    ds_read_b128 v[68:71], v13 offset:2048
    v_mfma_f32_32x32x16_bf16 v[152:167], v[32:35], v[44:47], v[152:167]
    v_mfma_f32_32x32x16_bf16 v[184:199], v[36:39], v[44:47], v[184:199]
    s_waitcnt vmcnt(18) lgkmcnt(0)
    s_barrier
    v_mfma_f32_32x32x16_bf16 v[72:87], v[48:51], v[64:67], v[72:87]
    ds_read_b128 v[24:27], v10 offset:24576
    v_mfma_f32_32x32x16_bf16 v[104:119], v[52:55], v[64:67], v[104:119]
    ds_read_b128 v[28:31], v10 offset:26624
    v_mfma_f32_32x32x16_bf16 v[136:151], v[56:59], v[64:67], v[136:151]
    ds_read_b128 v[32:35], v10 offset:28672
    v_mfma_f32_32x32x16_bf16 v[168:183], v[60:63], v[64:67], v[168:183]
    ds_read_b128 v[36:39], v10 offset:30720
    v_mfma_f32_32x32x16_bf16 v[88:103], v[48:51], v[68:71], v[88:103]
    ds_read_b128 v[40:43], v12 offset:24576
    v_mfma_f32_32x32x16_bf16 v[120:135], v[52:55], v[68:71], v[120:135]
    ds_read_b128 v[44:47], v12 offset:26624
    v_mfma_f32_32x32x16_bf16 v[152:167], v[56:59], v[68:71], v[152:167]
    v_mfma_f32_32x32x16_bf16 v[184:199], v[60:63], v[68:71], v[184:199]
    s_waitcnt lgkmcnt(0)
    v_mfma_f32_32x32x16_bf16 v[72:87], v[24:27], v[40:43], v[72:87]
    ds_read_b128 v[48:51], v11 offset:24576
    v_mfma_f32_32x32x16_bf16 v[104:119], v[28:31], v[40:43], v[104:119]
    ds_read_b128 v[52:55], v11 offset:26624
    v_mfma_f32_32x32x16_bf16 v[136:151], v[32:35], v[40:43], v[136:151]
    ds_read_b128 v[56:59], v11 offset:28672
    v_mfma_f32_32x32x16_bf16 v[168:183], v[36:39], v[40:43], v[168:183]
    ds_read_b128 v[60:63], v11 offset:30720
    v_mfma_f32_32x32x16_bf16 v[88:103], v[24:27], v[44:47], v[88:103]
    ds_read_b128 v[64:67], v13 offset:24576
    v_mfma_f32_32x32x16_bf16 v[120:135], v[28:31], v[44:47], v[120:135]
    ds_read_b128 v[68:71], v13 offset:26624
    v_mfma_f32_32x32x16_bf16 v[152:167], v[32:35], v[44:47], v[152:167]
    v_mfma_f32_32x32x16_bf16 v[184:199], v[36:39], v[44:47], v[184:199]
    s_waitcnt vmcnt(12) lgkmcnt(0)
    s_barrier
    v_mfma_f32_32x32x16_bf16 v[72:87], v[48:51], v[64:67], v[72:87]
    ds_read_b128 v[24:27], v14 offset:0
    v_mfma_f32_32x32x16_bf16 v[104:119], v[52:55], v[64:67], v[104:119]
    ds_read_b128 v[28:31], v14 offset:2048
    v_mfma_f32_32x32x16_bf16 v[136:151], v[56:59], v[64:67], v[136:151]
    ds_read_b128 v[32:35], v14 offset:4096
    v_mfma_f32_32x32x16_bf16 v[168:183], v[60:63], v[64:67], v[168:183]
    ds_read_b128 v[36:39], v14 offset:6144
    v_mfma_f32_32x32x16_bf16 v[88:103], v[48:51], v[68:71], v[88:103]
    ds_read_b128 v[40:43], v16 offset:0
    v_mfma_f32_32x32x16_bf16 v[120:135], v[52:55], v[68:71], v[120:135]
    ds_read_b128 v[44:47], v16 offset:2048
    v_mfma_f32_32x32x16_bf16 v[152:167], v[56:59], v[68:71], v[152:167]
    v_mfma_f32_32x32x16_bf16 v[184:199], v[60:63], v[68:71], v[184:199]
    s_waitcnt lgkmcnt(0)
    v_mfma_f32_32x32x16_bf16 v[72:87], v[24:27], v[40:43], v[72:87]
    ds_read_b128 v[48:51], v15 offset:0
    v_mfma_f32_32x32x16_bf16 v[104:119], v[28:31], v[40:43], v[104:119]
    ds_read_b128 v[52:55], v15 offset:2048
    v_mfma_f32_32x32x16_bf16 v[136:151], v[32:35], v[40:43], v[136:151]
    ds_read_b128 v[56:59], v15 offset:4096
    v_mfma_f32_32x32x16_bf16 v[168:183], v[36:39], v[40:43], v[168:183]
    ds_read_b128 v[60:63], v15 offset:6144
    v_mfma_f32_32x32x16_bf16 v[88:103], v[24:27], v[44:47], v[88:103]
    ds_read_b128 v[64:67], v17 offset:0
    v_mfma_f32_32x32x16_bf16 v[120:135], v[28:31], v[44:47], v[120:135]
    ds_read_b128 v[68:71], v17 offset:2048
    v_mfma_f32_32x32x16_bf16 v[152:167], v[32:35], v[44:47], v[152:167]
    v_mfma_f32_32x32x16_bf16 v[184:199], v[36:39], v[44:47], v[184:199]
    s_waitcnt vmcnt(6) lgkmcnt(0)
    s_barrier
    v_mfma_f32_32x32x16_bf16 v[72:87], v[48:51], v[64:67], v[72:87]
    ds_read_b128 v[24:27], v14 offset:24576
    v_mfma_f32_32x32x16_bf16 v[104:119], v[52:55], v[64:67], v[104:119]
    ds_read_b128 v[28:31], v14 offset:26624
    v_mfma_f32_32x32x16_bf16 v[136:151], v[56:59], v[64:67], v[136:151]
    ds_read_b128 v[32:35], v14 offset:28672
    v_mfma_f32_32x32x16_bf16 v[168:183], v[60:63], v[64:67], v[168:183]
    ds_read_b128 v[36:39], v14 offset:30720
    v_mfma_f32_32x32x16_bf16 v[88:103], v[48:51], v[68:71], v[88:103]
    ds_read_b128 v[40:43], v16 offset:24576
    v_mfma_f32_32x32x16_bf16 v[120:135], v[52:55], v[68:71], v[120:135]
    ds_read_b128 v[44:47], v16 offset:26624
    v_mfma_f32_32x32x16_bf16 v[152:167], v[56:59], v[68:71], v[152:167]
    v_mfma_f32_32x32x16_bf16 v[184:199], v[60:63], v[68:71], v[184:199]
    s_waitcnt lgkmcnt(0)
    v_mfma_f32_32x32x16_bf16 v[72:87], v[24:27], v[40:43], v[72:87]
    ds_read_b128 v[48:51], v15 offset:24576
    v_mfma_f32_32x32x16_bf16 v[104:119], v[28:31], v[40:43], v[104:119]
    ds_read_b128 v[52:55], v15 offset:26624
    v_mfma_f32_32x32x16_bf16 v[136:151], v[32:35], v[40:43], v[136:151]
    ds_read_b128 v[56:59], v15 offset:28672
    v_mfma_f32_32x32x16_bf16 v[168:183], v[36:39], v[40:43], v[168:183]
    ds_read_b128 v[60:63], v15 offset:30720
    v_mfma_f32_32x32x16_bf16 v[88:103], v[24:27], v[44:47], v[88:103]
    ds_read_b128 v[64:67], v17 offset:24576
    v_mfma_f32_32x32x16_bf16 v[120:135], v[28:31], v[44:47], v[120:135]
    ds_read_b128 v[68:71], v17 offset:26624
    v_mfma_f32_32x32x16_bf16 v[152:167], v[32:35], v[44:47], v[152:167]
    v_mfma_f32_32x32x16_bf16 v[184:199], v[36:39], v[44:47], v[184:199]
    s_waitcnt vmcnt(0) lgkmcnt(0)
    s_barrier
    v_mfma_f32_32x32x16_bf16 v[72:87], v[48:51], v[64:67], v[72:87]
    ds_read_b128 v[24:27], v18 offset:0
    v_mfma_f32_32x32x16_bf16 v[104:119], v[52:55], v[64:67], v[104:119]
    ds_read_b128 v[28:31], v18 offset:2048
    v_mfma_f32_32x32x16_bf16 v[136:151], v[56:59], v[64:67], v[136:151]
    ds_read_b128 v[32:35], v18 offset:4096
    v_mfma_f32_32x32x16_bf16 v[168:183], v[60:63], v[64:67], v[168:183]
    ds_read_b128 v[36:39], v18 offset:6144
    v_mfma_f32_32x32x16_bf16 v[88:103], v[48:51], v[68:71], v[88:103]
    ds_read_b128 v[40:43], v20 offset:0
    v_mfma_f32_32x32x16_bf16 v[120:135], v[52:55], v[68:71], v[120:135]
    ds_read_b128 v[44:47], v20 offset:2048
    v_mfma_f32_32x32x16_bf16 v[152:167], v[56:59], v[68:71], v[152:167]
    v_mfma_f32_32x32x16_bf16 v[184:199], v[60:63], v[68:71], v[184:199]
    s_waitcnt lgkmcnt(0)
    v_mfma_f32_32x32x16_bf16 v[72:87], v[24:27], v[40:43], v[72:87]
    ds_read_b128 v[48:51], v19 offset:0
    v_mfma_f32_32x32x16_bf16 v[104:119], v[28:31], v[40:43], v[104:119]
    ds_read_b128 v[52:55], v19 offset:2048
    v_mfma_f32_32x32x16_bf16 v[136:151], v[32:35], v[40:43], v[136:151]
    ds_read_b128 v[56:59], v19 offset:4096
    v_mfma_f32_32x32x16_bf16 v[168:183], v[36:39], v[40:43], v[168:183]
    ds_read_b128 v[60:63], v19 offset:6144
    v_mfma_f32_32x32x16_bf16 v[88:103], v[24:27], v[44:47], v[88:103]
    ds_read_b128 v[64:67], v21 offset:0
    v_mfma_f32_32x32x16_bf16 v[120:135], v[28:31], v[44:47], v[120:135]
    ds_read_b128 v[68:71], v21 offset:2048
    v_mfma_f32_32x32x16_bf16 v[152:167], v[32:35], v[44:47], v[152:167]
    v_mfma_f32_32x32x16_bf16 v[184:199], v[36:39], v[44:47], v[184:199]
    s_waitcnt lgkmcnt(0)
    v_mfma_f32_32x32x16_bf16 v[72:87], v[48:51], v[64:67], v[72:87]
    v_mfma_f32_32x32x16_bf16 v[104:119], v[52:55], v[64:67], v[104:119]
    v_mfma_f32_32x32x16_bf16 v[136:151], v[56:59], v[64:67], v[136:151]
    v_mfma_f32_32x32x16_bf16 v[168:183], v[60:63], v[64:67], v[168:183]
    v_mfma_f32_32x32x16_bf16 v[88:103], v[48:51], v[68:71], v[88:103]
    v_mfma_f32_32x32x16_bf16 v[120:135], v[52:55], v[68:71], v[120:135]
    v_mfma_f32_32x32x16_bf16 v[152:167], v[56:59], v[68:71], v[152:167]
    v_mfma_f32_32x32x16_bf16 v[184:199], v[60:63], v[68:71], v[184:199]
    s_mul_i32 s46, s20, 256
    s_add_u32 s46, s46, s44
    s_mul_i32 s47, s21, 128
    s_add_u32 s47, s47, s45
    s_mov_b32 s24, 3840
    v_add_u32 v4, s47, v2
    v_mul_lo_u32 v4, v4, s24
    v_lshlrev_b32 v5, 4, v3
    v_add_u32 v4, v4, v5
    s_lshl_b32 s49, s46, 1
    s_add_u32 s49, s49, 83886080
    v_add_u32 v4, s49, v4
    s_nop 15

    s_cmp_ge_u32 s46, 1920
    s_cbranch_scc1 .k2w_end
    v_cvt_pk_bf16_f32 v24, v72, v73
    v_cvt_pk_bf16_f32 v25, v74, v75
    v_cvt_pk_bf16_f32 v26, v76, v77
    v_cvt_pk_bf16_f32 v27, v78, v79
    v_cvt_pk_bf16_f32 v28, v80, v81
    v_cvt_pk_bf16_f32 v29, v82, v83
    v_cvt_pk_bf16_f32 v30, v84, v85
    v_cvt_pk_bf16_f32 v31, v86, v87
    s_nop 1
    v_permlane32_swap_b32 v24, v26
    v_permlane32_swap_b32 v25, v27
    v_permlane32_swap_b32 v28, v30
    v_permlane32_swap_b32 v29, v31
    s_nop 1
    buffer_store_dwordx4 v[24:27], v4, s[40:43], 0 offen offset:0 sc1
    buffer_store_dwordx4 v[28:31], v4, s[40:43], 0 offen offset:32 sc1
    v_cvt_pk_bf16_f32 v32, v104, v105
    v_cvt_pk_bf16_f32 v33, v106, v107
    v_cvt_pk_bf16_f32 v34, v108, v109
    v_cvt_pk_bf16_f32 v35, v110, v111
    v_cvt_pk_bf16_f32 v36, v112, v113
    v_cvt_pk_bf16_f32 v37, v114, v115
    v_cvt_pk_bf16_f32 v38, v116, v117
    v_cvt_pk_bf16_f32 v39, v118, v119
    s_nop 1
    v_permlane32_swap_b32 v32, v34
    v_permlane32_swap_b32 v33, v35
    v_permlane32_swap_b32 v36, v38
    v_permlane32_swap_b32 v37, v39
    s_nop 1
    buffer_store_dwordx4 v[32:35], v4, s[40:43], 0 offen offset:64 sc1
    buffer_store_dwordx4 v[36:39], v4, s[40:43], 0 offen offset:96 sc1
    v_cvt_pk_bf16_f32 v40, v136, v137
    v_cvt_pk_bf16_f32 v41, v138, v139
    v_cvt_pk_bf16_f32 v42, v140, v141
    v_cvt_pk_bf16_f32 v43, v142, v143
    v_cvt_pk_bf16_f32 v44, v144, v145
    v_cvt_pk_bf16_f32 v45, v146, v147
    v_cvt_pk_bf16_f32 v46, v148, v149
    v_cvt_pk_bf16_f32 v47, v150, v151
    s_nop 1
    v_permlane32_swap_b32 v40, v42
    v_permlane32_swap_b32 v41, v43
    v_permlane32_swap_b32 v44, v46
    v_permlane32_swap_b32 v45, v47
    s_nop 1
    buffer_store_dwordx4 v[40:43], v4, s[40:43], 0 offen offset:128 sc1
    buffer_store_dwordx4 v[44:47], v4, s[40:43], 0 offen offset:160 sc1
    v_cvt_pk_bf16_f32 v24, v168, v169
    v_cvt_pk_bf16_f32 v25, v170, v171
    v_cvt_pk_bf16_f32 v26, v172, v173
    v_cvt_pk_bf16_f32 v27, v174, v175
    v_cvt_pk_bf16_f32 v28, v176, v177
    v_cvt_pk_bf16_f32 v29, v178, v179
    v_cvt_pk_bf16_f32 v30, v180, v181
    v_cvt_pk_bf16_f32 v31, v182, v183
    s_nop 1
    v_permlane32_swap_b32 v24, v26
    v_permlane32_swap_b32 v25, v27
    v_permlane32_swap_b32 v28, v30
    v_permlane32_swap_b32 v29, v31
    s_nop 1
    buffer_store_dwordx4 v[24:27], v4, s[40:43], 0 offen offset:192 sc1
    buffer_store_dwordx4 v[28:31], v4, s[40:43], 0 offen offset:224 sc1
    v_add_u32 v4, 122880, v4
    v_cvt_pk_bf16_f32 v32, v88, v89
    v_cvt_pk_bf16_f32 v33, v90, v91
    v_cvt_pk_bf16_f32 v34, v92, v93
    v_cvt_pk_bf16_f32 v35, v94, v95
    v_cvt_pk_bf16_f32 v36, v96, v97
    v_cvt_pk_bf16_f32 v37, v98, v99
    v_cvt_pk_bf16_f32 v38, v100, v101
    v_cvt_pk_bf16_f32 v39, v102, v103
    s_nop 1
    v_permlane32_swap_b32 v32, v34
    v_permlane32_swap_b32 v33, v35
    v_permlane32_swap_b32 v36, v38
    v_permlane32_swap_b32 v37, v39
    s_nop 1
    buffer_store_dwordx4 v[32:35], v4, s[40:43], 0 offen offset:0 sc1
    buffer_store_dwordx4 v[36:39], v4, s[40:43], 0 offen offset:32 sc1
    v_cvt_pk_bf16_f32 v40, v120, v121
    v_cvt_pk_bf16_f32 v41, v122, v123
    v_cvt_pk_bf16_f32 v42, v124, v125
    v_cvt_pk_bf16_f32 v43, v126, v127
    v_cvt_pk_bf16_f32 v44, v128, v129
    v_cvt_pk_bf16_f32 v45, v130, v131
    v_cvt_pk_bf16_f32 v46, v132, v133
    v_cvt_pk_bf16_f32 v47, v134, v135
    s_nop 1
    v_permlane32_swap_b32 v40, v42
    v_permlane32_swap_b32 v41, v43
    v_permlane32_swap_b32 v44, v46
    v_permlane32_swap_b32 v45, v47
    s_nop 1
    buffer_store_dwordx4 v[40:43], v4, s[40:43], 0 offen offset:64 sc1
    buffer_store_dwordx4 v[44:47], v4, s[40:43], 0 offen offset:96 sc1
    v_cvt_pk_bf16_f32 v24, v152, v153
    v_cvt_pk_bf16_f32 v25, v154, v155
    v_cvt_pk_bf16_f32 v26, v156, v157
    v_cvt_pk_bf16_f32 v27, v158, v159
    v_cvt_pk_bf16_f32 v28, v160, v161
    v_cvt_pk_bf16_f32 v29, v162, v163
    v_cvt_pk_bf16_f32 v30, v164, v165
    v_cvt_pk_bf16_f32 v31, v166, v167
    s_nop 1
    v_permlane32_swap_b32 v24, v26
    v_permlane32_swap_b32 v25, v27
    v_permlane32_swap_b32 v28, v30
    v_permlane32_swap_b32 v29, v31
    s_nop 1
    buffer_store_dwordx4 v[24:27], v4, s[40:43], 0 offen offset:128 sc1
    buffer_store_dwordx4 v[28:31], v4, s[40:43], 0 offen offset:160 sc1
    v_cvt_pk_bf16_f32 v32, v184, v185
    v_cvt_pk_bf16_f32 v33, v186, v187
    v_cvt_pk_bf16_f32 v34, v188, v189
    v_cvt_pk_bf16_f32 v35, v190, v191
    v_cvt_pk_bf16_f32 v36, v192, v193
    v_cvt_pk_bf16_f32 v37, v194, v195
    v_cvt_pk_bf16_f32 v38, v196, v197
    v_cvt_pk_bf16_f32 v39, v198, v199
    s_nop 1
    v_permlane32_swap_b32 v32, v34
    v_permlane32_swap_b32 v33, v35
    v_permlane32_swap_b32 v36, v38
    v_permlane32_swap_b32 v37, v39
    s_nop 1
    buffer_store_dwordx4 v[32:35], v4, s[40:43], 0 offen offset:192 sc1
    buffer_store_dwordx4 v[36:39], v4, s[40:43], 0 offen offset:224 sc1
    s_branch .k2_wloop
.k2w_end:
    s_branch .k2_wloop
.k2_claim:
    s_waitcnt vmcnt(0) lgkmcnt(0)
    s_barrier
    s_cmp_lg_u32 s96, 0
    s_cbranch_scc1 .at_4
    s_mov_b64 exec, 1

    v_mov_b32 v1, 1
    v_mov_b32 v2, 0
    buffer_atomic_add v1, v2, s[92:95], 0 offen sc0
    s_waitcnt vmcnt(0)
    v_mov_b32 v2, 122880
    ds_write_b32 v2, v1
    s_mov_b64 exec, -1

.at_4:
    s_waitcnt lgkmcnt(0)
    s_barrier
    v_mov_b32 v2, 122880
    ds_read_b32 v1, v2
    s_waitcnt lgkmcnt(0)
    v_readfirstlane_b32 s4, v1
    s_mov_b32 s90, 0

    s_mov_b32 s99, s4
    s_mov_b32 s98, 0x10001
    s_cmp_lt_u32 s4, 32
    s_cbranch_scc1 .k2_chain

    s_waitcnt vmcnt(0) lgkmcnt(0)
    s_barrier
    s_cmp_lg_u32 s96, 0
    s_cbranch_scc1 .at_5
    s_mov_b64 exec, 1

    v_mov_b32 v1, 1
    v_mov_b32 v2, 64
    buffer_atomic_add v1, v2, s[92:95], 0 offen sc0
    s_waitcnt vmcnt(0)
    v_mov_b32 v2, 122880
    ds_write_b32 v2, v1
    s_mov_b64 exec, -1

.at_5:
    s_waitcnt lgkmcnt(0)
    s_barrier
    v_mov_b32 v2, 122880
    ds_read_b32 v1, v2
    s_waitcnt lgkmcnt(0)
    v_readfirstlane_b32 s4, v1
    s_mov_b32 s90, 0

    s_add_u32 s99, s4, 32
    s_mov_b32 s98, 0x10001
    s_cmp_lt_u32 s4, 32
    s_cbranch_scc1 .k2_chain

.k2_wloop2:
    s_waitcnt vmcnt(0) lgkmcnt(0)
    s_barrier
    s_cmp_lg_u32 s96, 0
    s_cbranch_scc1 .at_6
    s_mov_b64 exec, 1

    s_cmp_eq_u32 s90, 0
    s_cbranch_scc1 .at_7
    v_mov_b32 v3, 1
    v_mov_b32 v4, s90
    buffer_atomic_add v3, v4, s[84:87], 0 offen sc1

.at_7:
    v_mov_b32 v1, 1
    v_mov_b32 v2, 196
    buffer_atomic_add v1, v2, s[92:95], 0 offen sc0
    s_waitcnt vmcnt(0)
    v_mov_b32 v2, 122880
    ds_write_b32 v2, v1
    s_mov_b64 exec, -1

.at_6:
    s_waitcnt lgkmcnt(0)
    s_barrier
    v_mov_b32 v2, 122880
    ds_read_b32 v1, v2
    s_waitcnt lgkmcnt(0)
    v_readfirstlane_b32 s4, v1
    s_mov_b32 s90, 0

    s_mov_b32 s2, s4
    s_cmp_lt_u32 s4, 80
    s_cbranch_scc1 .k2_rp
    s_sub_u32 s4, s4, 80
    s_cmp_ge_u32 s4, 256
    s_cbranch_scc1 .k2_p2b
    s_add_u32 s2, s4, 512

    v_mov_b32 v2, 136186880
    s_mov_b32 s89, 0

.wc_8:
    buffer_load_dword v1, v2, s[84:87], 0 offen sc1
    s_waitcnt vmcnt(0)
    v_readfirstlane_b32 s88, v1
    s_cmp_ge_u32 s88, 130
    s_cbranch_scc1 .wc_9
    s_sleep 16
    s_add_u32 s89, s89, 1
    s_cmp_lt_u32 s89, 1048576
    s_cbranch_scc1 .wc_8
    s_endpgm

.wc_9:
    s_mov_b32 s90, 136187008
    s_branch .k2_att

.k2_p2b:
    s_cmp_ge_u32 s4, 416
    s_cbranch_scc1 .k2_p2c
    s_sub_u32 s2, s4, 96

    v_mov_b32 v2, 136187008
    s_mov_b32 s89, 0

.wc_10:
    buffer_load_dword v1, v2, s[84:87], 0 offen sc1
    s_waitcnt vmcnt(0)
    v_readfirstlane_b32 s88, v1
    s_cmp_ge_u32 s88, 258
    s_cbranch_scc1 .wc_11
    s_sleep 16
    s_add_u32 s89, s89, 1
    s_cmp_lt_u32 s89, 1048576
    s_cbranch_scc1 .wc_10
    s_endpgm

.wc_11:
    s_branch .k2_op
.k2_p2c:
    s_sub_u32 s5, s4, 416
    s_cmp_ge_u32 s5, 546
    s_cbranch_scc1 .k2_wexit

    s_mul_i32 s6, s5, 3121
    s_lshr_b32 s6, s6, 16
    s_mul_i32 s7, s6, 21
    s_sub_u32 s7, s5, s7
    s_lshl_b32 s5, s6, 7
    s_cmp_ge_u32 s7, 16
    s_cbranch_scc1 .k2_p2d
    s_lshl_b32 s2, s6, 4
    s_add_u32 s2, s2, s7
    s_lshr_b32 s7, s6, 1
    s_lshl_b32 s7, s7, 7
    s_add_u32 s7, s7, 136184832

    v_mov_b32 v2, s7
    s_mov_b32 s89, 0

.wc_12:
    buffer_load_dword v1, v2, s[84:87], 0 offen sc1
    s_waitcnt vmcnt(0)
    v_readfirstlane_b32 s88, v1
    s_cmp_ge_u32 s88, 18
    s_cbranch_scc1 .wc_13
    s_sleep 16
    s_add_u32 s89, s89, 1
    s_cmp_lt_u32 s89, 1048576
    s_cbranch_scc1 .wc_12
    s_endpgm

.wc_13:
    s_add_u32 s7, s5, 136187904
    v_mov_b32 v2, s7
    s_mov_b32 s89, 0

.wc_14:
    buffer_load_dword v1, v2, s[84:87], 0 offen sc1
    s_waitcnt vmcnt(0)
    v_readfirstlane_b32 s88, v1
    s_cmp_ge_u32 s88, 66
    s_cbranch_scc1 .wc_15
    s_sleep 16
    s_add_u32 s89, s89, 1
    s_cmp_lt_u32 s89, 1048576
    s_cbranch_scc1 .wc_14
    s_endpgm

.wc_15:
    s_add_u32 s90, s5, 136192000
    s_branch .k2_att

.k2_p2d:
    s_sub_u32 s7, s7, 16
    s_lshl_b32 s7, s7, 2
    s_and_b32 s2, s6, 3
    s_add_u32 s7, s7, s2
    s_lshl_b32 s7, s7, 3
    s_lshr_b32 s2, s6, 2
    s_add_u32 s2, s2, s7
    s_add_u32 s7, s5, 136192000

    v_mov_b32 v2, s7
    s_mov_b32 s89, 0

.wc_16:
    buffer_load_dword v1, v2, s[84:87], 0 offen sc1
    s_waitcnt vmcnt(0)
    v_readfirstlane_b32 s88, v1
    s_cmp_ge_u32 s88, 18
    s_cbranch_scc1 .wc_17
    s_sleep 16
    s_add_u32 s89, s89, 1
    s_cmp_lt_u32 s89, 1048576
    s_cbranch_scc1 .wc_16
    s_endpgm

.wc_17:
.k2_op:
    s_cmp_ge_u32 s2, 320
    s_cbranch_scc1 .k2_exit
    v_lshrrev_b32 v1, 6, v0
    s_sub_u32 s5, s2, 0
    s_and_b32 s4, s5, 7
    v_readfirstlane_b32 s3, v1
    s_lshr_b32 s5, s5, 3
    v_and_b32 v1, 63, v0
    s_lshl_b32 s50, s3, 10

    s_cmp_ge_u32 s5, 20
    s_cbranch_scc1 .k2o_j1
    s_sub_u32 s7, s5, 0
    s_load_dwordx2 s[8:9], s[0:1], 96
    s_load_dwordx2 s[10:11], s[0:1], 96
    s_load_dwordx2 s[12:13], s[0:1], 80
    s_lshr_b32 s20, s7, 2
    s_mul_i32 s21, s20, 4
    s_sub_u32 s21, s7, s21
    s_mul_i32 s6, s4, 4
    s_add_u32 s21, s21, s6
    v_lshrrev_b32 v2, 2, v1
    v_lshrrev_b32 v3, 4, v1
    v_xor_b32 v3, v3, v1
    v_and_b32 v3, 3, v3
    v_lshlrev_b32 v3, 4, v3
    s_lshl_b32 s6, s3, 4
    s_mul_i32 s22, s20, 128
    s_add_u32 s22, s22, s6
    s_mul_i32 s23, s21, 64
    s_add_u32 s23, s23, s6
    s_mov_b32 s24, 8192
    s_mov_b32 s25, 8192

    v_add_u32 v4, s22, v2
    v_mul_lo_u32 v4, v4, s24
    v_add_u32 v4, v4, v3
    v_add_u32 v4, 16777216, v4
    v_add_u32 v5, s22, v2
    v_add_u32 v5, 64, v5
    v_mul_lo_u32 v5, v5, s24
    v_add_u32 v5, v5, v3
    v_add_u32 v5, 16777216, v5
    v_add_u32 v6, s23, v2
    v_mul_lo_u32 v6, v6, s25
    v_add_u32 v6, v6, v3
    v_add_u32 v6, 100663296, v6
    s_waitcnt lgkmcnt(0)
    s_mov_b32 s32, s8
    s_mov_b32 s33, s9
    s_mov_b32 s34, 268435456
    s_mov_b32 s35, 0x00020000
    s_mov_b32 s36, s10
    s_mov_b32 s37, s11
    s_mov_b32 s38, 268435456
    s_mov_b32 s39, 0x00020000
    s_mov_b32 s40, s12
    s_mov_b32 s41, s13
    s_mov_b32 s42, 5242880
    s_mov_b32 s43, 0x00020000
    s_mov_b32 s48, 0
    s_add_u32 m0, s50, 0
    s_nop 0
    buffer_load_dwordx4 v4, s[32:35], s48 offen lds
    s_add_u32 m0, s50, 4096
    s_nop 0
    buffer_load_dwordx4 v5, s[32:35], s48 offen lds
    s_add_u32 m0, s50, 8192
    s_nop 0
    buffer_load_dwordx4 v6, s[36:39], s48 offen lds
    s_add_u32 s48, s48, 64
    s_add_u32 m0, s50, 12288
    s_nop 0
    buffer_load_dwordx4 v4, s[32:35], s48 offen lds
    s_add_u32 m0, s50, 16384
    s_nop 0
    buffer_load_dwordx4 v5, s[32:35], s48 offen lds
    s_add_u32 m0, s50, 20480
    s_nop 0
    buffer_load_dwordx4 v6, s[36:39], s48 offen lds
    s_add_u32 s48, s48, 64
    s_add_u32 m0, s50, 24576
    s_nop 0
    buffer_load_dwordx4 v4, s[32:35], s48 offen lds
    s_add_u32 m0, s50, 28672
    s_nop 0
    buffer_load_dwordx4 v5, s[32:35], s48 offen lds
    s_add_u32 m0, s50, 32768
    s_nop 0
    buffer_load_dwordx4 v6, s[36:39], s48 offen lds
    s_add_u32 s48, s48, 64
    s_add_u32 m0, s50, 36864
    s_nop 0
    buffer_load_dwordx4 v4, s[32:35], s48 offen lds
    s_add_u32 m0, s50, 40960
    s_nop 0
    buffer_load_dwordx4 v5, s[32:35], s48 offen lds
    s_add_u32 m0, s50, 45056
    s_nop 0
    buffer_load_dwordx4 v6, s[36:39], s48 offen lds
    s_add_u32 s48, s48, 64
    s_add_u32 m0, s50, 49152
    s_nop 0
    buffer_load_dwordx4 v4, s[32:35], s48 offen lds
    s_add_u32 m0, s50, 53248
    s_nop 0
    buffer_load_dwordx4 v5, s[32:35], s48 offen lds
    s_add_u32 m0, s50, 57344
    s_nop 0
    buffer_load_dwordx4 v6, s[36:39], s48 offen lds
    s_add_u32 s48, s48, 64
    s_add_u32 m0, s50, 61440
    s_nop 0
    buffer_load_dwordx4 v4, s[32:35], s48 offen lds
    s_add_u32 m0, s50, 65536
    s_nop 0
    buffer_load_dwordx4 v5, s[32:35], s48 offen lds
    s_add_u32 m0, s50, 69632
    s_nop 0
    buffer_load_dwordx4 v6, s[36:39], s48 offen lds
    s_add_u32 s48, s48, 64
    s_add_u32 m0, s50, 73728
    s_nop 0
    buffer_load_dwordx4 v4, s[32:35], s48 offen lds
    s_add_u32 m0, s50, 77824
    s_nop 0
    buffer_load_dwordx4 v5, s[32:35], s48 offen lds
    s_add_u32 m0, s50, 81920
    s_nop 0
    buffer_load_dwordx4 v6, s[36:39], s48 offen lds
    s_add_u32 s48, s48, 64
    s_add_u32 m0, s50, 86016
    s_nop 0
    buffer_load_dwordx4 v4, s[32:35], s48 offen lds
    s_add_u32 m0, s50, 90112
    s_nop 0
    buffer_load_dwordx4 v5, s[32:35], s48 offen lds
    s_add_u32 m0, s50, 94208
    s_nop 0
    buffer_load_dwordx4 v6, s[36:39], s48 offen lds
    s_add_u32 s48, s48, 64
    s_and_b32 s44, s3, 1
    s_lshr_b32 s45, s3, 1
    s_mul_i32 s44, s44, 64
    s_mul_i32 s45, s45, 32
    v_and_b32 v2, 31, v1
    v_lshrrev_b32 v3, 5, v1
    v_lshrrev_b32 v16, 2, v1
    v_xor_b32 v16, v16, v3
    v_and_b32 v16, 3, v16
    v_lshlrev_b32 v16, 4, v16
    v_add_u32 v7, s44, v2
    v_lshlrev_b32 v7, 6, v7
    v_add_u32 v7, v7, v16
    v_xor_b32 v8, 32, v7
    v_add_u32 v9, s45, v2
    v_lshlrev_b32 v9, 6, v9
    v_add_u32 v9, v9, v16
    v_add_u32 v9, 8192, v9
    v_xor_b32 v10, 32, v9

    v_add_u32 v11, 61440, v7
    v_add_u32 v12, 61440, v8
    v_add_u32 v13, 61440, v9
    v_add_u32 v14, 61440, v10
    v_mov_b32 v40, 0
    v_mov_b32 v41, 0
    v_mov_b32 v42, 0
    v_mov_b32 v43, 0
    v_mov_b32 v44, 0
    v_mov_b32 v45, 0
    v_mov_b32 v46, 0
    v_mov_b32 v47, 0
    v_mov_b32 v48, 0
    v_mov_b32 v49, 0
    v_mov_b32 v50, 0
    v_mov_b32 v51, 0
    v_mov_b32 v52, 0
    v_mov_b32 v53, 0
    v_mov_b32 v54, 0
    v_mov_b32 v55, 0
    v_mov_b32 v56, 0
    v_mov_b32 v57, 0
    v_mov_b32 v58, 0
    v_mov_b32 v59, 0
    v_mov_b32 v60, 0
    v_mov_b32 v61, 0
    v_mov_b32 v62, 0
    v_mov_b32 v63, 0
    v_mov_b32 v64, 0
    v_mov_b32 v65, 0
    v_mov_b32 v66, 0
    v_mov_b32 v67, 0
    v_mov_b32 v68, 0
    v_mov_b32 v69, 0
    v_mov_b32 v70, 0
    v_mov_b32 v71, 0
    s_waitcnt vmcnt(21)
    s_barrier
    ds_read_b128 v[16:19], v7 offset:0
    ds_read_b128 v[20:23], v7 offset:2048
    ds_read_b128 v[24:27], v9 offset:0
    s_mov_b32 s49, 15
.k2o_b0_loop:
    s_waitcnt lgkmcnt(0)
    v_mfma_f32_32x32x16_bf16 v[40:55], v[16:19], v[24:27], v[40:55]
    ds_read_b128 v[28:31], v8 offset:0
    ds_read_b128 v[32:35], v8 offset:2048
    v_mfma_f32_32x32x16_bf16 v[56:71], v[20:23], v[24:27], v[56:71]
    ds_read_b128 v[36:39], v10 offset:0
    s_waitcnt vmcnt(18) lgkmcnt(0)
    s_barrier
    v_mfma_f32_32x32x16_bf16 v[40:55], v[28:31], v[36:39], v[40:55]
    ds_read_b128 v[16:19], v7 offset:12288
    ds_read_b128 v[20:23], v7 offset:14336
    ds_read_b128 v[24:27], v9 offset:12288
    v_mfma_f32_32x32x16_bf16 v[56:71], v[32:35], v[36:39], v[56:71]
    s_add_u32 m0, s50, 0
    s_nop 0
    buffer_load_dwordx4 v4, s[32:35], s48 offen lds
    s_add_u32 m0, s50, 4096
    s_nop 0
    buffer_load_dwordx4 v5, s[32:35], s48 offen lds
    s_add_u32 m0, s50, 8192
    s_nop 0
    buffer_load_dwordx4 v6, s[36:39], s48 offen lds
    s_add_u32 s48, s48, 64
    s_waitcnt lgkmcnt(0)
    v_mfma_f32_32x32x16_bf16 v[40:55], v[16:19], v[24:27], v[40:55]
    ds_read_b128 v[28:31], v8 offset:12288
    ds_read_b128 v[32:35], v8 offset:14336
    v_mfma_f32_32x32x16_bf16 v[56:71], v[20:23], v[24:27], v[56:71]
    ds_read_b128 v[36:39], v10 offset:12288
    s_waitcnt vmcnt(18) lgkmcnt(0)
    s_barrier
    v_mfma_f32_32x32x16_bf16 v[40:55], v[28:31], v[36:39], v[40:55]
    ds_read_b128 v[16:19], v7 offset:24576
    ds_read_b128 v[20:23], v7 offset:26624
    ds_read_b128 v[24:27], v9 offset:24576
    v_mfma_f32_32x32x16_bf16 v[56:71], v[32:35], v[36:39], v[56:71]
    s_add_u32 m0, s50, 12288
    s_nop 0
    buffer_load_dwordx4 v4, s[32:35], s48 offen lds
    s_add_u32 m0, s50, 16384
    s_nop 0
    buffer_load_dwordx4 v5, s[32:35], s48 offen lds
    s_add_u32 m0, s50, 20480
    s_nop 0
    buffer_load_dwordx4 v6, s[36:39], s48 offen lds
    s_add_u32 s48, s48, 64
    s_waitcnt lgkmcnt(0)
    v_mfma_f32_32x32x16_bf16 v[40:55], v[16:19], v[24:27], v[40:55]
    ds_read_b128 v[28:31], v8 offset:24576
    ds_read_b128 v[32:35], v8 offset:26624
    v_mfma_f32_32x32x16_bf16 v[56:71], v[20:23], v[24:27], v[56:71]
    ds_read_b128 v[36:39], v10 offset:24576
    s_waitcnt vmcnt(18) lgkmcnt(0)
    s_barrier
    v_mfma_f32_32x32x16_bf16 v[40:55], v[28:31], v[36:39], v[40:55]
    ds_read_b128 v[16:19], v7 offset:36864
    ds_read_b128 v[20:23], v7 offset:38912
    ds_read_b128 v[24:27], v9 offset:36864
    v_mfma_f32_32x32x16_bf16 v[56:71], v[32:35], v[36:39], v[56:71]
    s_add_u32 m0, s50, 24576
    s_nop 0
    buffer_load_dwordx4 v4, s[32:35], s48 offen lds
    s_add_u32 m0, s50, 28672
    s_nop 0
    buffer_load_dwordx4 v5, s[32:35], s48 offen lds
    s_add_u32 m0, s50, 32768
    s_nop 0
    buffer_load_dwordx4 v6, s[36:39], s48 offen lds
    s_add_u32 s48, s48, 64
    s_waitcnt lgkmcnt(0)
    v_mfma_f32_32x32x16_bf16 v[40:55], v[16:19], v[24:27], v[40:55]
    ds_read_b128 v[28:31], v8 offset:36864
    ds_read_b128 v[32:35], v8 offset:38912
    v_mfma_f32_32x32x16_bf16 v[56:71], v[20:23], v[24:27], v[56:71]
    ds_read_b128 v[36:39], v10 offset:36864
    s_waitcnt vmcnt(18) lgkmcnt(0)
    s_barrier
    v_mfma_f32_32x32x16_bf16 v[40:55], v[28:31], v[36:39], v[40:55]
    ds_read_b128 v[16:19], v7 offset:49152
    ds_read_b128 v[20:23], v7 offset:51200
    ds_read_b128 v[24:27], v9 offset:49152
    v_mfma_f32_32x32x16_bf16 v[56:71], v[32:35], v[36:39], v[56:71]
    s_add_u32 m0, s50, 36864
    s_nop 0
    buffer_load_dwordx4 v4, s[32:35], s48 offen lds
    s_add_u32 m0, s50, 40960
    s_nop 0
    buffer_load_dwordx4 v5, s[32:35], s48 offen lds
    s_add_u32 m0, s50, 45056
    s_nop 0
    buffer_load_dwordx4 v6, s[36:39], s48 offen lds
    s_add_u32 s48, s48, 64
    s_waitcnt lgkmcnt(0)
    v_mfma_f32_32x32x16_bf16 v[40:55], v[16:19], v[24:27], v[40:55]
    ds_read_b128 v[28:31], v8 offset:49152
    ds_read_b128 v[32:35], v8 offset:51200
    v_mfma_f32_32x32x16_bf16 v[56:71], v[20:23], v[24:27], v[56:71]
    ds_read_b128 v[36:39], v10 offset:49152
    s_waitcnt vmcnt(18) lgkmcnt(0)
    s_barrier
    v_mfma_f32_32x32x16_bf16 v[40:55], v[28:31], v[36:39], v[40:55]
    ds_read_b128 v[16:19], v11 offset:0
    ds_read_b128 v[20:23], v11 offset:2048
    ds_read_b128 v[24:27], v13 offset:0
    v_mfma_f32_32x32x16_bf16 v[56:71], v[32:35], v[36:39], v[56:71]
    s_add_u32 m0, s50, 49152
    s_nop 0
    buffer_load_dwordx4 v4, s[32:35], s48 offen lds
    s_add_u32 m0, s50, 53248
    s_nop 0
    buffer_load_dwordx4 v5, s[32:35], s48 offen lds
    s_add_u32 m0, s50, 57344
    s_nop 0
    buffer_load_dwordx4 v6, s[36:39], s48 offen lds
    s_add_u32 s48, s48, 64
    s_waitcnt lgkmcnt(0)
    v_mfma_f32_32x32x16_bf16 v[40:55], v[16:19], v[24:27], v[40:55]
    ds_read_b128 v[28:31], v12 offset:0
    ds_read_b128 v[32:35], v12 offset:2048
    v_mfma_f32_32x32x16_bf16 v[56:71], v[20:23], v[24:27], v[56:71]
    ds_read_b128 v[36:39], v14 offset:0
    s_waitcnt vmcnt(18) lgkmcnt(0)
    s_barrier
    v_mfma_f32_32x32x16_bf16 v[40:55], v[28:31], v[36:39], v[40:55]
    ds_read_b128 v[16:19], v11 offset:12288
    ds_read_b128 v[20:23], v11 offset:14336
    ds_read_b128 v[24:27], v13 offset:12288
    v_mfma_f32_32x32x16_bf16 v[56:71], v[32:35], v[36:39], v[56:71]
    s_add_u32 m0, s50, 61440
    s_nop 0
    buffer_load_dwordx4 v4, s[32:35], s48 offen lds
    s_add_u32 m0, s50, 65536
    s_nop 0
    buffer_load_dwordx4 v5, s[32:35], s48 offen lds
    s_add_u32 m0, s50, 69632
    s_nop 0
    buffer_load_dwordx4 v6, s[36:39], s48 offen lds
    s_add_u32 s48, s48, 64
    s_waitcnt lgkmcnt(0)
    v_mfma_f32_32x32x16_bf16 v[40:55], v[16:19], v[24:27], v[40:55]
    ds_read_b128 v[28:31], v12 offset:12288
    ds_read_b128 v[32:35], v12 offset:14336
    v_mfma_f32_32x32x16_bf16 v[56:71], v[20:23], v[24:27], v[56:71]
    ds_read_b128 v[36:39], v14 offset:12288
    s_waitcnt vmcnt(18) lgkmcnt(0)
    s_barrier
    v_mfma_f32_32x32x16_bf16 v[40:55], v[28:31], v[36:39], v[40:55]
    ds_read_b128 v[16:19], v11 offset:24576
    ds_read_b128 v[20:23], v11 offset:26624
    ds_read_b128 v[24:27], v13 offset:24576
    v_mfma_f32_32x32x16_bf16 v[56:71], v[32:35], v[36:39], v[56:71]
    s_add_u32 m0, s50, 73728
    s_nop 0
    buffer_load_dwordx4 v4, s[32:35], s48 offen lds
    s_add_u32 m0, s50, 77824
    s_nop 0
    buffer_load_dwordx4 v5, s[32:35], s48 offen lds
    s_add_u32 m0, s50, 81920
    s_nop 0
    buffer_load_dwordx4 v6, s[36:39], s48 offen lds
    s_add_u32 s48, s48, 64
    s_waitcnt lgkmcnt(0)
    v_mfma_f32_32x32x16_bf16 v[40:55], v[16:19], v[24:27], v[40:55]
    ds_read_b128 v[28:31], v12 offset:24576
    ds_read_b128 v[32:35], v12 offset:26624
    v_mfma_f32_32x32x16_bf16 v[56:71], v[20:23], v[24:27], v[56:71]
    ds_read_b128 v[36:39], v14 offset:24576
    s_waitcnt vmcnt(18) lgkmcnt(0)
    s_barrier
    v_mfma_f32_32x32x16_bf16 v[40:55], v[28:31], v[36:39], v[40:55]
    ds_read_b128 v[16:19], v7 offset:0
    ds_read_b128 v[20:23], v7 offset:2048
    ds_read_b128 v[24:27], v9 offset:0
    v_mfma_f32_32x32x16_bf16 v[56:71], v[32:35], v[36:39], v[56:71]
    s_add_u32 m0, s50, 86016
    s_nop 0
    buffer_load_dwordx4 v4, s[32:35], s48 offen lds
    s_add_u32 m0, s50, 90112
    s_nop 0
    buffer_load_dwordx4 v5, s[32:35], s48 offen lds
    s_add_u32 m0, s50, 94208
    s_nop 0
    buffer_load_dwordx4 v6, s[36:39], s48 offen lds
    s_add_u32 s48, s48, 64
    s_sub_u32 s49, s49, 1
    s_cmp_lg_u32 s49, 0
    s_cbranch_scc1 .k2o_b0_loop
    s_waitcnt lgkmcnt(0)
    v_mfma_f32_32x32x16_bf16 v[40:55], v[16:19], v[24:27], v[40:55]
    ds_read_b128 v[28:31], v8 offset:0
    ds_read_b128 v[32:35], v8 offset:2048
    v_mfma_f32_32x32x16_bf16 v[56:71], v[20:23], v[24:27], v[56:71]
    ds_read_b128 v[36:39], v10 offset:0
    s_waitcnt vmcnt(18) lgkmcnt(0)
    s_barrier
    v_mfma_f32_32x32x16_bf16 v[40:55], v[28:31], v[36:39], v[40:55]
    ds_read_b128 v[16:19], v7 offset:12288
    ds_read_b128 v[20:23], v7 offset:14336
    v_mfma_f32_32x32x16_bf16 v[56:71], v[32:35], v[36:39], v[56:71]
    ds_read_b128 v[24:27], v9 offset:12288
    s_waitcnt lgkmcnt(0)
    v_mfma_f32_32x32x16_bf16 v[40:55], v[16:19], v[24:27], v[40:55]
    ds_read_b128 v[28:31], v8 offset:12288
    ds_read_b128 v[32:35], v8 offset:14336
    v_mfma_f32_32x32x16_bf16 v[56:71], v[20:23], v[24:27], v[56:71]
    ds_read_b128 v[36:39], v10 offset:12288
    s_waitcnt vmcnt(15) lgkmcnt(0)
    s_barrier
    v_mfma_f32_32x32x16_bf16 v[40:55], v[28:31], v[36:39], v[40:55]
    ds_read_b128 v[16:19], v7 offset:24576
    ds_read_b128 v[20:23], v7 offset:26624
    v_mfma_f32_32x32x16_bf16 v[56:71], v[32:35], v[36:39], v[56:71]
    ds_read_b128 v[24:27], v9 offset:24576
    s_waitcnt lgkmcnt(0)
    v_mfma_f32_32x32x16_bf16 v[40:55], v[16:19], v[24:27], v[40:55]
    ds_read_b128 v[28:31], v8 offset:24576
    ds_read_b128 v[32:35], v8 offset:26624
    v_mfma_f32_32x32x16_bf16 v[56:71], v[20:23], v[24:27], v[56:71]
    ds_read_b128 v[36:39], v10 offset:24576
    s_waitcnt vmcnt(12) lgkmcnt(0)
    s_barrier
    v_mfma_f32_32x32x16_bf16 v[40:55], v[28:31], v[36:39], v[40:55]
    ds_read_b128 v[16:19], v7 offset:36864
    ds_read_b128 v[20:23], v7 offset:38912
    v_mfma_f32_32x32x16_bf16 v[56:71], v[32:35], v[36:39], v[56:71]
    ds_read_b128 v[24:27], v9 offset:36864
    s_waitcnt lgkmcnt(0)
    v_mfma_f32_32x32x16_bf16 v[40:55], v[16:19], v[24:27], v[40:55]
    ds_read_b128 v[28:31], v8 offset:36864
    ds_read_b128 v[32:35], v8 offset:38912
    v_mfma_f32_32x32x16_bf16 v[56:71], v[20:23], v[24:27], v[56:71]
    ds_read_b128 v[36:39], v10 offset:36864
    s_waitcnt vmcnt(9) lgkmcnt(0)
    s_barrier
    v_mfma_f32_32x32x16_bf16 v[40:55], v[28:31], v[36:39], v[40:55]
    ds_read_b128 v[16:19], v7 offset:49152
    ds_read_b128 v[20:23], v7 offset:51200
    v_mfma_f32_32x32x16_bf16 v[56:71], v[32:35], v[36:39], v[56:71]
    ds_read_b128 v[24:27], v9 offset:49152
    s_waitcnt lgkmcnt(0)
    v_mfma_f32_32x32x16_bf16 v[40:55], v[16:19], v[24:27], v[40:55]
    ds_read_b128 v[28:31], v8 offset:49152
    ds_read_b128 v[32:35], v8 offset:51200
    v_mfma_f32_32x32x16_bf16 v[56:71], v[20:23], v[24:27], v[56:71]
    ds_read_b128 v[36:39], v10 offset:49152
    s_waitcnt vmcnt(6) lgkmcnt(0)
    s_barrier
    v_mfma_f32_32x32x16_bf16 v[40:55], v[28:31], v[36:39], v[40:55]
    ds_read_b128 v[16:19], v11 offset:0
    ds_read_b128 v[20:23], v11 offset:2048
    v_mfma_f32_32x32x16_bf16 v[56:71], v[32:35], v[36:39], v[56:71]
    ds_read_b128 v[24:27], v13 offset:0
    s_waitcnt lgkmcnt(0)
    v_mfma_f32_32x32x16_bf16 v[40:55], v[16:19], v[24:27], v[40:55]
    ds_read_b128 v[28:31], v12 offset:0
    ds_read_b128 v[32:35], v12 offset:2048
    v_mfma_f32_32x32x16_bf16 v[56:71], v[20:23], v[24:27], v[56:71]
    ds_read_b128 v[36:39], v14 offset:0
    s_waitcnt vmcnt(3) lgkmcnt(0)
    s_barrier
    v_mfma_f32_32x32x16_bf16 v[40:55], v[28:31], v[36:39], v[40:55]
    ds_read_b128 v[16:19], v11 offset:12288
    ds_read_b128 v[20:23], v11 offset:14336
    v_mfma_f32_32x32x16_bf16 v[56:71], v[32:35], v[36:39], v[56:71]
    ds_read_b128 v[24:27], v13 offset:12288
    s_waitcnt lgkmcnt(0)
    v_mfma_f32_32x32x16_bf16 v[40:55], v[16:19], v[24:27], v[40:55]
    ds_read_b128 v[28:31], v12 offset:12288
    ds_read_b128 v[32:35], v12 offset:14336
    v_mfma_f32_32x32x16_bf16 v[56:71], v[20:23], v[24:27], v[56:71]
    ds_read_b128 v[36:39], v14 offset:12288
    s_waitcnt vmcnt(0) lgkmcnt(0)
    s_barrier
    v_mfma_f32_32x32x16_bf16 v[40:55], v[28:31], v[36:39], v[40:55]
    ds_read_b128 v[16:19], v11 offset:24576
    ds_read_b128 v[20:23], v11 offset:26624
    v_mfma_f32_32x32x16_bf16 v[56:71], v[32:35], v[36:39], v[56:71]
    ds_read_b128 v[24:27], v13 offset:24576
    s_waitcnt lgkmcnt(0)
    v_mfma_f32_32x32x16_bf16 v[40:55], v[16:19], v[24:27], v[40:55]
    ds_read_b128 v[28:31], v12 offset:24576
    ds_read_b128 v[32:35], v12 offset:26624
    v_mfma_f32_32x32x16_bf16 v[56:71], v[20:23], v[24:27], v[56:71]
    ds_read_b128 v[36:39], v14 offset:24576
    s_waitcnt lgkmcnt(0)
    v_mfma_f32_32x32x16_bf16 v[40:55], v[28:31], v[36:39], v[40:55]
    v_mfma_f32_32x32x16_bf16 v[56:71], v[32:35], v[36:39], v[56:71]
    s_mul_i32 s46, s20, 128
    s_add_u32 s46, s46, s44
    s_mul_i32 s47, s21, 64
    s_add_u32 s47, s47, s45
    s_mov_b32 s24, 2560
    v_add_u32 v4, s47, v2
    v_mul_lo_u32 v4, v4, s24
    v_lshlrev_b32 v5, 4, v3
    v_add_u32 v4, v4, v5
    s_lshl_b32 s49, s46, 1
    s_add_u32 s49, s49, 0
    v_add_u32 v4, s49, v4
    s_nop 15

    v_cvt_pk_bf16_f32 v16, v40, v41
    v_cvt_pk_bf16_f32 v17, v42, v43
    v_cvt_pk_bf16_f32 v18, v44, v45
    v_cvt_pk_bf16_f32 v19, v46, v47
    v_cvt_pk_bf16_f32 v20, v48, v49
    v_cvt_pk_bf16_f32 v21, v50, v51
    v_cvt_pk_bf16_f32 v22, v52, v53
    v_cvt_pk_bf16_f32 v23, v54, v55
    s_nop 1
    v_permlane32_swap_b32 v16, v18
    v_permlane32_swap_b32 v17, v19
    v_permlane32_swap_b32 v20, v22
    v_permlane32_swap_b32 v21, v23
    s_nop 1
    buffer_store_dwordx4 v[16:19], v4, s[40:43], 0 offen offset:0
    buffer_store_dwordx4 v[20:23], v4, s[40:43], 0 offen offset:32
    v_cvt_pk_bf16_f32 v24, v56, v57
    v_cvt_pk_bf16_f32 v25, v58, v59
    v_cvt_pk_bf16_f32 v26, v60, v61
    v_cvt_pk_bf16_f32 v27, v62, v63
    v_cvt_pk_bf16_f32 v28, v64, v65
    v_cvt_pk_bf16_f32 v29, v66, v67
    v_cvt_pk_bf16_f32 v30, v68, v69
    v_cvt_pk_bf16_f32 v31, v70, v71
    s_nop 1
    v_permlane32_swap_b32 v24, v26
    v_permlane32_swap_b32 v25, v27
    v_permlane32_swap_b32 v28, v30
    v_permlane32_swap_b32 v29, v31
    s_nop 1
    buffer_store_dwordx4 v[24:27], v4, s[40:43], 0 offen offset:64
    buffer_store_dwordx4 v[28:31], v4, s[40:43], 0 offen offset:96
    s_branch .k2_wloop2
.k2o_j1:
    s_sub_u32 s7, s5, 20
    s_load_dwordx2 s[8:9], s[0:1], 96
    s_load_dwordx2 s[10:11], s[0:1], 96
    s_load_dwordx2 s[12:13], s[0:1], 80
    s_lshr_b32 s20, s7, 2
    s_mul_i32 s21, s20, 4
    s_sub_u32 s21, s7, s21
    s_mul_i32 s6, s4, 4
    s_add_u32 s21, s21, s6
    v_lshrrev_b32 v2, 2, v1
    v_lshrrev_b32 v3, 4, v1
    v_xor_b32 v3, v3, v1
    v_and_b32 v3, 3, v3
    v_lshlrev_b32 v3, 4, v3
    s_lshl_b32 s6, s3, 4
    s_mul_i32 s22, s20, 128
    s_add_u32 s22, s22, s6
    s_mul_i32 s23, s21, 64
    s_add_u32 s23, s23, s6
    s_mov_b32 s24, 1280
    s_mov_b32 s25, 1280

    v_add_u32 v4, s22, v2
    v_mul_lo_u32 v4, v4, s24
    v_add_u32 v4, v4, v3
    v_add_u32 v4, 26214400, v4
    v_add_u32 v5, s22, v2
    v_add_u32 v5, 64, v5
    v_mul_lo_u32 v5, v5, s24
    v_add_u32 v5, v5, v3
    v_add_u32 v5, 26214400, v5
    v_add_u32 v6, s23, v2
    v_mul_lo_u32 v6, v6, s25
    v_add_u32 v6, v6, v3
    v_add_u32 v6, 117440512, v6
    s_waitcnt lgkmcnt(0)
    s_mov_b32 s32, s8
    s_mov_b32 s33, s9
    s_mov_b32 s34, 268435456
    s_mov_b32 s35, 0x00020000
    s_mov_b32 s36, s10
    s_mov_b32 s37, s11
    s_mov_b32 s38, 268435456
    s_mov_b32 s39, 0x00020000
    s_mov_b32 s40, s12
    s_mov_b32 s41, s13
    s_mov_b32 s42, 5242880
    s_mov_b32 s43, 0x00020000
    s_mov_b32 s48, 0
    s_add_u32 m0, s50, 0
    s_nop 0
    buffer_load_dwordx4 v4, s[32:35], s48 offen lds
    s_add_u32 m0, s50, 4096
    s_nop 0
    buffer_load_dwordx4 v5, s[32:35], s48 offen lds
    s_add_u32 m0, s50, 8192
    s_nop 0
    buffer_load_dwordx4 v6, s[36:39], s48 offen lds
    s_add_u32 s48, s48, 64
    s_add_u32 m0, s50, 12288
    s_nop 0
    buffer_load_dwordx4 v4, s[32:35], s48 offen lds
    s_add_u32 m0, s50, 16384
    s_nop 0
    buffer_load_dwordx4 v5, s[32:35], s48 offen lds
    s_add_u32 m0, s50, 20480
    s_nop 0
    buffer_load_dwordx4 v6, s[36:39], s48 offen lds
    s_add_u32 s48, s48, 64
    s_add_u32 m0, s50, 24576
    s_nop 0
    buffer_load_dwordx4 v4, s[32:35], s48 offen lds
    s_add_u32 m0, s50, 28672
    s_nop 0
    buffer_load_dwordx4 v5, s[32:35], s48 offen lds
    s_add_u32 m0, s50, 32768
    s_nop 0
    buffer_load_dwordx4 v6, s[36:39], s48 offen lds
    s_add_u32 s48, s48, 64
    s_add_u32 m0, s50, 36864
    s_nop 0
    buffer_load_dwordx4 v4, s[32:35], s48 offen lds
    s_add_u32 m0, s50, 40960
    s_nop 0
    buffer_load_dwordx4 v5, s[32:35], s48 offen lds
    s_add_u32 m0, s50, 45056
    s_nop 0
    buffer_load_dwordx4 v6, s[36:39], s48 offen lds
    s_add_u32 s48, s48, 64
    s_add_u32 m0, s50, 49152
    s_nop 0
    buffer_load_dwordx4 v4, s[32:35], s48 offen lds
    s_add_u32 m0, s50, 53248
    s_nop 0
    buffer_load_dwordx4 v5, s[32:35], s48 offen lds
    s_add_u32 m0, s50, 57344
    s_nop 0
    buffer_load_dwordx4 v6, s[36:39], s48 offen lds
    s_add_u32 s48, s48, 64
    s_and_b32 s44, s3, 1
    s_lshr_b32 s45, s3, 1
    s_mul_i32 s44, s44, 64
    s_mul_i32 s45, s45, 32
    v_and_b32 v2, 31, v1
    v_lshrrev_b32 v3, 5, v1
    v_lshrrev_b32 v16, 2, v1
    v_xor_b32 v16, v16, v3
    v_and_b32 v16, 3, v16
    v_lshlrev_b32 v16, 4, v16
    v_add_u32 v7, s44, v2
    v_lshlrev_b32 v7, 6, v7
    v_add_u32 v7, v7, v16
    v_xor_b32 v8, 32, v7
    v_add_u32 v9, s45, v2
    v_lshlrev_b32 v9, 6, v9
    v_add_u32 v9, v9, v16
    v_add_u32 v9, 8192, v9
    v_xor_b32 v10, 32, v9

    v_mov_b32 v40, 0
    v_mov_b32 v41, 0
    v_mov_b32 v42, 0
    v_mov_b32 v43, 0
    v_mov_b32 v44, 0
    v_mov_b32 v45, 0
    v_mov_b32 v46, 0
    v_mov_b32 v47, 0
    v_mov_b32 v48, 0
    v_mov_b32 v49, 0
    v_mov_b32 v50, 0
    v_mov_b32 v51, 0
    v_mov_b32 v52, 0
    v_mov_b32 v53, 0
    v_mov_b32 v54, 0
    v_mov_b32 v55, 0
    v_mov_b32 v56, 0
    v_mov_b32 v57, 0
    v_mov_b32 v58, 0
    v_mov_b32 v59, 0
    v_mov_b32 v60, 0
    v_mov_b32 v61, 0
    v_mov_b32 v62, 0
    v_mov_b32 v63, 0
    v_mov_b32 v64, 0
    v_mov_b32 v65, 0
    v_mov_b32 v66, 0
    v_mov_b32 v67, 0
    v_mov_b32 v68, 0
    v_mov_b32 v69, 0
    v_mov_b32 v70, 0
    v_mov_b32 v71, 0
    s_waitcnt vmcnt(12)
    s_barrier
    ds_read_b128 v[16:19], v7 offset:0
    ds_read_b128 v[20:23], v7 offset:2048
    ds_read_b128 v[24:27], v9 offset:0
    s_mov_b32 s49, 3
.k2o_b1_loop:
    s_waitcnt lgkmcnt(0)
    v_mfma_f32_32x32x16_bf16 v[40:55], v[16:19], v[24:27], v[40:55]
    ds_read_b128 v[28:31], v8 offset:0
    ds_read_b128 v[32:35], v8 offset:2048
    v_mfma_f32_32x32x16_bf16 v[56:71], v[20:23], v[24:27], v[56:71]
    ds_read_b128 v[36:39], v10 offset:0
    s_waitcnt vmcnt(9) lgkmcnt(0)
    s_barrier
    v_mfma_f32_32x32x16_bf16 v[40:55], v[28:31], v[36:39], v[40:55]
    ds_read_b128 v[16:19], v7 offset:12288
    ds_read_b128 v[20:23], v7 offset:14336
    ds_read_b128 v[24:27], v9 offset:12288
    v_mfma_f32_32x32x16_bf16 v[56:71], v[32:35], v[36:39], v[56:71]
    s_add_u32 m0, s50, 0
    s_nop 0
    buffer_load_dwordx4 v4, s[32:35], s48 offen lds
    s_add_u32 m0, s50, 4096
    s_nop 0
    buffer_load_dwordx4 v5, s[32:35], s48 offen lds
    s_add_u32 m0, s50, 8192
    s_nop 0
    buffer_load_dwordx4 v6, s[36:39], s48 offen lds
    s_add_u32 s48, s48, 64
    s_waitcnt lgkmcnt(0)
    v_mfma_f32_32x32x16_bf16 v[40:55], v[16:19], v[24:27], v[40:55]
    ds_read_b128 v[28:31], v8 offset:12288
    ds_read_b128 v[32:35], v8 offset:14336
    v_mfma_f32_32x32x16_bf16 v[56:71], v[20:23], v[24:27], v[56:71]
    ds_read_b128 v[36:39], v10 offset:12288
    s_waitcnt vmcnt(9) lgkmcnt(0)
    s_barrier
    v_mfma_f32_32x32x16_bf16 v[40:55], v[28:31], v[36:39], v[40:55]
    ds_read_b128 v[16:19], v7 offset:24576
    ds_read_b128 v[20:23], v7 offset:26624
    ds_read_b128 v[24:27], v9 offset:24576
    v_mfma_f32_32x32x16_bf16 v[56:71], v[32:35], v[36:39], v[56:71]
    s_add_u32 m0, s50, 12288
    s_nop 0
    buffer_load_dwordx4 v4, s[32:35], s48 offen lds
    s_add_u32 m0, s50, 16384
    s_nop 0
    buffer_load_dwordx4 v5, s[32:35], s48 offen lds
    s_add_u32 m0, s50, 20480
    s_nop 0
    buffer_load_dwordx4 v6, s[36:39], s48 offen lds
    s_add_u32 s48, s48, 64
    s_waitcnt lgkmcnt(0)
    v_mfma_f32_32x32x16_bf16 v[40:55], v[16:19], v[24:27], v[40:55]
    ds_read_b128 v[28:31], v8 offset:24576
    ds_read_b128 v[32:35], v8 offset:26624
    v_mfma_f32_32x32x16_bf16 v[56:71], v[20:23], v[24:27], v[56:71]
    ds_read_b128 v[36:39], v10 offset:24576
    s_waitcnt vmcnt(9) lgkmcnt(0)
    s_barrier
    v_mfma_f32_32x32x16_bf16 v[40:55], v[28:31], v[36:39], v[40:55]
    ds_read_b128 v[16:19], v7 offset:36864
    ds_read_b128 v[20:23], v7 offset:38912
    ds_read_b128 v[24:27], v9 offset:36864
    v_mfma_f32_32x32x16_bf16 v[56:71], v[32:35], v[36:39], v[56:71]
    s_add_u32 m0, s50, 24576
    s_nop 0
    buffer_load_dwordx4 v4, s[32:35], s48 offen lds
    s_add_u32 m0, s50, 28672
    s_nop 0
    buffer_load_dwordx4 v5, s[32:35], s48 offen lds
    s_add_u32 m0, s50, 32768
    s_nop 0
    buffer_load_dwordx4 v6, s[36:39], s48 offen lds
    s_add_u32 s48, s48, 64
    s_waitcnt lgkmcnt(0)
    v_mfma_f32_32x32x16_bf16 v[40:55], v[16:19], v[24:27], v[40:55]
    ds_read_b128 v[28:31], v8 offset:36864
    ds_read_b128 v[32:35], v8 offset:38912
    v_mfma_f32_32x32x16_bf16 v[56:71], v[20:23], v[24:27], v[56:71]
    ds_read_b128 v[36:39], v10 offset:36864
    s_waitcnt vmcnt(9) lgkmcnt(0)
    s_barrier
    v_mfma_f32_32x32x16_bf16 v[40:55], v[28:31], v[36:39], v[40:55]
    ds_read_b128 v[16:19], v7 offset:49152
    ds_read_b128 v[20:23], v7 offset:51200
    ds_read_b128 v[24:27], v9 offset:49152
    v_mfma_f32_32x32x16_bf16 v[56:71], v[32:35], v[36:39], v[56:71]
    s_add_u32 m0, s50, 36864
    s_nop 0
    buffer_load_dwordx4 v4, s[32:35], s48 offen lds
    s_add_u32 m0, s50, 40960
    s_nop 0
    buffer_load_dwordx4 v5, s[32:35], s48 offen lds
    s_add_u32 m0, s50, 45056
    s_nop 0
    buffer_load_dwordx4 v6, s[36:39], s48 offen lds
    s_add_u32 s48, s48, 64
    s_waitcnt lgkmcnt(0)
    v_mfma_f32_32x32x16_bf16 v[40:55], v[16:19], v[24:27], v[40:55]
    ds_read_b128 v[28:31], v8 offset:49152
    ds_read_b128 v[32:35], v8 offset:51200
    v_mfma_f32_32x32x16_bf16 v[56:71], v[20:23], v[24:27], v[56:71]
    ds_read_b128 v[36:39], v10 offset:49152
    s_waitcnt vmcnt(9) lgkmcnt(0)
    s_barrier
    v_mfma_f32_32x32x16_bf16 v[40:55], v[28:31], v[36:39], v[40:55]
    ds_read_b128 v[16:19], v7 offset:0
    ds_read_b128 v[20:23], v7 offset:2048
    ds_read_b128 v[24:27], v9 offset:0
    v_mfma_f32_32x32x16_bf16 v[56:71], v[32:35], v[36:39], v[56:71]
    s_add_u32 m0, s50, 49152
    s_nop 0
    buffer_load_dwordx4 v4, s[32:35], s48 offen lds
    s_add_u32 m0, s50, 53248
    s_nop 0
    buffer_load_dwordx4 v5, s[32:35], s48 offen lds
    s_add_u32 m0, s50, 57344
    s_nop 0
    buffer_load_dwordx4 v6, s[36:39], s48 offen lds
    s_add_u32 s48, s48, 64
    s_sub_u32 s49, s49, 1
    s_cmp_lg_u32 s49, 0
    s_cbranch_scc1 .k2o_b1_loop
    s_waitcnt lgkmcnt(0)
    v_mfma_f32_32x32x16_bf16 v[40:55], v[16:19], v[24:27], v[40:55]
    ds_read_b128 v[28:31], v8 offset:0
    ds_read_b128 v[32:35], v8 offset:2048
    v_mfma_f32_32x32x16_bf16 v[56:71], v[20:23], v[24:27], v[56:71]
    ds_read_b128 v[36:39], v10 offset:0
    s_waitcnt vmcnt(9) lgkmcnt(0)
    s_barrier
    v_mfma_f32_32x32x16_bf16 v[40:55], v[28:31], v[36:39], v[40:55]
    ds_read_b128 v[16:19], v7 offset:12288
    ds_read_b128 v[20:23], v7 offset:14336
    v_mfma_f32_32x32x16_bf16 v[56:71], v[32:35], v[36:39], v[56:71]
    ds_read_b128 v[24:27], v9 offset:12288
    s_waitcnt lgkmcnt(0)
    v_mfma_f32_32x32x16_bf16 v[40:55], v[16:19], v[24:27], v[40:55]
    ds_read_b128 v[28:31], v8 offset:12288
    ds_read_b128 v[32:35], v8 offset:14336
    v_mfma_f32_32x32x16_bf16 v[56:71], v[20:23], v[24:27], v[56:71]
    ds_read_b128 v[36:39], v10 offset:12288
    s_waitcnt vmcnt(6) lgkmcnt(0)
    s_barrier
    v_mfma_f32_32x32x16_bf16 v[40:55], v[28:31], v[36:39], v[40:55]
    ds_read_b128 v[16:19], v7 offset:24576
    ds_read_b128 v[20:23], v7 offset:26624
    v_mfma_f32_32x32x16_bf16 v[56:71], v[32:35], v[36:39], v[56:71]
    ds_read_b128 v[24:27], v9 offset:24576
    s_waitcnt lgkmcnt(0)
    v_mfma_f32_32x32x16_bf16 v[40:55], v[16:19], v[24:27], v[40:55]
    ds_read_b128 v[28:31], v8 offset:24576
    ds_read_b128 v[32:35], v8 offset:26624
    v_mfma_f32_32x32x16_bf16 v[56:71], v[20:23], v[24:27], v[56:71]
    ds_read_b128 v[36:39], v10 offset:24576
    s_waitcnt vmcnt(3) lgkmcnt(0)
    s_barrier
    v_mfma_f32_32x32x16_bf16 v[40:55], v[28:31], v[36:39], v[40:55]
    ds_read_b128 v[16:19], v7 offset:36864
    ds_read_b128 v[20:23], v7 offset:38912
    v_mfma_f32_32x32x16_bf16 v[56:71], v[32:35], v[36:39], v[56:71]
    ds_read_b128 v[24:27], v9 offset:36864
    s_waitcnt lgkmcnt(0)
    v_mfma_f32_32x32x16_bf16 v[40:55], v[16:19], v[24:27], v[40:55]
    ds_read_b128 v[28:31], v8 offset:36864
    ds_read_b128 v[32:35], v8 offset:38912
    v_mfma_f32_32x32x16_bf16 v[56:71], v[20:23], v[24:27], v[56:71]
    ds_read_b128 v[36:39], v10 offset:36864
    s_waitcnt vmcnt(0) lgkmcnt(0)
    s_barrier
    v_mfma_f32_32x32x16_bf16 v[40:55], v[28:31], v[36:39], v[40:55]
    ds_read_b128 v[16:19], v7 offset:49152
    ds_read_b128 v[20:23], v7 offset:51200
    v_mfma_f32_32x32x16_bf16 v[56:71], v[32:35], v[36:39], v[56:71]
    ds_read_b128 v[24:27], v9 offset:49152
    s_waitcnt lgkmcnt(0)
    v_mfma_f32_32x32x16_bf16 v[40:55], v[16:19], v[24:27], v[40:55]
    ds_read_b128 v[28:31], v8 offset:49152
    ds_read_b128 v[32:35], v8 offset:51200
    v_mfma_f32_32x32x16_bf16 v[56:71], v[20:23], v[24:27], v[56:71]
    ds_read_b128 v[36:39], v10 offset:49152
    s_waitcnt lgkmcnt(0)
    v_mfma_f32_32x32x16_bf16 v[40:55], v[28:31], v[36:39], v[40:55]
    v_mfma_f32_32x32x16_bf16 v[56:71], v[32:35], v[36:39], v[56:71]
    s_mul_i32 s46, s20, 128
    s_add_u32 s46, s46, s44
    s_mul_i32 s47, s21, 64
    s_add_u32 s47, s47, s45
    s_mov_b32 s24, 2560
    v_add_u32 v4, s47, v2
    v_mul_lo_u32 v4, v4, s24
    v_lshlrev_b32 v5, 4, v3
    v_add_u32 v4, v4, v5
    s_lshl_b32 s49, s46, 1
    s_add_u32 s49, s49, 1280
    v_add_u32 v4, s49, v4
    s_nop 15

    v_cvt_pk_bf16_f32 v16, v40, v41
    v_cvt_pk_bf16_f32 v17, v42, v43
    v_cvt_pk_bf16_f32 v18, v44, v45
    v_cvt_pk_bf16_f32 v19, v46, v47
    v_cvt_pk_bf16_f32 v20, v48, v49
    v_cvt_pk_bf16_f32 v21, v50, v51
    v_cvt_pk_bf16_f32 v22, v52, v53
    v_cvt_pk_bf16_f32 v23, v54, v55
    s_nop 1
    v_permlane32_swap_b32 v16, v18
    v_permlane32_swap_b32 v17, v19
    v_permlane32_swap_b32 v20, v22
    v_permlane32_swap_b32 v21, v23
    s_nop 1
    buffer_store_dwordx4 v[16:19], v4, s[40:43], 0 offen offset:0
    buffer_store_dwordx4 v[20:23], v4, s[40:43], 0 offen offset:32
    v_cvt_pk_bf16_f32 v24, v56, v57
    v_cvt_pk_bf16_f32 v25, v58, v59
    v_cvt_pk_bf16_f32 v26, v60, v61
    v_cvt_pk_bf16_f32 v27, v62, v63
    v_cvt_pk_bf16_f32 v28, v64, v65
    v_cvt_pk_bf16_f32 v29, v66, v67
    v_cvt_pk_bf16_f32 v30, v68, v69
    v_cvt_pk_bf16_f32 v31, v70, v71
    s_nop 1
    v_permlane32_swap_b32 v24, v26
    v_permlane32_swap_b32 v25, v27
    v_permlane32_swap_b32 v28, v30
    v_permlane32_swap_b32 v29, v31
    s_nop 1
    buffer_store_dwordx4 v[24:27], v4, s[40:43], 0 offen offset:64
    buffer_store_dwordx4 v[28:31], v4, s[40:43], 0 offen offset:96
    s_branch .k2_wloop2
.k2o_end:
    s_branch .k2_wloop2
.k2_rp:
    s_load_dwordx2 s[4:5], s[0:1], 96
    v_lshrrev_b32 v1, 6, v0
    s_nop 1
    v_readfirstlane_b32 s18, v1
    v_and_b32 v1, 63, v0
    s_waitcnt lgkmcnt(0)

    s_mov_b32 s8, s4
    s_mov_b32 s9, s5
    s_mov_b32 s10, 268435456
    s_mov_b32 s11, 0x00020000
    v_and_b32 v2, 31, v1
    v_lshrrev_b32 v3, 5, v1
    v_lshlrev_b32 v4, 13, v2
    v_lshlrev_b32 v5, 4, v3
    v_add_u32 v4, v4, v5
    s_lshr_b32 s16, s2, 2
    s_and_b32 s17, s2, 3
    s_lshl_b32 s17, s17, 2
    s_add_u32 s17, s17, s18
    s_lshl_b32 s28, s16, 18
    s_lshl_b32 s29, s17, 9
    s_add_u32 s29, s29, s28
    s_add_u32 s29, s29, 16777216
    v_add_u32 v4, s29, v4
    s_lshl_b32 s29, s17, 14
    s_add_u32 s29, s29, s28
    s_add_u32 s29, s29, 27262976
    v_lshlrev_b32 v5, 4, v1
    v_add_u32 v5, s29, v5

    buffer_load_dwordx4 v[8:11], v4, s[8:11], 0 offen offset:0
    buffer_load_dwordx4 v[12:15], v4, s[8:11], 0 offen offset:32
    buffer_load_dwordx4 v[16:19], v4, s[8:11], 0 offen offset:64
    buffer_load_dwordx4 v[20:23], v4, s[8:11], 0 offen offset:96
    buffer_load_dwordx4 v[24:27], v4, s[8:11], 0 offen offset:128
    buffer_load_dwordx4 v[28:31], v4, s[8:11], 0 offen offset:160
    buffer_load_dwordx4 v[32:35], v4, s[8:11], 0 offen offset:192
    buffer_load_dwordx4 v[36:39], v4, s[8:11], 0 offen offset:224
    buffer_load_dwordx4 v[40:43], v4, s[8:11], 0 offen offset:256
    buffer_load_dwordx4 v[44:47], v4, s[8:11], 0 offen offset:288
    buffer_load_dwordx4 v[48:51], v4, s[8:11], 0 offen offset:320
    buffer_load_dwordx4 v[52:55], v4, s[8:11], 0 offen offset:352
    buffer_load_dwordx4 v[56:59], v4, s[8:11], 0 offen offset:384
    buffer_load_dwordx4 v[60:63], v4, s[8:11], 0 offen offset:416
    buffer_load_dwordx4 v[64:67], v4, s[8:11], 0 offen offset:448
    buffer_load_dwordx4 v[68:71], v4, s[8:11], 0 offen offset:480
    s_movk_i32 s28, 0
    s_waitcnt vmcnt(0)
    buffer_store_dwordx4 v[8:11], v5, s[8:11], s28 offen offset:0
    buffer_store_dwordx4 v[12:15], v5, s[8:11], s28 offen offset:1024
    buffer_store_dwordx4 v[16:19], v5, s[8:11], s28 offen offset:2048
    buffer_store_dwordx4 v[20:23], v5, s[8:11], s28 offen offset:3072
    s_movk_i32 s28, 4096
    buffer_store_dwordx4 v[24:27], v5, s[8:11], s28 offen offset:0
    buffer_store_dwordx4 v[28:31], v5, s[8:11], s28 offen offset:1024
    buffer_store_dwordx4 v[32:35], v5, s[8:11], s28 offen offset:2048
    buffer_store_dwordx4 v[36:39], v5, s[8:11], s28 offen offset:3072
    s_movk_i32 s28, 8192
    buffer_store_dwordx4 v[40:43], v5, s[8:11], s28 offen offset:0
    buffer_store_dwordx4 v[44:47], v5, s[8:11], s28 offen offset:1024
    buffer_store_dwordx4 v[48:51], v5, s[8:11], s28 offen offset:2048
    buffer_store_dwordx4 v[52:55], v5, s[8:11], s28 offen offset:3072
    s_movk_i32 s28, 12288
    buffer_store_dwordx4 v[56:59], v5, s[8:11], s28 offen offset:0
    buffer_store_dwordx4 v[60:63], v5, s[8:11], s28 offen offset:1024
    buffer_store_dwordx4 v[64:67], v5, s[8:11], s28 offen offset:2048
    buffer_store_dwordx4 v[68:71], v5, s[8:11], s28 offen offset:3072
    s_branch .k2_wloop2
.k2_att:
    s_load_dwordx2 s[4:5], s[0:1], 96
    v_lshrrev_b32 v1, 6, v0
    s_nop 1
    v_readfirstlane_b32 s18, v1
    v_and_b32 v1, 63, v0
    s_waitcnt lgkmcnt(0)
    s_mov_b32 s8, s4
    s_mov_b32 s9, s5
    s_mov_b32 s10, 268435456
    s_mov_b32 s11, 0x00020000
    s_mov_b32 s40, 0x3fb8aa3b
    s_cmp_ge_u32 s2, 512
    s_cbranch_scc1 .k2a_b
    s_lshl_b32 s16, s2, 2
    s_add_u32 s16, s16, s18
    s_and_b32 s17, s16, 31
    s_lshr_b32 s16, s16, 5
    s_mov_b32 s41, 0x3db504f3
    v_and_b32 v2, 31, v1
    v_lshrrev_b32 v3, 5, v1
    s_lshl_b32 s28, s16, 19
    s_lshl_b32 s29, s17, 8
    s_add_u32 s28, s28, s29
    s_add_u32 s28, s28, 33554432
    v_lshlrev_b32 v4, 14, v2
    v_lshlrev_b32 v5, 5, v3
    v_add_u32 v4, v4, v5
    v_add_u32 v4, s28, v4
    v_add_u32 v6, 0x2000, v4
    s_lshl_b32 s28, s16, 16
    s_lshl_b32 s29, s17, 11
    s_add_u32 s28, s28, s29
    s_add_u32 s28, s28, 121634816
    v_and_b32 v7, 7, v2
    v_lshlrev_b32 v7, 8, v7
    v_add_u32 v7, v7, v5
    v_add_u32 v7, s28, v7
    buffer_load_dwordx4 v[16:19], v4, s[8:11], 0 offen offset:0
    buffer_load_dwordx4 v[48:51], v6, s[8:11], 0 offen offset:0
    buffer_load_dwordx4 v[80:83], v7, s[8:11], 0 offen offset:0
    buffer_load_dwordx4 v[20:23], v4, s[8:11], 0 offen offset:16
    buffer_load_dwordx4 v[52:55], v6, s[8:11], 0 offen offset:16
    buffer_load_dwordx4 v[84:87], v7, s[8:11], 0 offen offset:16
    buffer_load_dwordx4 v[24:27], v4, s[8:11], 0 offen offset:64
    buffer_load_dwordx4 v[56:59], v6, s[8:11], 0 offen offset:64
    buffer_load_dwordx4 v[88:91], v7, s[8:11], 0 offen offset:64
    buffer_load_dwordx4 v[28:31], v4, s[8:11], 0 offen offset:80
    buffer_load_dwordx4 v[60:63], v6, s[8:11], 0 offen offset:80
    buffer_load_dwordx4 v[92:95], v7, s[8:11], 0 offen offset:80
    buffer_load_dwordx4 v[32:35], v4, s[8:11], 0 offen offset:128
    buffer_load_dwordx4 v[64:67], v6, s[8:11], 0 offen offset:128
    buffer_load_dwordx4 v[96:99], v7, s[8:11], 0 offen offset:128
    buffer_load_dwordx4 v[36:39], v4, s[8:11], 0 offen offset:144
    buffer_load_dwordx4 v[68:71], v6, s[8:11], 0 offen offset:144
    buffer_load_dwordx4 v[100:103], v7, s[8:11], 0 offen offset:144
    buffer_load_dwordx4 v[40:43], v4, s[8:11], 0 offen offset:192
    buffer_load_dwordx4 v[72:75], v6, s[8:11], 0 offen offset:192
    buffer_load_dwordx4 v[104:107], v7, s[8:11], 0 offen offset:192
    buffer_load_dwordx4 v[44:47], v4, s[8:11], 0 offen offset:208
    buffer_load_dwordx4 v[76:79], v6, s[8:11], 0 offen offset:208
    buffer_load_dwordx4 v[108:111], v7, s[8:11], 0 offen offset:208
    s_lshl_b32 s28, s17, 19
    s_lshl_b32 s29, s16, 6
    s_add_u32 s28, s28, s29
    s_add_u32 s28, s28, 67108864
    v_lshlrev_b32 v8, 12, v2
    v_lshlrev_b32 v5, 3, v3
    v_add_u32 v8, v8, v5
    v_add_u32 v8, s28, v8
    s_lshl_b32 s28, s16, 16
    s_lshl_b32 s29, s17, 11
    s_add_u32 s28, s28, s29
    s_add_u32 s28, s28, 125829120
    v_lshlrev_b32 v9, 4, v2
    v_add_u32 v9, v9, v5
    v_add_u32 v9, s28, v9
    s_mov_b32 s28, 0
    buffer_load_dwordx2 v[144:145], v8, s[8:11], s28 offen
    buffer_load_dwordx2 v[146:147], v8, s[8:11], s28 offen offset:16
    buffer_load_dwordx2 v[148:149], v8, s[8:11], s28 offen offset:32
    buffer_load_dwordx2 v[150:151], v8, s[8:11], s28 offen offset:48
    buffer_load_dwordx2 v[152:153], v9, s[8:11], 0 offen offset:0
    v_mov_b32 v154, 0
    v_mov_b32 v155, 0
    s_add_u32 s28, s28, 0x20000
    buffer_load_dwordx2 v[156:157], v8, s[8:11], s28 offen
    buffer_load_dwordx2 v[158:159], v8, s[8:11], s28 offen offset:16
    buffer_load_dwordx2 v[160:161], v8, s[8:11], s28 offen offset:32
    buffer_load_dwordx2 v[162:163], v8, s[8:11], s28 offen offset:48
    buffer_load_dwordx2 v[164:165], v9, s[8:11], 0 offen offset:512
    v_mov_b32 v166, 0
    v_mov_b32 v167, 0
    s_add_u32 s28, s28, 0x20000
    buffer_load_dwordx2 v[168:169], v8, s[8:11], s28 offen
    buffer_load_dwordx2 v[170:171], v8, s[8:11], s28 offen offset:16
    buffer_load_dwordx2 v[172:173], v8, s[8:11], s28 offen offset:32
    buffer_load_dwordx2 v[174:175], v8, s[8:11], s28 offen offset:48
    buffer_load_dwordx2 v[176:177], v9, s[8:11], 0 offen offset:1024
    v_mov_b32 v178, 0
    v_mov_b32 v179, 0
    s_add_u32 s28, s28, 0x20000
    buffer_load_dwordx2 v[180:181], v8, s[8:11], s28 offen
    buffer_load_dwordx2 v[182:183], v8, s[8:11], s28 offen offset:16
    buffer_load_dwordx2 v[184:185], v8, s[8:11], s28 offen offset:32
    buffer_load_dwordx2 v[186:187], v8, s[8:11], s28 offen offset:48
    buffer_load_dwordx2 v[188:189], v9, s[8:11], 0 offen offset:1536
    v_mov_b32 v190, 0
    v_mov_b32 v191, 0
    s_add_u32 s28, s28, 0x20000
    s_waitcnt vmcnt(20)
    v_mfma_f32_32x32x16_bf16 v[112:127], v[48:51], v[16:19], 0
    v_mfma_f32_32x32x16_bf16 v[112:127], v[52:55], v[20:23], v[112:127]
    v_mfma_f32_32x32x16_bf16 v[112:127], v[56:59], v[24:27], v[112:127]
    v_mfma_f32_32x32x16_bf16 v[112:127], v[60:63], v[28:31], v[112:127]
    v_mfma_f32_32x32x16_bf16 v[112:127], v[64:67], v[32:35], v[112:127]
    v_mfma_f32_32x32x16_bf16 v[112:127], v[68:71], v[36:39], v[112:127]
    v_mfma_f32_32x32x16_bf16 v[112:127], v[72:75], v[40:43], v[112:127]
    v_mfma_f32_32x32x16_bf16 v[112:127], v[76:79], v[44:47], v[112:127]
    v_mfma_f32_32x32x16_bf16 v[128:143], v[80:83], v[16:19], 0
    v_mfma_f32_32x32x16_bf16 v[128:143], v[84:87], v[20:23], v[128:143]
    v_mfma_f32_32x32x16_bf16 v[128:143], v[88:91], v[24:27], v[128:143]
    v_mfma_f32_32x32x16_bf16 v[128:143], v[92:95], v[28:31], v[128:143]
    v_mfma_f32_32x32x16_bf16 v[128:143], v[96:99], v[32:35], v[128:143]
    v_mfma_f32_32x32x16_bf16 v[128:143], v[100:103], v[36:39], v[128:143]
    v_mfma_f32_32x32x16_bf16 v[128:143], v[104:107], v[40:43], v[128:143]
    v_mfma_f32_32x32x16_bf16 v[128:143], v[108:111], v[44:47], v[128:143]
    s_nop 15
    s_nop 7
    v_cvt_pk_bf16_f32 v16, v112, v113
    v_lshlrev_b32 v112, 16, v16
    v_and_b32 v113, 0xffff0000, v16
    v_cvt_pk_bf16_f32 v16, v114, v115
    v_lshlrev_b32 v114, 16, v16
    v_and_b32 v115, 0xffff0000, v16
    v_cvt_pk_bf16_f32 v16, v116, v117
    v_lshlrev_b32 v116, 16, v16
    v_and_b32 v117, 0xffff0000, v16
    v_cvt_pk_bf16_f32 v16, v118, v119
    v_lshlrev_b32 v118, 16, v16
    v_and_b32 v119, 0xffff0000, v16
    v_cvt_pk_bf16_f32 v16, v120, v121
    v_lshlrev_b32 v120, 16, v16
    v_and_b32 v121, 0xffff0000, v16
    v_cvt_pk_bf16_f32 v16, v122, v123
    v_lshlrev_b32 v122, 16, v16
    v_and_b32 v123, 0xffff0000, v16
    v_cvt_pk_bf16_f32 v16, v124, v125
    v_lshlrev_b32 v124, 16, v16
    v_and_b32 v125, 0xffff0000, v16
    v_cvt_pk_bf16_f32 v16, v126, v127
    v_lshlrev_b32 v126, 16, v16
    v_and_b32 v127, 0xffff0000, v16
    v_cvt_pk_bf16_f32 v16, v128, v129
    v_lshlrev_b32 v128, 16, v16
    v_and_b32 v129, 0xffff0000, v16
    v_cvt_pk_bf16_f32 v16, v130, v131
    v_lshlrev_b32 v130, 16, v16
    v_and_b32 v131, 0xffff0000, v16
    v_mul_f32 v112, s41, v112
    v_mul_f32 v113, s41, v113
    v_mul_f32 v114, s41, v114
    v_mul_f32 v115, s41, v115
    v_mul_f32 v116, s41, v116
    v_mul_f32 v117, s41, v117
    v_mul_f32 v118, s41, v118
    v_mul_f32 v119, s41, v119
    v_mul_f32 v120, s41, v120
    v_mul_f32 v121, s41, v121
    v_mul_f32 v122, s41, v122
    v_mul_f32 v123, s41, v123
    v_mul_f32 v124, s41, v124
    v_mul_f32 v125, s41, v125
    v_mul_f32 v126, s41, v126
    v_mul_f32 v127, s41, v127
    v_mul_f32 v128, s41, v128
    v_mul_f32 v129, s41, v129
    v_mul_f32 v130, s41, v130
    v_mul_f32 v131, s41, v131
    v_cvt_pk_bf16_f32 v16, v112, v113
    v_lshlrev_b32 v112, 16, v16
    v_and_b32 v113, 0xffff0000, v16
    v_cvt_pk_bf16_f32 v16, v114, v115
    v_lshlrev_b32 v114, 16, v16
    v_and_b32 v115, 0xffff0000, v16
    v_cvt_pk_bf16_f32 v16, v116, v117
    v_lshlrev_b32 v116, 16, v16
    v_and_b32 v117, 0xffff0000, v16
    v_cvt_pk_bf16_f32 v16, v118, v119
    v_lshlrev_b32 v118, 16, v16
    v_and_b32 v119, 0xffff0000, v16
    v_cvt_pk_bf16_f32 v16, v120, v121
    v_lshlrev_b32 v120, 16, v16
    v_and_b32 v121, 0xffff0000, v16
    v_cvt_pk_bf16_f32 v16, v122, v123
    v_lshlrev_b32 v122, 16, v16
    v_and_b32 v123, 0xffff0000, v16
    v_cvt_pk_bf16_f32 v16, v124, v125
    v_lshlrev_b32 v124, 16, v16
    v_and_b32 v125, 0xffff0000, v16
    v_cvt_pk_bf16_f32 v16, v126, v127
    v_lshlrev_b32 v126, 16, v16
    v_and_b32 v127, 0xffff0000, v16
    v_cvt_pk_bf16_f32 v16, v128, v129
    v_lshlrev_b32 v128, 16, v16
    v_and_b32 v129, 0xffff0000, v16
    v_cvt_pk_bf16_f32 v16, v130, v131
    v_lshlrev_b32 v130, 16, v16
    v_and_b32 v131, 0xffff0000, v16
    v_mov_b32 v17, 0xf149f2ca
    v_lshlrev_b32 v18, 2, v3
    v_sub_u32 v18, v2, v18
    v_cmp_le_i32 vcc, 0, v18
    s_nop 1
    v_cndmask_b32 v112, v17, v112, vcc
    v_cmp_le_i32 vcc, 1, v18
    s_nop 1
    v_cndmask_b32 v113, v17, v113, vcc
    v_cmp_le_i32 vcc, 2, v18
    s_nop 1
    v_cndmask_b32 v114, v17, v114, vcc
    v_cmp_le_i32 vcc, 3, v18
    s_nop 1
    v_cndmask_b32 v115, v17, v115, vcc
    v_cmp_le_i32 vcc, 8, v18
    s_nop 1
    v_cndmask_b32 v116, v17, v116, vcc
    v_cmp_le_i32 vcc, 9, v18
    s_nop 1
    v_cndmask_b32 v117, v17, v117, vcc
    v_cmp_le_i32 vcc, 10, v18
    s_nop 1
    v_cndmask_b32 v118, v17, v118, vcc
    v_cmp_le_i32 vcc, 11, v18
    s_nop 1
    v_cndmask_b32 v119, v17, v119, vcc
    v_cmp_le_i32 vcc, 16, v18
    s_nop 1
    v_cndmask_b32 v120, v17, v120, vcc
    v_cmp_le_i32 vcc, 17, v18
    s_nop 1
    v_cndmask_b32 v121, v17, v121, vcc
    v_cmp_le_i32 vcc, 18, v18
    s_nop 1
    v_cndmask_b32 v122, v17, v122, vcc
    v_cmp_le_i32 vcc, 19, v18
    s_nop 1
    v_cndmask_b32 v123, v17, v123, vcc
    v_cmp_le_i32 vcc, 24, v18
    s_nop 1
    v_cndmask_b32 v124, v17, v124, vcc
    v_cmp_le_i32 vcc, 25, v18
    s_nop 1
    v_cndmask_b32 v125, v17, v125, vcc
    v_cmp_le_i32 vcc, 26, v18
    s_nop 1
    v_cndmask_b32 v126, v17, v126, vcc
    v_cmp_le_i32 vcc, 27, v18
    s_nop 1
    v_cndmask_b32 v127, v17, v127, vcc
    v_max3_f32 v19, v112, v113, v114
    v_max3_f32 v19, v19, v115, v116
    v_max3_f32 v19, v19, v117, v118
    v_max3_f32 v19, v19, v119, v120
    v_max3_f32 v19, v19, v121, v122
    v_max3_f32 v19, v19, v123, v124
    v_max3_f32 v19, v19, v125, v126
    v_max3_f32 v19, v19, v127, v128
    v_max3_f32 v19, v19, v129, v130
    v_max_f32 v19, v19, v131
    v_mov_b32 v20, v19
    v_mov_b32 v21, v19
    s_nop 1
    v_permlane32_swap_b32 v20, v21
    s_nop 1
    v_max_f32 v19, v20, v21
    v_sub_f32 v112, v112, v19
    v_sub_f32 v113, v113, v19
    v_sub_f32 v114, v114, v19
    v_sub_f32 v115, v115, v19
    v_sub_f32 v116, v116, v19
    v_sub_f32 v117, v117, v19
    v_sub_f32 v118, v118, v19
    v_sub_f32 v119, v119, v19
    v_sub_f32 v120, v120, v19
    v_sub_f32 v121, v121, v19
    v_sub_f32 v122, v122, v19
    v_sub_f32 v123, v123, v19
    v_sub_f32 v124, v124, v19
    v_sub_f32 v125, v125, v19
    v_sub_f32 v126, v126, v19
    v_sub_f32 v127, v127, v19
    v_sub_f32 v128, v128, v19
    v_sub_f32 v129, v129, v19
    v_sub_f32 v130, v130, v19
    v_sub_f32 v131, v131, v19
    v_mul_f32 v112, s40, v112
    v_mul_f32 v113, s40, v113
    v_mul_f32 v114, s40, v114
    v_mul_f32 v115, s40, v115
    v_mul_f32 v116, s40, v116
    v_mul_f32 v117, s40, v117
    v_mul_f32 v118, s40, v118
    v_mul_f32 v119, s40, v119
    v_mul_f32 v120, s40, v120
    v_mul_f32 v121, s40, v121
    v_mul_f32 v122, s40, v122
    v_mul_f32 v123, s40, v123
    v_mul_f32 v124, s40, v124
    v_mul_f32 v125, s40, v125
    v_mul_f32 v126, s40, v126
    v_mul_f32 v127, s40, v127
    v_mul_f32 v128, s40, v128
    v_mul_f32 v129, s40, v129
    v_mul_f32 v130, s40, v130
    v_mul_f32 v131, s40, v131
    v_exp_f32 v112, v112
    v_exp_f32 v113, v113
    v_exp_f32 v114, v114
    v_exp_f32 v115, v115
    v_exp_f32 v116, v116
    v_exp_f32 v117, v117
    v_exp_f32 v118, v118
    v_exp_f32 v119, v119
    v_exp_f32 v120, v120
    v_exp_f32 v121, v121
    v_exp_f32 v122, v122
    v_exp_f32 v123, v123
    v_exp_f32 v124, v124
    v_exp_f32 v125, v125
    v_exp_f32 v126, v126
    v_exp_f32 v127, v127
    v_exp_f32 v128, v128
    v_exp_f32 v129, v129
    v_exp_f32 v130, v130
    v_exp_f32 v131, v131
    s_nop 1
    v_add_f32 v19, v112, v113
    v_add_f32 v19, v19, v114
    v_add_f32 v19, v19, v115
    v_add_f32 v19, v19, v116
    v_add_f32 v19, v19, v117
    v_add_f32 v19, v19, v118
    v_add_f32 v19, v19, v119
    v_add_f32 v19, v19, v120
    v_add_f32 v19, v19, v121
    v_add_f32 v19, v19, v122
    v_add_f32 v19, v19, v123
    v_add_f32 v19, v19, v124
    v_add_f32 v19, v19, v125
    v_add_f32 v19, v19, v126
    v_add_f32 v19, v19, v127
    v_add_f32 v19, v19, v128
    v_add_f32 v19, v19, v129
    v_add_f32 v19, v19, v130
    v_add_f32 v19, v19, v131
    v_mov_b32 v20, v19
    v_mov_b32 v21, v19
    s_nop 1
    v_permlane32_swap_b32 v20, v21
    s_nop 1
    v_add_f32 v19, v20, v21
    v_rcp_f32 v19, v19
    s_nop 1
    v_mul_f32 v112, v112, v19
    v_mul_f32 v113, v113, v19
    v_mul_f32 v114, v114, v19
    v_mul_f32 v115, v115, v19
    v_mul_f32 v116, v116, v19
    v_mul_f32 v117, v117, v19
    v_mul_f32 v118, v118, v19
    v_mul_f32 v119, v119, v19
    v_mul_f32 v120, v120, v19
    v_mul_f32 v121, v121, v19
    v_mul_f32 v122, v122, v19
    v_mul_f32 v123, v123, v19
    v_mul_f32 v124, v124, v19
    v_mul_f32 v125, v125, v19
    v_mul_f32 v126, v126, v19
    v_mul_f32 v127, v127, v19
    v_mul_f32 v128, v128, v19
    v_mul_f32 v129, v129, v19
    v_mul_f32 v130, v130, v19
    v_mul_f32 v131, v131, v19
    v_cvt_pk_bf16_f32 v24, v112, v113
    v_cvt_pk_bf16_f32 v25, v114, v115
    v_cvt_pk_bf16_f32 v26, v116, v117
    v_cvt_pk_bf16_f32 v27, v118, v119
    v_cvt_pk_bf16_f32 v28, v120, v121
    v_cvt_pk_bf16_f32 v29, v122, v123
    v_cvt_pk_bf16_f32 v30, v124, v125
    v_cvt_pk_bf16_f32 v31, v126, v127
    v_cvt_pk_bf16_f32 v32, v128, v129
    v_cvt_pk_bf16_f32 v33, v130, v131
    v_mov_b32 v34, 0
    v_mov_b32 v35, 0
    s_waitcnt vmcnt(0)
    s_nop 1
    v_mfma_f32_32x32x16_bf16 v[48:63], v[144:147], v[24:27], 0
    v_mfma_f32_32x32x16_bf16 v[48:63], v[148:151], v[28:31], v[48:63]
    v_mfma_f32_32x32x16_bf16 v[48:63], v[152:155], v[32:35], v[48:63]
    v_mfma_f32_32x32x16_bf16 v[64:79], v[156:159], v[24:27], 0
    v_mfma_f32_32x32x16_bf16 v[64:79], v[160:163], v[28:31], v[64:79]
    v_mfma_f32_32x32x16_bf16 v[64:79], v[164:167], v[32:35], v[64:79]
    v_mfma_f32_32x32x16_bf16 v[80:95], v[168:171], v[24:27], 0
    v_mfma_f32_32x32x16_bf16 v[80:95], v[172:175], v[28:31], v[80:95]
    v_mfma_f32_32x32x16_bf16 v[80:95], v[176:179], v[32:35], v[80:95]
    v_mfma_f32_32x32x16_bf16 v[96:111], v[180:183], v[24:27], 0
    v_mfma_f32_32x32x16_bf16 v[96:111], v[184:187], v[28:31], v[96:111]
    v_mfma_f32_32x32x16_bf16 v[96:111], v[188:191], v[32:35], v[96:111]
    s_lshl_b32 s28, s16, 18
    s_lshl_b32 s29, s17, 8
    s_add_u32 s28, s28, s29
    s_add_u32 s28, s28, 100663296
    v_lshlrev_b32 v4, 13, v2
    v_lshlrev_b32 v5, 4, v3
    v_add_u32 v4, v4, v5
    v_add_u32 v4, s28, v4
    s_nop 15
    s_nop 7
    v_cvt_pk_bf16_f32 v16, v48, v49
    v_cvt_pk_bf16_f32 v17, v50, v51
    v_cvt_pk_bf16_f32 v18, v52, v53
    v_cvt_pk_bf16_f32 v19, v54, v55
    v_cvt_pk_bf16_f32 v20, v56, v57
    v_cvt_pk_bf16_f32 v21, v58, v59
    v_cvt_pk_bf16_f32 v22, v60, v61
    v_cvt_pk_bf16_f32 v23, v62, v63
    s_nop 1
    v_permlane32_swap_b32 v16, v18
    v_permlane32_swap_b32 v17, v19
    v_permlane32_swap_b32 v20, v22
    v_permlane32_swap_b32 v21, v23
    s_nop 1
    buffer_store_dwordx4 v[16:19], v4, s[8:11], 0 offen offset:0 sc1
    buffer_store_dwordx4 v[20:23], v4, s[8:11], 0 offen offset:32 sc1
    v_cvt_pk_bf16_f32 v24, v64, v65
    v_cvt_pk_bf16_f32 v25, v66, v67
    v_cvt_pk_bf16_f32 v26, v68, v69
    v_cvt_pk_bf16_f32 v27, v70, v71
    v_cvt_pk_bf16_f32 v28, v72, v73
    v_cvt_pk_bf16_f32 v29, v74, v75
    v_cvt_pk_bf16_f32 v30, v76, v77
    v_cvt_pk_bf16_f32 v31, v78, v79
    s_nop 1
    v_permlane32_swap_b32 v24, v26
    v_permlane32_swap_b32 v25, v27
    v_permlane32_swap_b32 v28, v30
    v_permlane32_swap_b32 v29, v31
    s_nop 1
    buffer_store_dwordx4 v[24:27], v4, s[8:11], 0 offen offset:64 sc1
    buffer_store_dwordx4 v[28:31], v4, s[8:11], 0 offen offset:96 sc1
    v_cvt_pk_bf16_f32 v16, v80, v81
    v_cvt_pk_bf16_f32 v17, v82, v83
    v_cvt_pk_bf16_f32 v18, v84, v85
    v_cvt_pk_bf16_f32 v19, v86, v87
    v_cvt_pk_bf16_f32 v20, v88, v89
    v_cvt_pk_bf16_f32 v21, v90, v91
    v_cvt_pk_bf16_f32 v22, v92, v93
    v_cvt_pk_bf16_f32 v23, v94, v95
    s_nop 1
    v_permlane32_swap_b32 v16, v18
    v_permlane32_swap_b32 v17, v19
    v_permlane32_swap_b32 v20, v22
    v_permlane32_swap_b32 v21, v23
    s_nop 1
    buffer_store_dwordx4 v[16:19], v4, s[8:11], 0 offen offset:128 sc1
    buffer_store_dwordx4 v[20:23], v4, s[8:11], 0 offen offset:160 sc1
    v_cvt_pk_bf16_f32 v24, v96, v97
    v_cvt_pk_bf16_f32 v25, v98, v99
    v_cvt_pk_bf16_f32 v26, v100, v101
    v_cvt_pk_bf16_f32 v27, v102, v103
    v_cvt_pk_bf16_f32 v28, v104, v105
    v_cvt_pk_bf16_f32 v29, v106, v107
    v_cvt_pk_bf16_f32 v30, v108, v109
    v_cvt_pk_bf16_f32 v31, v110, v111
    s_nop 1
    v_permlane32_swap_b32 v24, v26
    v_permlane32_swap_b32 v25, v27
    v_permlane32_swap_b32 v28, v30
    v_permlane32_swap_b32 v29, v31
    s_nop 1
    buffer_store_dwordx4 v[24:27], v4, s[8:11], 0 offen offset:192 sc1
    buffer_store_dwordx4 v[28:31], v4, s[8:11], 0 offen offset:224 sc1
    s_waitcnt vmcnt(0)
    s_branch .k2_wloop2
.k2a_b:
    s_sub_u32 s16, s2, 512
    s_lshl_b32 s16, s16, 3
    v_lshrrev_b32 v2, 5, v0
    v_add_u32 v2, s16, v2
    v_and_b32 v3, 31, v0
    v_mul_u32_u24 v3, 40, v3
    s_mov_b32 s41, 0x3e64f92e
    s_movk_i32 s28, 3840
    v_mul_lo_u32 v4, v2, s28
    v_add_u32 v4, v4, v3
    v_add_u32 v4, 83886080, v4
    buffer_load_dwordx4 v[16:19], v4, s[8:11], 0 offen
    buffer_load_dwordx4 v[20:23], v4, s[8:11], 0 offen offset:16
    buffer_load_dwordx2 v[24:25], v4, s[8:11], 0 offen offset:32
    v_subrev_u32 v5, 0, v2
    v_max_i32 v5, 0, v5
    v_mul_lo_u32 v5, v5, s28
    v_add_u32 v5, v5, v3
    v_add_u32 v5, 83886080, v5
    buffer_load_dwordx4 v[28:31], v5, s[8:11], 0 offen offset:1280
    buffer_load_dwordx4 v[32:35], v5, s[8:11], 0 offen offset:1296
    buffer_load_dwordx2 v[36:37], v5, s[8:11], 0 offen offset:1312
    buffer_load_dwordx4 v[128:131], v5, s[8:11], 0 offen offset:2560
    buffer_load_dwordx4 v[132:135], v5, s[8:11], 0 offen offset:2576
    buffer_load_dwordx2 v[136:137], v5, s[8:11], 0 offen offset:2592
    v_subrev_u32 v5, 2, v2
    v_max_i32 v5, 0, v5
    v_mul_lo_u32 v5, v5, s28
    v_add_u32 v5, v5, v3
    v_add_u32 v5, 83886080, v5
    buffer_load_dwordx4 v[40:43], v5, s[8:11], 0 offen offset:1280
    buffer_load_dwordx4 v[44:47], v5, s[8:11], 0 offen offset:1296
    buffer_load_dwordx2 v[48:49], v5, s[8:11], 0 offen offset:1312
    buffer_load_dwordx4 v[140:143], v5, s[8:11], 0 offen offset:2560
    buffer_load_dwordx4 v[144:147], v5, s[8:11], 0 offen offset:2576
    buffer_load_dwordx2 v[148:149], v5, s[8:11], 0 offen offset:2592
    v_subrev_u32 v5, 4, v2
    v_max_i32 v5, 0, v5
    v_mul_lo_u32 v5, v5, s28
    v_add_u32 v5, v5, v3
    v_add_u32 v5, 83886080, v5
    buffer_load_dwordx4 v[52:55], v5, s[8:11], 0 offen offset:1280
    buffer_load_dwordx4 v[56:59], v5, s[8:11], 0 offen offset:1296
    buffer_load_dwordx2 v[60:61], v5, s[8:11], 0 offen offset:1312
    buffer_load_dwordx4 v[152:155], v5, s[8:11], 0 offen offset:2560
    buffer_load_dwordx4 v[156:159], v5, s[8:11], 0 offen offset:2576
    buffer_load_dwordx2 v[160:161], v5, s[8:11], 0 offen offset:2592
    v_subrev_u32 v5, 6, v2
    v_max_i32 v5, 0, v5
    v_mul_lo_u32 v5, v5, s28
    v_add_u32 v5, v5, v3
    v_add_u32 v5, 83886080, v5
    buffer_load_dwordx4 v[64:67], v5, s[8:11], 0 offen offset:1280
    buffer_load_dwordx4 v[68:71], v5, s[8:11], 0 offen offset:1296
    buffer_load_dwordx2 v[72:73], v5, s[8:11], 0 offen offset:1312
    buffer_load_dwordx4 v[164:167], v5, s[8:11], 0 offen offset:2560
    buffer_load_dwordx4 v[168:171], v5, s[8:11], 0 offen offset:2576
    buffer_load_dwordx2 v[172:173], v5, s[8:11], 0 offen offset:2592
    v_subrev_u32 v5, 8, v2
    v_max_i32 v5, 0, v5
    v_mul_lo_u32 v5, v5, s28
    v_add_u32 v5, v5, v3
    v_add_u32 v5, 83886080, v5
    buffer_load_dwordx4 v[76:79], v5, s[8:11], 0 offen offset:1280
    buffer_load_dwordx4 v[80:83], v5, s[8:11], 0 offen offset:1296
    buffer_load_dwordx2 v[84:85], v5, s[8:11], 0 offen offset:1312
    buffer_load_dwordx4 v[176:179], v5, s[8:11], 0 offen offset:2560
    buffer_load_dwordx4 v[180:183], v5, s[8:11], 0 offen offset:2576
    buffer_load_dwordx2 v[184:185], v5, s[8:11], 0 offen offset:2592
    v_subrev_u32 v5, 10, v2
    v_max_i32 v5, 0, v5
    v_mul_lo_u32 v5, v5, s28
    v_add_u32 v5, v5, v3
    v_add_u32 v5, 83886080, v5
    buffer_load_dwordx4 v[88:91], v5, s[8:11], 0 offen offset:1280
    buffer_load_dwordx4 v[92:95], v5, s[8:11], 0 offen offset:1296
    buffer_load_dwordx2 v[96:97], v5, s[8:11], 0 offen offset:1312
    buffer_load_dwordx4 v[188:191], v5, s[8:11], 0 offen offset:2560
    buffer_load_dwordx4 v[192:195], v5, s[8:11], 0 offen offset:2576
    buffer_load_dwordx2 v[196:197], v5, s[8:11], 0 offen offset:2592
    v_subrev_u32 v5, 12, v2
    v_max_i32 v5, 0, v5
    v_mul_lo_u32 v5, v5, s28
    v_add_u32 v5, v5, v3
    v_add_u32 v5, 83886080, v5
    buffer_load_dwordx4 v[100:103], v5, s[8:11], 0 offen offset:1280
    buffer_load_dwordx4 v[104:107], v5, s[8:11], 0 offen offset:1296
    buffer_load_dwordx2 v[108:109], v5, s[8:11], 0 offen offset:1312
    buffer_load_dwordx4 v[200:203], v5, s[8:11], 0 offen offset:2560
    buffer_load_dwordx4 v[204:207], v5, s[8:11], 0 offen offset:2576
    buffer_load_dwordx2 v[208:209], v5, s[8:11], 0 offen offset:2592
    v_subrev_u32 v5, 14, v2
    v_max_i32 v5, 0, v5
    v_mul_lo_u32 v5, v5, s28
    v_add_u32 v5, v5, v3
    v_add_u32 v5, 83886080, v5
    buffer_load_dwordx4 v[112:115], v5, s[8:11], 0 offen offset:1280
    buffer_load_dwordx4 v[116:119], v5, s[8:11], 0 offen offset:1296
    buffer_load_dwordx2 v[120:121], v5, s[8:11], 0 offen offset:1312
    buffer_load_dwordx4 v[212:215], v5, s[8:11], 0 offen offset:2560
    buffer_load_dwordx4 v[216:219], v5, s[8:11], 0 offen offset:2576
    buffer_load_dwordx2 v[220:221], v5, s[8:11], 0 offen offset:2592
    s_waitcnt vmcnt(0)
    v_mov_b32 v224, 0
    v_dot2_f32_bf16 v224, v16, v28, v224
    v_dot2_f32_bf16 v224, v17, v29, v224
    v_dot2_f32_bf16 v224, v18, v30, v224
    v_dot2_f32_bf16 v224, v19, v31, v224
    v_dot2_f32_bf16 v224, v20, v32, v224
    v_dot2_f32_bf16 v224, v21, v33, v224
    v_dot2_f32_bf16 v224, v22, v34, v224
    v_dot2_f32_bf16 v224, v23, v35, v224
    v_dot2_f32_bf16 v224, v24, v36, v224
    v_dot2_f32_bf16 v224, v25, v37, v224
    v_mov_b32 v225, 0
    v_dot2_f32_bf16 v225, v16, v40, v225
    v_dot2_f32_bf16 v225, v17, v41, v225
    v_dot2_f32_bf16 v225, v18, v42, v225
    v_dot2_f32_bf16 v225, v19, v43, v225
    v_dot2_f32_bf16 v225, v20, v44, v225
    v_dot2_f32_bf16 v225, v21, v45, v225
    v_dot2_f32_bf16 v225, v22, v46, v225
    v_dot2_f32_bf16 v225, v23, v47, v225
    v_dot2_f32_bf16 v225, v24, v48, v225
    v_dot2_f32_bf16 v225, v25, v49, v225
    v_mov_b32 v226, 0
    v_dot2_f32_bf16 v226, v16, v52, v226
    v_dot2_f32_bf16 v226, v17, v53, v226
    v_dot2_f32_bf16 v226, v18, v54, v226
    v_dot2_f32_bf16 v226, v19, v55, v226
    v_dot2_f32_bf16 v226, v20, v56, v226
    v_dot2_f32_bf16 v226, v21, v57, v226
    v_dot2_f32_bf16 v226, v22, v58, v226
    v_dot2_f32_bf16 v226, v23, v59, v226
    v_dot2_f32_bf16 v226, v24, v60, v226
    v_dot2_f32_bf16 v226, v25, v61, v226
    v_mov_b32 v227, 0
    v_dot2_f32_bf16 v227, v16, v64, v227
    v_dot2_f32_bf16 v227, v17, v65, v227
    v_dot2_f32_bf16 v227, v18, v66, v227
    v_dot2_f32_bf16 v227, v19, v67, v227
    v_dot2_f32_bf16 v227, v20, v68, v227
    v_dot2_f32_bf16 v227, v21, v69, v227
    v_dot2_f32_bf16 v227, v22, v70, v227
    v_dot2_f32_bf16 v227, v23, v71, v227
    v_dot2_f32_bf16 v227, v24, v72, v227
    v_dot2_f32_bf16 v227, v25, v73, v227
    v_mov_b32 v228, 0
    v_dot2_f32_bf16 v228, v16, v76, v228
    v_dot2_f32_bf16 v228, v17, v77, v228
    v_dot2_f32_bf16 v228, v18, v78, v228
    v_dot2_f32_bf16 v228, v19, v79, v228
    v_dot2_f32_bf16 v228, v20, v80, v228
    v_dot2_f32_bf16 v228, v21, v81, v228
    v_dot2_f32_bf16 v228, v22, v82, v228
    v_dot2_f32_bf16 v228, v23, v83, v228
    v_dot2_f32_bf16 v228, v24, v84, v228
    v_dot2_f32_bf16 v228, v25, v85, v228
    v_mov_b32 v229, 0
    v_dot2_f32_bf16 v229, v16, v88, v229
    v_dot2_f32_bf16 v229, v17, v89, v229
    v_dot2_f32_bf16 v229, v18, v90, v229
    v_dot2_f32_bf16 v229, v19, v91, v229
    v_dot2_f32_bf16 v229, v20, v92, v229
    v_dot2_f32_bf16 v229, v21, v93, v229
    v_dot2_f32_bf16 v229, v22, v94, v229
    v_dot2_f32_bf16 v229, v23, v95, v229
    v_dot2_f32_bf16 v229, v24, v96, v229
    v_dot2_f32_bf16 v229, v25, v97, v229
    v_mov_b32 v230, 0
    v_dot2_f32_bf16 v230, v16, v100, v230
    v_dot2_f32_bf16 v230, v17, v101, v230
    v_dot2_f32_bf16 v230, v18, v102, v230
    v_dot2_f32_bf16 v230, v19, v103, v230
    v_dot2_f32_bf16 v230, v20, v104, v230
    v_dot2_f32_bf16 v230, v21, v105, v230
    v_dot2_f32_bf16 v230, v22, v106, v230
    v_dot2_f32_bf16 v230, v23, v107, v230
    v_dot2_f32_bf16 v230, v24, v108, v230
    v_dot2_f32_bf16 v230, v25, v109, v230
    v_mov_b32 v231, 0
    v_dot2_f32_bf16 v231, v16, v112, v231
    v_dot2_f32_bf16 v231, v17, v113, v231
    v_dot2_f32_bf16 v231, v18, v114, v231
    v_dot2_f32_bf16 v231, v19, v115, v231
    v_dot2_f32_bf16 v231, v20, v116, v231
    v_dot2_f32_bf16 v231, v21, v117, v231
    v_dot2_f32_bf16 v231, v22, v118, v231
    v_dot2_f32_bf16 v231, v23, v119, v231
    v_dot2_f32_bf16 v231, v24, v120, v231
    v_dot2_f32_bf16 v231, v25, v121, v231
    v_cvt_pk_bf16_f32 v6, v224, v225
    v_lshlrev_b32 v224, 16, v6
    v_and_b32 v225, 0xffff0000, v6
    v_cvt_pk_bf16_f32 v6, v226, v227
    v_lshlrev_b32 v226, 16, v6
    v_and_b32 v227, 0xffff0000, v6
    v_cvt_pk_bf16_f32 v6, v228, v229
    v_lshlrev_b32 v228, 16, v6
    v_and_b32 v229, 0xffff0000, v6
    v_cvt_pk_bf16_f32 v6, v230, v231
    v_lshlrev_b32 v230, 16, v6
    v_and_b32 v231, 0xffff0000, v6
    v_mul_f32 v224, s41, v224
    v_mul_f32 v225, s41, v225
    v_mul_f32 v226, s41, v226
    v_mul_f32 v227, s41, v227
    v_mul_f32 v228, s41, v228
    v_mul_f32 v229, s41, v229
    v_mul_f32 v230, s41, v230
    v_mul_f32 v231, s41, v231
    v_cvt_pk_bf16_f32 v6, v224, v225
    v_lshlrev_b32 v224, 16, v6
    v_and_b32 v225, 0xffff0000, v6
    v_cvt_pk_bf16_f32 v6, v226, v227
    v_lshlrev_b32 v226, 16, v6
    v_and_b32 v227, 0xffff0000, v6
    v_cvt_pk_bf16_f32 v6, v228, v229
    v_lshlrev_b32 v228, 16, v6
    v_and_b32 v229, 0xffff0000, v6
    v_cvt_pk_bf16_f32 v6, v230, v231
    v_lshlrev_b32 v230, 16, v6
    v_and_b32 v231, 0xffff0000, v6
    v_mov_b32 v7, 0xf149f2ca
    v_cmp_le_u32 vcc, 2, v2
    s_nop 1
    v_cndmask_b32 v225, v7, v225, vcc
    v_cmp_le_u32 vcc, 4, v2
    s_nop 1
    v_cndmask_b32 v226, v7, v226, vcc
    v_cmp_le_u32 vcc, 6, v2
    s_nop 1
    v_cndmask_b32 v227, v7, v227, vcc
    v_cmp_le_u32 vcc, 8, v2
    s_nop 1
    v_cndmask_b32 v228, v7, v228, vcc
    v_cmp_le_u32 vcc, 10, v2
    s_nop 1
    v_cndmask_b32 v229, v7, v229, vcc
    v_cmp_le_u32 vcc, 12, v2
    s_nop 1
    v_cndmask_b32 v230, v7, v230, vcc
    v_cmp_le_u32 vcc, 14, v2
    s_nop 1
    v_cndmask_b32 v231, v7, v231, vcc
    v_max3_f32 v8, v224, v225, v226
    v_max3_f32 v8, v8, v227, v228
    v_max3_f32 v8, v8, v229, v230
    v_max_f32 v8, v8, v231
    v_sub_f32 v224, v224, v8
    v_sub_f32 v225, v225, v8
    v_sub_f32 v226, v226, v8
    v_sub_f32 v227, v227, v8
    v_sub_f32 v228, v228, v8
    v_sub_f32 v229, v229, v8
    v_sub_f32 v230, v230, v8
    v_sub_f32 v231, v231, v8
    v_mul_f32 v224, s40, v224
    v_mul_f32 v225, s40, v225
    v_mul_f32 v226, s40, v226
    v_mul_f32 v227, s40, v227
    v_mul_f32 v228, s40, v228
    v_mul_f32 v229, s40, v229
    v_mul_f32 v230, s40, v230
    v_mul_f32 v231, s40, v231
    v_exp_f32 v224, v224
    v_exp_f32 v225, v225
    v_exp_f32 v226, v226
    v_exp_f32 v227, v227
    v_exp_f32 v228, v228
    v_exp_f32 v229, v229
    v_exp_f32 v230, v230
    v_exp_f32 v231, v231
    s_nop 1
    v_add_f32 v8, v224, v225
    v_add_f32 v8, v8, v226
    v_add_f32 v8, v8, v227
    v_add_f32 v8, v8, v228
    v_add_f32 v8, v8, v229
    v_add_f32 v8, v8, v230
    v_add_f32 v8, v8, v231
    v_rcp_f32 v8, v8
    s_nop 1
    v_mul_f32 v224, v224, v8
    v_mul_f32 v225, v225, v8
    v_mul_f32 v226, v226, v8
    v_mul_f32 v227, v227, v8
    v_mul_f32 v228, v228, v8
    v_mul_f32 v229, v229, v8
    v_mul_f32 v230, v230, v8
    v_mul_f32 v231, v231, v8
    v_cvt_pk_bf16_f32 v6, v224, v225
    v_lshlrev_b32 v224, 16, v6
    v_and_b32 v225, 0xffff0000, v6
    v_cvt_pk_bf16_f32 v6, v226, v227
    v_lshlrev_b32 v226, 16, v6
    v_and_b32 v227, 0xffff0000, v6
    v_cvt_pk_bf16_f32 v6, v228, v229
    v_lshlrev_b32 v228, 16, v6
    v_and_b32 v229, 0xffff0000, v6
    v_cvt_pk_bf16_f32 v6, v230, v231
    v_lshlrev_b32 v230, 16, v6
    v_and_b32 v231, 0xffff0000, v6
    v_lshlrev_b32 v6, 16, v128
    v_and_b32 v7, 0xffff0000, v128
    v_mul_f32 v232, v224, v6
    v_mul_f32 v233, v224, v7
    v_lshlrev_b32 v6, 16, v129
    v_and_b32 v7, 0xffff0000, v129
    v_mul_f32 v234, v224, v6
    v_mul_f32 v235, v224, v7
    v_lshlrev_b32 v6, 16, v130
    v_and_b32 v7, 0xffff0000, v130
    v_mul_f32 v236, v224, v6
    v_mul_f32 v237, v224, v7
    v_lshlrev_b32 v6, 16, v131
    v_and_b32 v7, 0xffff0000, v131
    v_mul_f32 v238, v224, v6
    v_mul_f32 v239, v224, v7
    v_lshlrev_b32 v6, 16, v132
    v_and_b32 v7, 0xffff0000, v132
    v_mul_f32 v240, v224, v6
    v_mul_f32 v241, v224, v7
    v_lshlrev_b32 v6, 16, v133
    v_and_b32 v7, 0xffff0000, v133
    v_mul_f32 v242, v224, v6
    v_mul_f32 v243, v224, v7
    v_lshlrev_b32 v6, 16, v134
    v_and_b32 v7, 0xffff0000, v134
    v_mul_f32 v244, v224, v6
    v_mul_f32 v245, v224, v7
    v_lshlrev_b32 v6, 16, v135
    v_and_b32 v7, 0xffff0000, v135
    v_mul_f32 v246, v224, v6
    v_mul_f32 v247, v224, v7
    v_lshlrev_b32 v6, 16, v136
    v_and_b32 v7, 0xffff0000, v136
    v_mul_f32 v248, v224, v6
    v_mul_f32 v249, v224, v7
    v_lshlrev_b32 v6, 16, v137
    v_and_b32 v7, 0xffff0000, v137
    v_mul_f32 v250, v224, v6
    v_mul_f32 v251, v224, v7
    v_lshlrev_b32 v6, 16, v140
    v_and_b32 v7, 0xffff0000, v140
    v_fma_f32 v232, v225, v6, v232
    v_fma_f32 v233, v225, v7, v233
    v_lshlrev_b32 v6, 16, v141
    v_and_b32 v7, 0xffff0000, v141
    v_fma_f32 v234, v225, v6, v234
    v_fma_f32 v235, v225, v7, v235
    v_lshlrev_b32 v6, 16, v142
    v_and_b32 v7, 0xffff0000, v142
    v_fma_f32 v236, v225, v6, v236
    v_fma_f32 v237, v225, v7, v237
    v_lshlrev_b32 v6, 16, v143
    v_and_b32 v7, 0xffff0000, v143
    v_fma_f32 v238, v225, v6, v238
    v_fma_f32 v239, v225, v7, v239
    v_lshlrev_b32 v6, 16, v144
    v_and_b32 v7, 0xffff0000, v144
    v_fma_f32 v240, v225, v6, v240
    v_fma_f32 v241, v225, v7, v241
    v_lshlrev_b32 v6, 16, v145
    v_and_b32 v7, 0xffff0000, v145
    v_fma_f32 v242, v225, v6, v242
    v_fma_f32 v243, v225, v7, v243
    v_lshlrev_b32 v6, 16, v146
    v_and_b32 v7, 0xffff0000, v146
    v_fma_f32 v244, v225, v6, v244
    v_fma_f32 v245, v225, v7, v245
    v_lshlrev_b32 v6, 16, v147
    v_and_b32 v7, 0xffff0000, v147
    v_fma_f32 v246, v225, v6, v246
    v_fma_f32 v247, v225, v7, v247
    v_lshlrev_b32 v6, 16, v148
    v_and_b32 v7, 0xffff0000, v148
    v_fma_f32 v248, v225, v6, v248
    v_fma_f32 v249, v225, v7, v249
    v_lshlrev_b32 v6, 16, v149
    v_and_b32 v7, 0xffff0000, v149
    v_fma_f32 v250, v225, v6, v250
    v_fma_f32 v251, v225, v7, v251
    v_lshlrev_b32 v6, 16, v152
    v_and_b32 v7, 0xffff0000, v152
    v_fma_f32 v232, v226, v6, v232
    v_fma_f32 v233, v226, v7, v233
    v_lshlrev_b32 v6, 16, v153
    v_and_b32 v7, 0xffff0000, v153
    v_fma_f32 v234, v226, v6, v234
    v_fma_f32 v235, v226, v7, v235
    v_lshlrev_b32 v6, 16, v154
    v_and_b32 v7, 0xffff0000, v154
    v_fma_f32 v236, v226, v6, v236
    v_fma_f32 v237, v226, v7, v237
    v_lshlrev_b32 v6, 16, v155
    v_and_b32 v7, 0xffff0000, v155
    v_fma_f32 v238, v226, v6, v238
    v_fma_f32 v239, v226, v7, v239
    v_lshlrev_b32 v6, 16, v156
    v_and_b32 v7, 0xffff0000, v156
    v_fma_f32 v240, v226, v6, v240
    v_fma_f32 v241, v226, v7, v241
    v_lshlrev_b32 v6, 16, v157
    v_and_b32 v7, 0xffff0000, v157
    v_fma_f32 v242, v226, v6, v242
    v_fma_f32 v243, v226, v7, v243
    v_lshlrev_b32 v6, 16, v158
    v_and_b32 v7, 0xffff0000, v158
    v_fma_f32 v244, v226, v6, v244
    v_fma_f32 v245, v226, v7, v245
    v_lshlrev_b32 v6, 16, v159
    v_and_b32 v7, 0xffff0000, v159
    v_fma_f32 v246, v226, v6, v246
    v_fma_f32 v247, v226, v7, v247
    v_lshlrev_b32 v6, 16, v160
    v_and_b32 v7, 0xffff0000, v160
    v_fma_f32 v248, v226, v6, v248
    v_fma_f32 v249, v226, v7, v249
    v_lshlrev_b32 v6, 16, v161
    v_and_b32 v7, 0xffff0000, v161
    v_fma_f32 v250, v226, v6, v250
    v_fma_f32 v251, v226, v7, v251
    v_lshlrev_b32 v6, 16, v164
    v_and_b32 v7, 0xffff0000, v164
    v_fma_f32 v232, v227, v6, v232
    v_fma_f32 v233, v227, v7, v233
    v_lshlrev_b32 v6, 16, v165
    v_and_b32 v7, 0xffff0000, v165
    v_fma_f32 v234, v227, v6, v234
    v_fma_f32 v235, v227, v7, v235
    v_lshlrev_b32 v6, 16, v166
    v_and_b32 v7, 0xffff0000, v166
    v_fma_f32 v236, v227, v6, v236
    v_fma_f32 v237, v227, v7, v237
    v_lshlrev_b32 v6, 16, v167
    v_and_b32 v7, 0xffff0000, v167
    v_fma_f32 v238, v227, v6, v238
    v_fma_f32 v239, v227, v7, v239
    v_lshlrev_b32 v6, 16, v168
    v_and_b32 v7, 0xffff0000, v168
    v_fma_f32 v240, v227, v6, v240
    v_fma_f32 v241, v227, v7, v241
    v_lshlrev_b32 v6, 16, v169
    v_and_b32 v7, 0xffff0000, v169
    v_fma_f32 v242, v227, v6, v242
    v_fma_f32 v243, v227, v7, v243
    v_lshlrev_b32 v6, 16, v170
    v_and_b32 v7, 0xffff0000, v170
    v_fma_f32 v244, v227, v6, v244
    v_fma_f32 v245, v227, v7, v245
    v_lshlrev_b32 v6, 16, v171
    v_and_b32 v7, 0xffff0000, v171
    v_fma_f32 v246, v227, v6, v246
    v_fma_f32 v247, v227, v7, v247
    v_lshlrev_b32 v6, 16, v172
    v_and_b32 v7, 0xffff0000, v172
    v_fma_f32 v248, v227, v6, v248
    v_fma_f32 v249, v227, v7, v249
    v_lshlrev_b32 v6, 16, v173
    v_and_b32 v7, 0xffff0000, v173
    v_fma_f32 v250, v227, v6, v250
    v_fma_f32 v251, v227, v7, v251
    v_lshlrev_b32 v6, 16, v176
    v_and_b32 v7, 0xffff0000, v176
    v_fma_f32 v232, v228, v6, v232
    v_fma_f32 v233, v228, v7, v233
    v_lshlrev_b32 v6, 16, v177
    v_and_b32 v7, 0xffff0000, v177
    v_fma_f32 v234, v228, v6, v234
    v_fma_f32 v235, v228, v7, v235
    v_lshlrev_b32 v6, 16, v178
    v_and_b32 v7, 0xffff0000, v178
    v_fma_f32 v236, v228, v6, v236
    v_fma_f32 v237, v228, v7, v237
    v_lshlrev_b32 v6, 16, v179
    v_and_b32 v7, 0xffff0000, v179
    v_fma_f32 v238, v228, v6, v238
    v_fma_f32 v239, v228, v7, v239
    v_lshlrev_b32 v6, 16, v180
    v_and_b32 v7, 0xffff0000, v180
    v_fma_f32 v240, v228, v6, v240
    v_fma_f32 v241, v228, v7, v241
    v_lshlrev_b32 v6, 16, v181
    v_and_b32 v7, 0xffff0000, v181
    v_fma_f32 v242, v228, v6, v242
    v_fma_f32 v243, v228, v7, v243
    v_lshlrev_b32 v6, 16, v182
    v_and_b32 v7, 0xffff0000, v182
    v_fma_f32 v244, v228, v6, v244
    v_fma_f32 v245, v228, v7, v245
    v_lshlrev_b32 v6, 16, v183
    v_and_b32 v7, 0xffff0000, v183
    v_fma_f32 v246, v228, v6, v246
    v_fma_f32 v247, v228, v7, v247
    v_lshlrev_b32 v6, 16, v184
    v_and_b32 v7, 0xffff0000, v184
    v_fma_f32 v248, v228, v6, v248
    v_fma_f32 v249, v228, v7, v249
    v_lshlrev_b32 v6, 16, v185
    v_and_b32 v7, 0xffff0000, v185
    v_fma_f32 v250, v228, v6, v250
    v_fma_f32 v251, v228, v7, v251
    v_lshlrev_b32 v6, 16, v188
    v_and_b32 v7, 0xffff0000, v188
    v_fma_f32 v232, v229, v6, v232
    v_fma_f32 v233, v229, v7, v233
    v_lshlrev_b32 v6, 16, v189
    v_and_b32 v7, 0xffff0000, v189
    v_fma_f32 v234, v229, v6, v234
    v_fma_f32 v235, v229, v7, v235
    v_lshlrev_b32 v6, 16, v190
    v_and_b32 v7, 0xffff0000, v190
    v_fma_f32 v236, v229, v6, v236
    v_fma_f32 v237, v229, v7, v237
    v_lshlrev_b32 v6, 16, v191
    v_and_b32 v7, 0xffff0000, v191
    v_fma_f32 v238, v229, v6, v238
    v_fma_f32 v239, v229, v7, v239
    v_lshlrev_b32 v6, 16, v192
    v_and_b32 v7, 0xffff0000, v192
    v_fma_f32 v240, v229, v6, v240
    v_fma_f32 v241, v229, v7, v241
    v_lshlrev_b32 v6, 16, v193
    v_and_b32 v7, 0xffff0000, v193
    v_fma_f32 v242, v229, v6, v242
    v_fma_f32 v243, v229, v7, v243
    v_lshlrev_b32 v6, 16, v194
    v_and_b32 v7, 0xffff0000, v194
    v_fma_f32 v244, v229, v6, v244
    v_fma_f32 v245, v229, v7, v245
    v_lshlrev_b32 v6, 16, v195
    v_and_b32 v7, 0xffff0000, v195
    v_fma_f32 v246, v229, v6, v246
    v_fma_f32 v247, v229, v7, v247
    v_lshlrev_b32 v6, 16, v196
    v_and_b32 v7, 0xffff0000, v196
    v_fma_f32 v248, v229, v6, v248
    v_fma_f32 v249, v229, v7, v249
    v_lshlrev_b32 v6, 16, v197
    v_and_b32 v7, 0xffff0000, v197
    v_fma_f32 v250, v229, v6, v250
    v_fma_f32 v251, v229, v7, v251
    v_lshlrev_b32 v6, 16, v200
    v_and_b32 v7, 0xffff0000, v200
    v_fma_f32 v232, v230, v6, v232
    v_fma_f32 v233, v230, v7, v233
    v_lshlrev_b32 v6, 16, v201
    v_and_b32 v7, 0xffff0000, v201
    v_fma_f32 v234, v230, v6, v234
    v_fma_f32 v235, v230, v7, v235
    v_lshlrev_b32 v6, 16, v202
    v_and_b32 v7, 0xffff0000, v202
    v_fma_f32 v236, v230, v6, v236
    v_fma_f32 v237, v230, v7, v237
    v_lshlrev_b32 v6, 16, v203
    v_and_b32 v7, 0xffff0000, v203
    v_fma_f32 v238, v230, v6, v238
    v_fma_f32 v239, v230, v7, v239
    v_lshlrev_b32 v6, 16, v204
    v_and_b32 v7, 0xffff0000, v204
    v_fma_f32 v240, v230, v6, v240
    v_fma_f32 v241, v230, v7, v241
    v_lshlrev_b32 v6, 16, v205
    v_and_b32 v7, 0xffff0000, v205
    v_fma_f32 v242, v230, v6, v242
    v_fma_f32 v243, v230, v7, v243
    v_lshlrev_b32 v6, 16, v206
    v_and_b32 v7, 0xffff0000, v206
    v_fma_f32 v244, v230, v6, v244
    v_fma_f32 v245, v230, v7, v245
    v_lshlrev_b32 v6, 16, v207
    v_and_b32 v7, 0xffff0000, v207
    v_fma_f32 v246, v230, v6, v246
    v_fma_f32 v247, v230, v7, v247
    v_lshlrev_b32 v6, 16, v208
    v_and_b32 v7, 0xffff0000, v208
    v_fma_f32 v248, v230, v6, v248
    v_fma_f32 v249, v230, v7, v249
    v_lshlrev_b32 v6, 16, v209
    v_and_b32 v7, 0xffff0000, v209
    v_fma_f32 v250, v230, v6, v250
    v_fma_f32 v251, v230, v7, v251
    v_lshlrev_b32 v6, 16, v212
    v_and_b32 v7, 0xffff0000, v212
    v_fma_f32 v232, v231, v6, v232
    v_fma_f32 v233, v231, v7, v233
    v_lshlrev_b32 v6, 16, v213
    v_and_b32 v7, 0xffff0000, v213
    v_fma_f32 v234, v231, v6, v234
    v_fma_f32 v235, v231, v7, v235
    v_lshlrev_b32 v6, 16, v214
    v_and_b32 v7, 0xffff0000, v214
    v_fma_f32 v236, v231, v6, v236
    v_fma_f32 v237, v231, v7, v237
    v_lshlrev_b32 v6, 16, v215
    v_and_b32 v7, 0xffff0000, v215
    v_fma_f32 v238, v231, v6, v238
    v_fma_f32 v239, v231, v7, v239
    v_lshlrev_b32 v6, 16, v216
    v_and_b32 v7, 0xffff0000, v216
    v_fma_f32 v240, v231, v6, v240
    v_fma_f32 v241, v231, v7, v241
    v_lshlrev_b32 v6, 16, v217
    v_and_b32 v7, 0xffff0000, v217
    v_fma_f32 v242, v231, v6, v242
    v_fma_f32 v243, v231, v7, v243
    v_lshlrev_b32 v6, 16, v218
    v_and_b32 v7, 0xffff0000, v218
    v_fma_f32 v244, v231, v6, v244
    v_fma_f32 v245, v231, v7, v245
    v_lshlrev_b32 v6, 16, v219
    v_and_b32 v7, 0xffff0000, v219
    v_fma_f32 v246, v231, v6, v246
    v_fma_f32 v247, v231, v7, v247
    v_lshlrev_b32 v6, 16, v220
    v_and_b32 v7, 0xffff0000, v220
    v_fma_f32 v248, v231, v6, v248
    v_fma_f32 v249, v231, v7, v249
    v_lshlrev_b32 v6, 16, v221
    v_and_b32 v7, 0xffff0000, v221
    v_fma_f32 v250, v231, v6, v250
    v_fma_f32 v251, v231, v7, v251
    v_cvt_pk_bf16_f32 v16, v232, v233
    v_cvt_pk_bf16_f32 v17, v234, v235
    v_cvt_pk_bf16_f32 v18, v236, v237
    v_cvt_pk_bf16_f32 v19, v238, v239
    v_cvt_pk_bf16_f32 v20, v240, v241
    v_cvt_pk_bf16_f32 v21, v242, v243
    v_cvt_pk_bf16_f32 v22, v244, v245
    v_cvt_pk_bf16_f32 v23, v246, v247
    v_cvt_pk_bf16_f32 v24, v248, v249
    v_cvt_pk_bf16_f32 v25, v250, v251
    v_mul_u32_u24 v4, 1280, v2
    v_add_u32 v4, v4, v3
    v_add_u32 v4, 117440512, v4
    buffer_store_dwordx4 v[16:19], v4, s[8:11], 0 offen sc1
    buffer_store_dwordx4 v[20:23], v4, s[8:11], 0 offen offset:16 sc1
    buffer_store_dwordx2 v[24:25], v4, s[8:11], 0 offen offset:32 sc1
    s_waitcnt vmcnt(0)
    s_branch .k2_wloop2
.k2_wexit:
.k2_exit:
    s_endpgm
.k2_chain:
    s_waitcnt vmcnt(0) lgkmcnt(0)
    s_barrier
    s_cmp_lg_u32 s96, 0
    s_cbranch_scc1 .at_18
    s_mov_b64 exec, 1

    v_mov_b32 v1, s98
    v_mov_b32 v2, 128
    buffer_atomic_add v1, v2, s[92:95], 0 offen sc0
    s_waitcnt vmcnt(0)
    v_mov_b32 v2, 122880
    ds_write_b32 v2, v1
    s_mov_b64 exec, -1

.at_18:
    s_waitcnt lgkmcnt(0)
    s_barrier
    v_mov_b32 v2, 122880
    ds_read_b32 v1, v2
    s_waitcnt lgkmcnt(0)
    v_readfirstlane_b32 s4, v1
    s_mov_b32 s90, 0

    s_load_dwordx2 s[4:5], s[0:1], 96
    s_load_dwordx2 s[6:7], s[0:1], 8
    s_mov_b32 s18, s96
    v_and_b32 v1, 63, v0
    v_and_b32 v2, 15, v1
    v_lshrrev_b32 v3, 4, v1
    s_waitcnt lgkmcnt(0)

    s_mov_b32 s8, s4
    s_mov_b32 s9, s5
    s_mov_b32 s10, 268435456
    s_mov_b32 s11, 0x00020000
    s_mov_b32 s12, s6
    s_mov_b32 s13, s7
    s_mov_b32 s14, 10240
    s_mov_b32 s15, 0x00020000
    s_lshr_b32 s16, s99, 1
    s_and_b32 s17, s99, 1
    s_lshr_b32 s36, s99, 5
    s_and_b32 s37, s99, 31
    s_mov_b32 s24, 0x33333333
    s_mov_b32 s25, 0x33333333
    s_cmp_eq_u32 s18, 3
    s_cselect_b32 s26, -1, 0x00ff00ff
    s_mov_b32 s27, s26
    s_and_b32 s34, s26, 65535
    s_and_b32 s35, s26, 0
    s_and_b32 s38, s26, 65535
    s_and_b32 s39, s26, 0
    s_mov_b32 s40, 0x3fb8aa3b
    s_mov_b32 s41, 0x3fb8aa3b
    s_mov_b32 s42, 0x3db504f3
    s_mov_b32 s43, 0x3db504f3
    s_mov_b32 s44, 2560
    s_mov_b32 s45, 81920
    s_mov_b32 s46, 327680
    s_mul_i32 s50, s36, 163840
    s_sub_u32 s55, 245760, s50

    s_add_u32 s51, s50, 4096
    s_add_u32 s56, s55, 4096
    s_add_u32 s52, s50, 8192
    s_add_u32 s57, s55, 8192
    s_add_u32 s53, s50, 12288
    s_add_u32 s58, s55, 12288
    s_add_u32 s54, s50, 16384
    s_add_u32 s59, s55, 16384
    v_lshrrev_b32 v4, 2, v2
    v_lshlrev_b32 v4, 3, v4
    v_and_b32 v5, 3, v2
    v_add_u32 v20, v4, v5
    s_lshl_b32 s28, s16, 7
    s_lshl_b32 s29, s18, 5
    s_add_u32 s28, s28, s29
    v_add_u32 v4, s28, v20
    v_mul_u32_u24 v4, 1280, v4
    v_lshlrev_b32 v21, 4, v3
    v_add_u32 v4, v4, v21
    v_add_u32 v4, 0, v4
    v_add_u32 v5, 5120, v4
    v_add_u32 v6, 5242880, v4
    v_add_u32 v7, 5248000, v4
    s_lshl_b32 s28, s16, 7
    s_lshl_b32 s29, s17, 6
    s_add_u32 s28, s28, s29
    s_lshl_b32 s29, s18, 4
    s_add_u32 s30, s28, s29
    v_add_u32 v8, s30, v2
    v_mul_u32_u24 v8, 1280, v8
    v_add_u32 v8, v8, v21
    v_add_u32 v8, 10485760, v8

    buffer_load_dwordx4 a[0:3], v4, s[8:11], 0 offen offset:0
    buffer_load_dwordx4 a[4:7], v4, s[8:11], 0 offen offset:64
    buffer_load_dwordx4 a[8:11], v4, s[8:11], 0 offen offset:128
    buffer_load_dwordx4 a[12:15], v4, s[8:11], 0 offen offset:192
    buffer_load_dwordx4 a[16:19], v4, s[8:11], 0 offen offset:256
    buffer_load_dwordx4 a[20:23], v4, s[8:11], 0 offen offset:320
    buffer_load_dwordx4 a[24:27], v4, s[8:11], 0 offen offset:384
    buffer_load_dwordx4 a[28:31], v4, s[8:11], 0 offen offset:448
    buffer_load_dwordx4 a[32:35], v4, s[8:11], 0 offen offset:512
    buffer_load_dwordx4 a[36:39], v4, s[8:11], 0 offen offset:576
    buffer_load_dwordx4 a[40:43], v4, s[8:11], 0 offen offset:640
    buffer_load_dwordx4 a[44:47], v4, s[8:11], 0 offen offset:704
    buffer_load_dwordx4 a[48:51], v4, s[8:11], 0 offen offset:768
    buffer_load_dwordx4 a[52:55], v4, s[8:11], 0 offen offset:832
    buffer_load_dwordx4 a[56:59], v4, s[8:11], 0 offen offset:896
    buffer_load_dwordx4 a[60:63], v4, s[8:11], 0 offen offset:960
    buffer_load_dwordx4 a[64:67], v4, s[8:11], 0 offen offset:1024
    buffer_load_dwordx4 a[68:71], v4, s[8:11], 0 offen offset:1088
    buffer_load_dwordx4 a[72:75], v4, s[8:11], 0 offen offset:1152
    buffer_load_dwordx4 a[76:79], v4, s[8:11], 0 offen offset:1216
    buffer_load_dwordx4 a[80:83], v5, s[8:11], 0 offen offset:0
    buffer_load_dwordx4 a[84:87], v5, s[8:11], 0 offen offset:64
    buffer_load_dwordx4 a[88:91], v5, s[8:11], 0 offen offset:128
    buffer_load_dwordx4 a[92:95], v5, s[8:11], 0 offen offset:192
    buffer_load_dwordx4 a[96:99], v5, s[8:11], 0 offen offset:256
    buffer_load_dwordx4 a[100:103], v5, s[8:11], 0 offen offset:320
    buffer_load_dwordx4 a[104:107], v5, s[8:11], 0 offen offset:384
    buffer_load_dwordx4 a[108:111], v5, s[8:11], 0 offen offset:448
    buffer_load_dwordx4 a[112:115], v5, s[8:11], 0 offen offset:512
    buffer_load_dwordx4 a[116:119], v5, s[8:11], 0 offen offset:576
    buffer_load_dwordx4 a[120:123], v5, s[8:11], 0 offen offset:640
    buffer_load_dwordx4 a[124:127], v5, s[8:11], 0 offen offset:704
    buffer_load_dwordx4 a[128:131], v5, s[8:11], 0 offen offset:768
    buffer_load_dwordx4 a[132:135], v5, s[8:11], 0 offen offset:832
    buffer_load_dwordx4 a[136:139], v5, s[8:11], 0 offen offset:896
    buffer_load_dwordx4 a[140:143], v5, s[8:11], 0 offen offset:960
    buffer_load_dwordx4 a[144:147], v5, s[8:11], 0 offen offset:1024
    buffer_load_dwordx4 a[148:151], v5, s[8:11], 0 offen offset:1088
    buffer_load_dwordx4 a[152:155], v5, s[8:11], 0 offen offset:1152
    buffer_load_dwordx4 a[156:159], v5, s[8:11], 0 offen offset:1216
    s_waitcnt vmcnt(0)
    buffer_load_dwordx4 a[160:163], v6, s[8:11], 0 offen offset:0
    buffer_load_dwordx4 a[164:167], v6, s[8:11], 0 offen offset:64
    buffer_load_dwordx4 a[168:171], v6, s[8:11], 0 offen offset:128
    buffer_load_dwordx4 a[172:175], v6, s[8:11], 0 offen offset:192
    buffer_load_dwordx4 a[176:179], v6, s[8:11], 0 offen offset:256
    buffer_load_dwordx4 a[180:183], v6, s[8:11], 0 offen offset:320
    buffer_load_dwordx4 a[184:187], v6, s[8:11], 0 offen offset:384
    buffer_load_dwordx4 a[188:191], v6, s[8:11], 0 offen offset:448
    buffer_load_dwordx4 a[192:195], v6, s[8:11], 0 offen offset:512
    buffer_load_dwordx4 a[196:199], v6, s[8:11], 0 offen offset:576
    buffer_load_dwordx4 a[200:203], v6, s[8:11], 0 offen offset:640
    buffer_load_dwordx4 a[204:207], v6, s[8:11], 0 offen offset:704
    buffer_load_dwordx4 a[208:211], v6, s[8:11], 0 offen offset:768
    buffer_load_dwordx4 a[212:215], v6, s[8:11], 0 offen offset:832
    buffer_load_dwordx4 a[216:219], v6, s[8:11], 0 offen offset:896
    buffer_load_dwordx4 a[220:223], v6, s[8:11], 0 offen offset:960
    buffer_load_dwordx4 a[224:227], v6, s[8:11], 0 offen offset:1024
    buffer_load_dwordx4 a[228:231], v6, s[8:11], 0 offen offset:1088
    buffer_load_dwordx4 a[232:235], v6, s[8:11], 0 offen offset:1152
    buffer_load_dwordx4 a[236:239], v6, s[8:11], 0 offen offset:1216
    buffer_load_dwordx4 a[240:243], v7, s[8:11], 0 offen offset:0
    buffer_load_dwordx4 a[244:247], v7, s[8:11], 0 offen offset:64
    buffer_load_dwordx4 a[248:251], v7, s[8:11], 0 offen offset:128
    buffer_load_dwordx4 a[252:255], v7, s[8:11], 0 offen offset:192
    buffer_load_dwordx4 v[112:115], v7, s[8:11], 0 offen offset:256
    buffer_load_dwordx4 v[116:119], v7, s[8:11], 0 offen offset:320
    buffer_load_dwordx4 v[120:123], v7, s[8:11], 0 offen offset:384
    buffer_load_dwordx4 v[124:127], v7, s[8:11], 0 offen offset:448
    buffer_load_dwordx4 v[128:131], v7, s[8:11], 0 offen offset:512
    buffer_load_dwordx4 v[132:135], v7, s[8:11], 0 offen offset:576
    buffer_load_dwordx4 v[136:139], v7, s[8:11], 0 offen offset:640
    buffer_load_dwordx4 v[140:143], v7, s[8:11], 0 offen offset:704
    buffer_load_dwordx4 v[144:147], v7, s[8:11], 0 offen offset:768
    buffer_load_dwordx4 v[148:151], v7, s[8:11], 0 offen offset:832
    buffer_load_dwordx4 v[152:155], v7, s[8:11], 0 offen offset:896
    buffer_load_dwordx4 v[156:159], v7, s[8:11], 0 offen offset:960
    buffer_load_dwordx4 v[160:163], v7, s[8:11], 0 offen offset:1024
    buffer_load_dwordx4 v[164:167], v7, s[8:11], 0 offen offset:1088
    buffer_load_dwordx4 v[168:171], v7, s[8:11], 0 offen offset:1152
    buffer_load_dwordx4 v[172:175], v7, s[8:11], 0 offen offset:1216
    s_waitcnt vmcnt(0)
    buffer_load_dwordx4 v[176:179], v8, s[8:11], 0 offen offset:0
    buffer_load_dwordx4 v[180:183], v8, s[8:11], 0 offen offset:64
    buffer_load_dwordx4 v[184:187], v8, s[8:11], 0 offen offset:128
    buffer_load_dwordx4 v[188:191], v8, s[8:11], 0 offen offset:192
    buffer_load_dwordx4 v[192:195], v8, s[8:11], 0 offen offset:256
    buffer_load_dwordx4 v[196:199], v8, s[8:11], 0 offen offset:320
    buffer_load_dwordx4 v[200:203], v8, s[8:11], 0 offen offset:384
    buffer_load_dwordx4 v[204:207], v8, s[8:11], 0 offen offset:448
    buffer_load_dwordx4 v[208:211], v8, s[8:11], 0 offen offset:512
    buffer_load_dwordx4 v[212:215], v8, s[8:11], 0 offen offset:576
    buffer_load_dwordx4 v[216:219], v8, s[8:11], 0 offen offset:640
    buffer_load_dwordx4 v[220:223], v8, s[8:11], 0 offen offset:704
    buffer_load_dwordx4 v[224:227], v8, s[8:11], 0 offen offset:768
    buffer_load_dwordx4 v[228:231], v8, s[8:11], 0 offen offset:832
    buffer_load_dwordx4 v[232:235], v8, s[8:11], 0 offen offset:896
    buffer_load_dwordx4 v[236:239], v8, s[8:11], 0 offen offset:960
    buffer_load_dwordx4 v[240:243], v8, s[8:11], 0 offen offset:1024
    buffer_load_dwordx4 v[244:247], v8, s[8:11], 0 offen offset:1088
    buffer_load_dwordx4 v[248:251], v8, s[8:11], 0 offen offset:1152
    buffer_load_dwordx4 v[252:255], v8, s[8:11], 0 offen offset:1216
    v_lshrrev_b32 v4, 3, v0
    v_and_b32 v5, 7, v0
    v_lshlrev_b32 v6, 13, v4
    v_lshlrev_b32 v7, 4, v5
    v_add_u32 v6, v6, v7
    s_lshl_b32 s28, s16, 8
    s_lshl_b32 s29, s17, 7
    s_add_u32 s28, s28, s29
    s_add_u32 s28, s28, 16777216
    v_add_u32 v6, s28, v6
    v_mul_u32_u24 v8, 144, v4
    v_add_u32 v8, v8, v7
    s_mov_b32 s28, 0

    buffer_load_dwordx4 v[24:27], v6, s[8:11], s28 offen
    s_add_u32 s28, s28, 0x40000
    buffer_load_dwordx4 v[28:31], v6, s[8:11], s28 offen
    s_add_u32 s28, s28, 0x40000
    buffer_load_dwordx4 v[32:35], v6, s[8:11], s28 offen
    s_add_u32 s28, s28, 0x40000
    buffer_load_dwordx4 v[36:39], v6, s[8:11], s28 offen
    s_add_u32 s28, s28, 0x40000
    buffer_load_dwordx4 v[40:43], v6, s[8:11], s28 offen
    s_add_u32 s28, s28, 0x40000
    buffer_load_dwordx4 v[44:47], v6, s[8:11], s28 offen
    s_add_u32 s28, s28, 0x40000
    buffer_load_dwordx4 v[48:51], v6, s[8:11], s28 offen
    s_add_u32 s28, s28, 0x40000
    buffer_load_dwordx4 v[52:55], v6, s[8:11], s28 offen
    s_add_u32 s28, s28, 0x40000
    buffer_load_dwordx4 v[56:59], v6, s[8:11], s28 offen
    s_add_u32 s28, s28, 0x40000
    buffer_load_dwordx4 v[60:63], v6, s[8:11], s28 offen
    s_add_u32 s28, s28, 0x40000
    buffer_load_dwordx4 v[64:67], v6, s[8:11], s28 offen
    s_add_u32 s28, s28, 0x40000
    buffer_load_dwordx4 v[68:71], v6, s[8:11], s28 offen
    s_add_u32 s28, s28, 0x40000
    buffer_load_dwordx4 v[72:75], v6, s[8:11], s28 offen
    s_add_u32 s28, s28, 0x40000
    buffer_load_dwordx4 v[76:79], v6, s[8:11], s28 offen
    s_add_u32 s28, s28, 0x40000
    buffer_load_dwordx4 v[80:83], v6, s[8:11], s28 offen
    s_add_u32 s28, s28, 0x40000
    buffer_load_dwordx4 v[84:87], v6, s[8:11], s28 offen
    s_add_u32 s28, s28, 0x40000
    buffer_load_dwordx4 v[88:91], v6, s[8:11], s28 offen
    s_add_u32 s28, s28, 0x40000
    buffer_load_dwordx4 v[92:95], v6, s[8:11], s28 offen
    s_add_u32 s28, s28, 0x40000
    buffer_load_dwordx4 v[96:99], v6, s[8:11], s28 offen
    s_add_u32 s28, s28, 0x40000
    buffer_load_dwordx4 v[100:103], v6, s[8:11], s28 offen
    s_add_u32 s28, s28, 0x40000
    s_waitcnt vmcnt(0)
    ds_write_b128 v8, v[24:27] offset:0
    ds_write_b128 v8, v[28:31] offset:4608
    ds_write_b128 v8, v[32:35] offset:9216
    ds_write_b128 v8, v[36:39] offset:13824
    ds_write_b128 v8, v[40:43] offset:18432
    ds_write_b128 v8, v[44:47] offset:23040
    ds_write_b128 v8, v[48:51] offset:27648
    ds_write_b128 v8, v[52:55] offset:32256
    ds_write_b128 v8, v[56:59] offset:36864
    ds_write_b128 v8, v[60:63] offset:41472
    v_add_u32 v8, 46080, v8
    ds_write_b128 v8, v[64:67] offset:0
    ds_write_b128 v8, v[68:71] offset:4608
    ds_write_b128 v8, v[72:75] offset:9216
    ds_write_b128 v8, v[76:79] offset:13824
    ds_write_b128 v8, v[80:83] offset:18432
    ds_write_b128 v8, v[84:87] offset:23040
    ds_write_b128 v8, v[88:91] offset:27648
    ds_write_b128 v8, v[92:95] offset:32256
    ds_write_b128 v8, v[96:99] offset:36864
    ds_write_b128 v8, v[100:103] offset:41472
    v_mov_b32 v24, 0
    v_mov_b32 v25, 0
    v_mov_b32 v26, 0
    v_mov_b32 v27, 0
    v_lshlrev_b32 v4, 4, v0
    v_add_u32 v4, 92160, v4

    ds_write_b128 v4, v[24:27] offset:0
    ds_write_b128 v4, v[24:27] offset:4096
    ds_write_b128 v4, v[24:27] offset:8192
    ds_write_b128 v4, v[24:27] offset:12288
    ds_write_b128 v4, v[24:27] offset:16384
    v_cmp_gt_u32 vcc, 16, v0
    s_and_saveexec_b64 s[28:29], vcc
    ds_write_b128 v4, v[24:27] offset:20480
    s_mov_b64 exec, s[28:29]
    s_waitcnt lgkmcnt(0)
    s_barrier

    v_mul_u32_u24 v4, 656, v2
    v_add_u32 v4, v4, v21
    v_add_u32 v4, 92160, v4
    v_lshlrev_b32 v5, 4, v1
    v_add_u32 v5, 112896, v5
    s_lshl_b32 s28, s18, 10
    v_add_u32 v6, s28, v5
    s_lshl_b32 s28, s18, 2
    s_add_u32 s28, s28, 4096
    v_add_u32 v7, s28, v5
    v_mul_u32_u24 v22, 144, v2
    v_lshlrev_b32 v23, 3, v3
    s_lshl_b32 s28, s18, 5
    s_add_u32 s28, s28, 118016
    v_add_u32 v8, v22, v23
    v_add_u32 v8, s28, v8
    v_add_u32 v9, v22, v21
    v_add_u32 v9, 118016, v9
    s_mul_i32 s28, s18, 160
    v_add_u32 v10, s28, v2
    v_mul_u32_u24 v10, 144, v10
    v_add_u32 v10, v10, v21

    v_lshlrev_b32 v22, 1, v3
    v_lshrrev_b32 v23, 3, v2
    v_add_u32 v22, v22, v23
    s_lshl_b32 s28, s36, 5
    s_lshl_b32 s29, s18, 3
    s_add_u32 s28, s28, s29
    v_add_u32 v22, s28, v22
    v_mul_u32_u24 v22, 20480, v22
    v_and_b32 v23, 7, v2
    v_lshlrev_b32 v23, 4, v23
    v_add_u32 v22, v22, v23
    s_mul_i32 s28, s37, 640
    s_add_u32 s28, s28, 134217728
    v_add_u32 v11, s28, v22

    v_mul_u32_u24 v22, 5120, v3
    v_lshlrev_b32 v23, 4, v2
    v_add_u32 v22, v22, v23
    s_mul_i32 s28, s99, 20480
    s_lshl_b32 s29, s18, 7
    s_add_u32 s28, s28, s29
    s_add_u32 s28, s28, 134217728
    v_add_u32 v12, s28, v22

    s_lshl_b32 s28, s18, 3
    v_add_u32 v22, s28, v2
    v_lshrrev_b32 v23, 3, v22
    v_lshlrev_b32 v23, 12, v23
    v_and_b32 v22, 7, v22
    v_lshlrev_b32 v22, 4, v22
    v_add_u32 v22, v22, v23
    v_mul_u32_u24 v23, 20480, v3
    v_add_u32 v22, v22, v23
    s_lshl_b32 s28, s37, 7
    s_add_u32 s28, s28, s50
    s_add_u32 s28, s28, 135528448
    v_add_u32 v13, s28, v22
    v_lshlrev_b32 v22, 4, v0
    v_add_u32 v14, 135528448, v22
    s_and_b32 s28, s37, 0
    s_mul_i32 s28, s28, 20480
    s_and_b32 s29, s37, 0
    s_mul_i32 s29, s29, 20480

    s_add_u32 s50, s50, s28
    s_add_u32 s55, s55, s29
    s_add_u32 s51, s51, s28
    s_add_u32 s56, s56, s29
    s_add_u32 s52, s52, s28
    s_add_u32 s57, s57, s29
    s_add_u32 s53, s53, s28
    s_add_u32 s58, s58, s29
    s_add_u32 s54, s54, s28
    s_add_u32 s59, s59, s29
    v_lshrrev_b32 v22, 3, v0
    v_and_b32 v23, 7, v0
    v_and_b32 v24, 1, v22
    v_lshlrev_b32 v24, 1, v24
    v_lshrrev_b32 v25, 2, v23
    v_add_u32 v24, v24, v25
    v_and_b32 v25, 1, v23
    v_lshlrev_b32 v26, 2, v24
    v_add_u32 v26, v26, v25
    v_lshlrev_b32 v27, 1, v24
    v_add_u32 v27, v27, v25
    v_lshrrev_b32 v24, 3, v22
    v_mul_u32_u24 v24, 40, v24
    v_bfe_u32 v25, v23, 1, 1
    v_lshlrev_b32 v25, 2, v25
    v_add_u32 v24, v24, v25
    v_bfe_u32 v25, v22, 1, 2
    v_add_u32 v24, v24, v25
    v_lshlrev_b32 v24, 3, v24
    v_mul_u32_u24 v26, 656, v26
    v_lshrrev_b32 v25, 1, v24
    v_add_u32 v15, v26, v25
    v_add_u32 v15, 92160, v15
    v_mul_u32_u24 v27, 1280, v27
    v_add_u32 v27, v27, v24

    buffer_load_dwordx2 v[28:29], v27, s[12:15], 0 offen offset:0
    buffer_load_dwordx2 v[30:31], v27, s[12:15], 0 offen offset:64
    buffer_load_dwordx2 v[32:33], v27, s[12:15], 0 offen offset:128
    buffer_load_dwordx2 v[34:35], v27, s[12:15], 0 offen offset:192
    buffer_load_dwordx2 v[36:37], v27, s[12:15], 0 offen offset:256
    v_lshlrev_b32 v22, 14, v20
    v_add_u32 v22, v22, v21
    s_lshl_b32 s28, s16, 8
    s_lshl_b32 s29, s18, 6
    s_add_u32 s28, s28, s29
    s_add_u32 s29, s28, 33562624
    v_add_u32 v16, s29, v22
    v_add_u32 v22, s30, v2
    v_lshlrev_b32 v23, 12, v22
    v_add_u32 v23, v23, v21
    v_add_u32 v17, 67108864, v23
    v_lshlrev_b32 v22, 4, v22
    v_lshlrev_b32 v23, 2, v3
    v_add_u32 v22, v22, v23
    v_add_u32 v19, 125829120, v22
    v_lshrrev_b32 v22, 2, v2
    v_lshlrev_b32 v22, 1, v22
    v_and_b32 v23, 1, v2
    v_add_u32 v22, v22, v23
    v_lshlrev_b32 v22, 8, v22
    v_add_u32 v22, v22, v21
    s_lshl_b32 s28, s16, 11
    s_lshl_b32 s29, s18, 6
    s_add_u32 s28, s28, s29
    s_add_u32 s28, s28, 121634816
    v_add_u32 v18, s28, v22

    s_mul_i32 s28, s18, 1280
    s_add_u32 s28, s28, 102656
    v_mul_u32_u24 v22, 160, v3
    v_lshlrev_b32 v23, 1, v20
    v_add_u32 v22, v22, v23
    v_add_u32 v1, s28, v22
    v_lshrrev_b32 v22, 2, v2
    v_lshlrev_b32 v22, 1, v22
    v_and_b32 v23, 1, v2
    v_add_u32 v22, v22, v23
    v_mul_u32_u24 v22, 80, v22
    v_add_u32 v22, v22, v21
    v_add_u32 v2, s28, v22
    v_mov_b32 v22, 0xeeeeeeee
    v_mov_b32 v23, 0x44444444
    v_cndmask_b32 v3, v22, v23, s[24:25]

    v_mov_b32 v23, 136183808
    s_mov_b32 s89, 0

.wc_19:
    buffer_load_dword v22, v23, s[84:87], 0 offen sc1
    s_waitcnt vmcnt(0)
    v_readfirstlane_b32 s88, v22
    s_cmp_ge_u32 s88, 66
    s_cbranch_scc1 .wc_20
    s_sleep 4
    s_add_u32 s89, s89, 1
    s_cmp_lt_u32 s89, 1048576
    s_cbranch_scc1 .wc_19
    s_endpgm

.wc_20:
    s_mov_b32 s28, 0x10000
    buffer_load_dwordx4 v[68:71], v16, s[8:11], 0 offen
    buffer_load_dwordx4 v[72:75], v16, s[8:11], s28 offen
    buffer_load_dwordx4 v[76:79], v17, s[8:11], 0 offen

    ds_read_b128 v[80:83], v10 offset:6912
    ds_read_b128 v[84:87], v10 offset:6976
    ds_read_b128 v[88:91], v10 offset:9216
    ds_read_b128 v[92:95], v10 offset:9280
    ds_read_b128 v[96:99], v10 offset:11520
    ds_read_b128 v[100:103], v10 offset:11584
    ds_read_b128 v[104:107], v10 offset:13824
    ds_read_b128 v[108:111], v10 offset:13888
    s_waitcnt vmcnt(0)
    ds_write_b32 v15, v28 offset:0
    ds_write_b32 v15, v29 offset:1312
    ds_write_b32 v15, v30 offset:32
    ds_write_b32 v15, v31 offset:1344
    ds_write_b32 v15, v32 offset:64
    ds_write_b32 v15, v33 offset:1376
    ds_write_b32 v15, v34 offset:96
    ds_write_b32 v15, v35 offset:1408
    ds_write_b32 v15, v36 offset:128
    ds_write_b32 v15, v37 offset:1440
    s_cmp_eq_u32 s17, 0
    s_cselect_b32 s48, s24, 0
    s_cselect_b32 s49, s25, 0
    s_mov_b32 s22, 0
    v_mov_b32 v22, 128

.k2_join:
    buffer_load_dword v23, v22, s[92:95], 0 offen sc1
    s_waitcnt vmcnt(0)
    v_readfirstlane_b32 s28, v23
    s_and_b32 s29, s28, 0xffff
    s_cmp_eq_u32 s29, 64
    s_cbranch_scc1 .k2_joined
    s_sleep 8
    s_add_u32 s22, s22, 1
    s_cmp_lt_u32 s22, 1048576
    s_cbranch_scc1 .k2_join
    s_endpgm

.k2_joined:
    s_lshr_b32 s23, s28, 16
    s_or_b32 s23, s23, 0
    s_mov_b32 s19, 0
    s_mov_b32 s20, 1
    s_mov_b32 s21, 1
    s_mov_b64 vcc, s[24:25]

    s_cmp_lg_u32 s23, 0
    s_cbranch_scc1 .k2_stepM
.k2_step:
    s_waitcnt lgkmcnt(0)
    s_barrier

    s_add_u32 s28, s19, 1
    s_min_u32 s28, s28, 63
    s_lshl_b32 s29, s28, 19
    s_add_u32 s30, s29, 0x10000
    s_lshl_b32 s31, s28, 6
    s_lshl_b32 s47, s19, 16
    ds_read_b128 v[24:27], v4 offset:0
    ds_read_b128 v[28:31], v4 offset:64
    ds_read_b128 v[32:35], v4 offset:128
    ds_read_b128 v[36:39], v4 offset:192
    ds_read_b128 v[40:43], v4 offset:256
    ds_read_b128 v[44:47], v4 offset:320
    v_mov_b64 v[48:49], 0
    v_mov_b64 v[50:51], 0
    v_mov_b64 v[52:53], 0
    v_mov_b64 v[54:55], 0
    v_mov_b64 v[56:57], 0
    v_mov_b64 v[58:59], 0
    v_mov_b64 v[60:61], 0
    v_mov_b64 v[62:63], 0
    v_mov_b64 v[64:65], 0
    v_mov_b64 v[66:67], 0
    s_and_b32 s88, s28, 7
    s_cbranch_scc1 .fl_21
    s_lshl_b32 s88, s28, 4
    s_add_u32 s88, s88, 136183808
    v_mov_b32 v21, s88
    buffer_load_dword v20, v21, s[8:11], 0 offen sc1

.fl_21:
    s_and_b32 s88, s19, 1
    s_or_b32 s88, s88, s18
    s_cbranch_scc1 .fl_22
    s_lshl_b32 s88, s19, 6
    s_add_u32 s88, s88, 136187776
    s_mov_b64 exec, 1
    v_mov_b32 v23, s88
    v_mov_b32 v22, 1
    buffer_atomic_add v22, v23, s[8:11], 0 offen sc1
    s_mov_b64 exec, -1

.fl_22:
    s_waitcnt lgkmcnt(5)
    v_smfmac_f32_16x16x64_bf16 v[48:51], v[24:27], a[0:7], v3
    v_smfmac_f32_16x16x64_bf16 v[52:55], v[24:27], a[80:87], v3
    v_smfmac_f32_16x16x64_bf16 v[56:59], v[24:27], a[160:167], v3
    v_smfmac_f32_16x16x64_bf16 v[60:63], v[24:27], a[240:247], v3
    ds_read_b128 v[24:27], v4 offset:384
    s_waitcnt lgkmcnt(5)
    v_smfmac_f32_16x16x64_bf16 v[48:51], v[28:31], a[8:15], v3
    v_smfmac_f32_16x16x64_bf16 v[52:55], v[28:31], a[88:95], v3
    v_smfmac_f32_16x16x64_bf16 v[56:59], v[28:31], a[168:175], v3
    v_smfmac_f32_16x16x64_bf16 v[60:63], v[28:31], a[248:255], v3
    ds_read_b128 v[28:31], v4 offset:448
    s_waitcnt lgkmcnt(5)
    v_smfmac_f32_16x16x64_bf16 v[48:51], v[32:35], a[16:23], v3
    v_smfmac_f32_16x16x64_bf16 v[52:55], v[32:35], a[96:103], v3
    v_smfmac_f32_16x16x64_bf16 v[56:59], v[32:35], a[176:183], v3
    v_smfmac_f32_16x16x64_bf16 v[60:63], v[32:35], v[112:119], v3
    ds_read_b128 v[32:35], v4 offset:512
    s_waitcnt lgkmcnt(5)
    v_smfmac_f32_16x16x64_bf16 v[48:51], v[36:39], a[24:31], v3
    v_smfmac_f32_16x16x64_bf16 v[52:55], v[36:39], a[104:111], v3
    v_smfmac_f32_16x16x64_bf16 v[56:59], v[36:39], a[184:191], v3
    v_smfmac_f32_16x16x64_bf16 v[60:63], v[36:39], v[120:127], v3
    ds_read_b128 v[36:39], v4 offset:576
    s_waitcnt lgkmcnt(5)
    v_smfmac_f32_16x16x64_bf16 v[48:51], v[40:43], a[32:39], v3
    v_smfmac_f32_16x16x64_bf16 v[52:55], v[40:43], a[112:119], v3
    v_smfmac_f32_16x16x64_bf16 v[56:59], v[40:43], a[192:199], v3
    v_smfmac_f32_16x16x64_bf16 v[60:63], v[40:43], v[128:135], v3
    s_waitcnt lgkmcnt(4)
    v_smfmac_f32_16x16x64_bf16 v[48:51], v[44:47], a[40:47], v3
    v_smfmac_f32_16x16x64_bf16 v[52:55], v[44:47], a[120:127], v3
    v_smfmac_f32_16x16x64_bf16 v[56:59], v[44:47], a[200:207], v3
    v_smfmac_f32_16x16x64_bf16 v[60:63], v[44:47], v[136:143], v3
    s_waitcnt lgkmcnt(3)
    v_smfmac_f32_16x16x64_bf16 v[48:51], v[24:27], a[48:55], v3
    v_smfmac_f32_16x16x64_bf16 v[52:55], v[24:27], a[128:135], v3
    v_smfmac_f32_16x16x64_bf16 v[56:59], v[24:27], a[208:215], v3
    v_smfmac_f32_16x16x64_bf16 v[60:63], v[24:27], v[144:151], v3
    s_waitcnt lgkmcnt(2)
    v_smfmac_f32_16x16x64_bf16 v[48:51], v[28:31], a[56:63], v3
    v_smfmac_f32_16x16x64_bf16 v[52:55], v[28:31], a[136:143], v3
    v_smfmac_f32_16x16x64_bf16 v[56:59], v[28:31], a[216:223], v3
    v_smfmac_f32_16x16x64_bf16 v[60:63], v[28:31], v[152:159], v3
    s_waitcnt lgkmcnt(1)
    v_smfmac_f32_16x16x64_bf16 v[48:51], v[32:35], a[64:71], v3
    v_smfmac_f32_16x16x64_bf16 v[52:55], v[32:35], a[144:151], v3
    v_smfmac_f32_16x16x64_bf16 v[56:59], v[32:35], a[224:231], v3
    v_smfmac_f32_16x16x64_bf16 v[60:63], v[32:35], v[160:167], v3
    s_waitcnt lgkmcnt(0)
    v_smfmac_f32_16x16x64_bf16 v[48:51], v[36:39], a[72:79], v3
    v_smfmac_f32_16x16x64_bf16 v[52:55], v[36:39], a[152:159], v3
    v_smfmac_f32_16x16x64_bf16 v[56:59], v[36:39], a[232:239], v3
    v_smfmac_f32_16x16x64_bf16 v[60:63], v[36:39], v[168:175], v3
    v_smfmac_f32_16x16x64_bf16 v[64:67], v[24:27], v[224:231], v3
    ds_read_b128 v[24:27], v4 offset:0
    s_nop 2
    v_pk_add_f32 v[48:49], v[48:49], v[50:51]
    v_cvt_pk_bf16_f32 v48, v48, v49
    ds_write_b16 v1, v48 offset:0
    ds_write_b16_d16_hi v1, v48 offset:80
    v_pk_add_f32 v[52:53], v[52:53], v[54:55]
    v_cvt_pk_bf16_f32 v52, v52, v53
    ds_write_b16 v1, v52 offset:8
    ds_write_b16_d16_hi v1, v52 offset:88
    ds_read_b128 v[40:43], v2
    v_pk_add_f32 v[56:57], v[56:57], v[58:59]
    v_cvt_pk_bf16_f32 v56, v56, v57
    ds_write_b16 v1, v56 offset:640
    ds_write_b16_d16_hi v1, v56 offset:720
    v_pk_add_f32 v[60:61], v[60:61], v[62:63]
    v_cvt_pk_bf16_f32 v60, v60, v61
    ds_write_b16 v1, v60 offset:648
    ds_write_b16_d16_hi v1, v60 offset:728
    ds_read_b128 v[44:47], v2 offset:640
    v_smfmac_f32_16x16x64_bf16 v[64:67], v[28:31], v[232:239], v3
    ds_read_b128 v[28:31], v4 offset:64
    v_smfmac_f32_16x16x64_bf16 v[64:67], v[32:35], v[240:247], v3
    ds_read_b128 v[32:35], v4 offset:128
    v_smfmac_f32_16x16x64_bf16 v[64:67], v[36:39], v[248:255], v3
    ds_read_b128 v[36:39], v4 offset:192
    s_waitcnt lgkmcnt(8)
    v_mfma_f32_16x16x32_bf16 v[48:51], v[68:71], v[40:43], 0
    v_mfma_f32_16x16x32_bf16 v[52:55], v[72:75], v[40:43], 0
    s_waitcnt lgkmcnt(3)
    v_mfma_f32_16x16x32_bf16 v[56:59], v[44:47], v[40:43], 0
    s_and_b32 s88, s28, 7
    s_cbranch_scc1 .fl_23
    s_waitcnt vmcnt(0)
    v_readfirstlane_b32 s88, v20
    s_cmp_ge_u32 s88, 66
    s_cbranch_scc1 .fl_23
    s_lshl_b32 s91, s28, 4
    s_add_u32 s91, s91, 136183808

    v_mov_b32 v21, s91
    s_mov_b32 s89, 0

.wc_24:
    buffer_load_dword v20, v21, s[84:87], 0 offen sc1
    s_waitcnt vmcnt(0)
    v_readfirstlane_b32 s88, v20
    s_cmp_ge_u32 s88, 66
    s_cbranch_scc1 .wc_25
    s_sleep 4
    s_add_u32 s89, s89, 1
    s_cmp_lt_u32 s89, 1048576
    s_cbranch_scc1 .wc_24
    s_endpgm

.wc_25:
.fl_23:
    s_mov_b64 exec, s[48:49]
    buffer_store_dwordx4 v[44:47], v18, s[8:11], s47 offen sc1
    s_mov_b64 exec, -1
    buffer_load_dwordx4 v[68:71], v16, s[8:11], s29 offen
    buffer_load_dwordx4 v[72:75], v16, s[8:11], s30 offen
    v_smfmac_f32_16x16x64_bf16 v[64:67], v[24:27], v[176:183], v3
    ds_read_b128 v[24:27], v4 offset:256
    v_cndmask_b32_dpp v60, v52, v48, vcc quad_perm:[2,3,0,1] row_mask:0xf bank_mask:0xf
    v_cndmask_b32_dpp v61, v53, v49, vcc quad_perm:[2,3,0,1] row_mask:0xf bank_mask:0xf
    v_cndmask_b32_dpp v62, v54, v50, vcc quad_perm:[2,3,0,1] row_mask:0xf bank_mask:0xf
    v_cndmask_b32_dpp v63, v55, v51, vcc quad_perm:[2,3,0,1] row_mask:0xf bank_mask:0xf
    ds_write_b128 v6, v[60:63]
    v_cndmask_b32_dpp v58, v57, v56, vcc quad_perm:[2,3,0,1] row_mask:0xf bank_mask:0xf
    ds_write_b32 v7, v58
    s_waitcnt lgkmcnt(5)
    v_smfmac_f32_16x16x64_bf16 v[64:67], v[28:31], v[184:191], v3
    ds_read_b128 v[28:31], v4 offset:320
    s_waitcnt lgkmcnt(5)
    v_smfmac_f32_16x16x64_bf16 v[64:67], v[32:35], v[192:199], v3
    s_waitcnt lgkmcnt(0)
    s_barrier
    ds_read_b128 v[48:51], v5 offset:0
    ds_read_b128 v[52:55], v5 offset:1024
    ds_read_b128 v[56:59], v5 offset:2048
    ds_read_b128 v[60:63], v5 offset:3072
    ds_read_b128 v[40:43], v5 offset:4096
    v_smfmac_f32_16x16x64_bf16 v[64:67], v[36:39], v[200:207], v3
    v_smfmac_f32_16x16x64_bf16 v[64:67], v[24:27], v[208:215], v3
    v_smfmac_f32_16x16x64_bf16 v[64:67], v[28:31], v[216:223], v3
    s_waitcnt lgkmcnt(3)
    v_pk_add_f32 v[48:49], v[48:49], v[52:53]
    v_pk_add_f32 v[50:51], v[50:51], v[54:55]
    s_waitcnt lgkmcnt(1)
    v_pk_add_f32 v[56:57], v[56:57], v[60:61]
    v_pk_add_f32 v[58:59], v[58:59], v[62:63]
    s_waitcnt lgkmcnt(0)
    v_pk_add_f32 v[40:41], v[40:41], v[42:43]
    v_pk_add_f32 v[48:49], v[48:49], v[56:57]
    v_pk_add_f32 v[50:51], v[50:51], v[58:59]
    v_add_f32 v52, v40, v41
    v_cvt_pk_bf16_f32 v44, v48, v49
    v_cvt_pk_bf16_f32 v45, v50, v51
    v_cvt_pk_bf16_f32 v46, v52, v52
    v_lshlrev_b32 v48, 16, v44
    v_and_b32 v49, 0xffff0000, v44
    v_lshlrev_b32 v50, 16, v45
    v_and_b32 v51, 0xffff0000, v45
    v_lshlrev_b32 v52, 16, v46
    v_pk_mul_f32 v[48:49], v[48:49], s[42:43]
    v_pk_mul_f32 v[50:51], v[50:51], s[42:43]
    v_mul_f32 v52, s42, v52
    v_cvt_pk_bf16_f32 v44, v48, v49
    v_cvt_pk_bf16_f32 v45, v50, v51
    v_cvt_pk_bf16_f32 v46, v52, v52
    v_lshlrev_b32 v48, 16, v44
    v_and_b32 v49, 0xffff0000, v44
    v_lshlrev_b32 v50, 16, v45
    v_and_b32 v51, 0xffff0000, v45
    v_lshlrev_b32 v52, 16, v46
    v_max3_f32 v44, v48, v49, v50
    v_max3_f32 v44, v44, v51, v52
    s_nop 1
    v_max_f32_dpp v44, v44, v44 quad_perm:[2,3,0,1] row_mask:0xf bank_mask:0xf
    v_mov_b32 v45, v44
    s_nop 1
    v_permlane16_swap_b32 v44, v45
    v_max_f32 v44, v44, v45
    v_mov_b32 v45, v44
    s_nop 1
    v_permlane32_swap_b32 v44, v45
    v_max_f32 v44, v44, v45
    v_mul_f32 v44, s40, v44
    v_sub_f32 v44, 0, v44
    v_mov_b32 v45, v44
    v_pk_fma_f32 v[48:49], v[48:49], s[40:41], v[44:45]
    v_pk_fma_f32 v[50:51], v[50:51], s[40:41], v[44:45]
    v_fma_f32 v52, v52, s40, v44
    v_exp_f32 v48, v48
    v_exp_f32 v49, v49
    v_exp_f32 v50, v50
    v_exp_f32 v51, v51
    v_exp_f32 v52, v52
    v_pk_add_f32 v[44:45], v[48:49], v[50:51]
    v_add_f32 v44, v44, v45
    v_add_f32 v44, v44, v52
    s_nop 1
    v_add_f32_dpp v44, v44, v44 quad_perm:[2,3,0,1] row_mask:0xf bank_mask:0xf
    v_mov_b32 v45, v44
    s_nop 1
    v_permlane16_swap_b32 v44, v45
    v_add_f32 v44, v44, v45
    v_mov_b32 v45, v44
    s_nop 1
    v_permlane32_swap_b32 v44, v45
    v_add_f32 v44, v44, v45
    v_rcp_f32 v44, v44
    s_nop 0
    v_mov_b32 v45, v44
    v_pk_mul_f32 v[48:49], v[48:49], v[44:45]
    v_pk_mul_f32 v[50:51], v[50:51], v[44:45]
    v_mul_f32 v52, v52, v44
    v_cvt_pk_bf16_f32 v56, v48, v49
    v_cvt_pk_bf16_f32 v57, v50, v51
    v_mov_b32_dpp v53, v52 quad_perm:[2,3,0,1] row_mask:0xf bank_mask:0xf
    v_mov_b32_dpp v58, v56 quad_perm:[2,3,0,1] row_mask:0xf bank_mask:0xf
    v_mov_b32_dpp v59, v57 quad_perm:[2,3,0,1] row_mask:0xf bank_mask:0xf
    v_cvt_pk_bf16_f32 v60, v52, v53
    v_mov_b32 v61, 0
    v_mfma_f32_16x16x32_bf16 v[40:43], v[76:79], v[56:59], 0
    v_pk_add_f32 v[64:65], v[64:65], v[66:67]
    v_cvt_pk_bf16_f32 v62, v64, v65
    v_mov_b32 v63, 0
    s_nop 2
    v_mfma_f32_16x16x16_bf16 v[40:43], v[62:63], v[60:61], v[40:43]
    buffer_store_dword v62, v19, s[8:11], s47 offen sc1
    buffer_load_dwordx4 v[76:79], v17, s[8:11], s31 offen
    s_cmp_eq_u32 s19, 63
    s_cbranch_scc1 .k2_fin
    ds_read_b128 v[24:27], v10 offset:0
    ds_read_b128 v[28:31], v10 offset:64
    ds_read_b128 v[32:35], v10 offset:2304
    ds_read_b128 v[36:39], v10 offset:2368
    v_cvt_pk_bf16_f32 v48, v40, v41
    v_cvt_pk_bf16_f32 v49, v42, v43
    ds_write_b64 v8, v[48:49]
    ds_read_b128 v[40:43], v10 offset:4608
    ds_read_b128 v[44:47], v10 offset:4672
    s_waitcnt lgkmcnt(0)
    s_barrier
    ds_read_b128 v[64:67], v9
    ds_read_b128 v[20:23], v9 offset:64
    s_waitcnt lgkmcnt(1)
    v_mfma_f32_16x16x32_bf16 v[48:51], v[24:27], v[64:67], 0
    v_mfma_f32_16x16x32_bf16 v[52:55], v[32:35], v[64:67], 0
    s_waitcnt lgkmcnt(0)
    v_mfma_f32_16x16x32_bf16 v[48:51], v[28:31], v[20:23], v[48:51]
    v_mfma_f32_16x16x32_bf16 v[52:55], v[36:39], v[20:23], v[52:55]
    ds_read_b128 v[24:27], v10 offset:16128
    ds_read_b128 v[28:31], v10 offset:16192
    ds_read_b128 v[32:35], v10 offset:18432
    ds_read_b128 v[36:39], v10 offset:18496
    v_mfma_f32_16x16x32_bf16 v[56:59], v[40:43], v[64:67], 0
    v_mfma_f32_16x16x32_bf16 v[60:63], v[80:83], v[64:67], 0
    v_mfma_f32_16x16x32_bf16 v[56:59], v[44:47], v[20:23], v[56:59]
    v_mfma_f32_16x16x32_bf16 v[60:63], v[84:87], v[20:23], v[60:63]
    ds_read_b128 v[40:43], v10 offset:20736
    ds_read_b128 v[44:47], v10 offset:20800
    v_cndmask_b32_dpp v48, v52, v48, vcc quad_perm:[2,3,0,1] row_mask:0xf bank_mask:0xf
    v_cndmask_b32_dpp v49, v53, v49, vcc quad_perm:[2,3,0,1] row_mask:0xf bank_mask:0xf
    v_cndmask_b32_dpp v50, v54, v50, vcc quad_perm:[2,3,0,1] row_mask:0xf bank_mask:0xf
    v_cndmask_b32_dpp v51, v55, v51, vcc quad_perm:[2,3,0,1] row_mask:0xf bank_mask:0xf
    v_and_or_b32 v48, v48, -4, s20
    v_and_or_b32 v49, v49, -4, s20
    v_and_or_b32 v50, v50, -4, s20
    v_and_or_b32 v51, v51, -4, s20
    buffer_store_dwordx4 v[48:51], v11, s[8:11], 0 offen offset:0
    v_mfma_f32_16x16x32_bf16 v[48:51], v[88:91], v[64:67], 0
    v_mfma_f32_16x16x32_bf16 v[52:55], v[96:99], v[64:67], 0
    v_mfma_f32_16x16x32_bf16 v[48:51], v[92:95], v[20:23], v[48:51]
    v_mfma_f32_16x16x32_bf16 v[52:55], v[100:103], v[20:23], v[52:55]
    v_cndmask_b32_dpp v56, v60, v56, vcc quad_perm:[2,3,0,1] row_mask:0xf bank_mask:0xf
    v_cndmask_b32_dpp v57, v61, v57, vcc quad_perm:[2,3,0,1] row_mask:0xf bank_mask:0xf
    v_cndmask_b32_dpp v58, v62, v58, vcc quad_perm:[2,3,0,1] row_mask:0xf bank_mask:0xf
    v_cndmask_b32_dpp v59, v63, v59, vcc quad_perm:[2,3,0,1] row_mask:0xf bank_mask:0xf
    v_and_or_b32 v56, v56, -4, s20
    v_and_or_b32 v57, v57, -4, s20
    v_and_or_b32 v58, v58, -4, s20
    v_and_or_b32 v59, v59, -4, s20
    buffer_store_dwordx4 v[56:59], v11, s[8:11], 0 offen offset:128
    v_mfma_f32_16x16x32_bf16 v[56:59], v[104:107], v[64:67], 0
    s_waitcnt lgkmcnt(5)
    v_mfma_f32_16x16x32_bf16 v[60:63], v[24:27], v[64:67], 0
    v_mfma_f32_16x16x32_bf16 v[56:59], v[108:111], v[20:23], v[56:59]
    s_waitcnt lgkmcnt(4)
    v_mfma_f32_16x16x32_bf16 v[60:63], v[28:31], v[20:23], v[60:63]
    v_cndmask_b32_dpp v48, v52, v48, vcc quad_perm:[2,3,0,1] row_mask:0xf bank_mask:0xf
    v_cndmask_b32_dpp v49, v53, v49, vcc quad_perm:[2,3,0,1] row_mask:0xf bank_mask:0xf
    v_cndmask_b32_dpp v50, v54, v50, vcc quad_perm:[2,3,0,1] row_mask:0xf bank_mask:0xf
    v_cndmask_b32_dpp v51, v55, v51, vcc quad_perm:[2,3,0,1] row_mask:0xf bank_mask:0xf
    v_and_or_b32 v48, v48, -4, s20
    v_and_or_b32 v49, v49, -4, s20
    v_and_or_b32 v50, v50, -4, s20
    v_and_or_b32 v51, v51, -4, s20
    buffer_store_dwordx4 v[48:51], v11, s[8:11], 0 offen offset:256
    s_waitcnt lgkmcnt(3)
    v_mfma_f32_16x16x32_bf16 v[48:51], v[32:35], v[64:67], 0
    s_waitcnt lgkmcnt(1)
    v_mfma_f32_16x16x32_bf16 v[52:55], v[40:43], v[64:67], 0
    v_mfma_f32_16x16x32_bf16 v[48:51], v[36:39], v[20:23], v[48:51]
    s_waitcnt lgkmcnt(0)
    v_mfma_f32_16x16x32_bf16 v[52:55], v[44:47], v[20:23], v[52:55]
    v_cndmask_b32_dpp v56, v60, v56, vcc quad_perm:[2,3,0,1] row_mask:0xf bank_mask:0xf
    v_cndmask_b32_dpp v57, v61, v57, vcc quad_perm:[2,3,0,1] row_mask:0xf bank_mask:0xf
    v_cndmask_b32_dpp v58, v62, v58, vcc quad_perm:[2,3,0,1] row_mask:0xf bank_mask:0xf
    v_cndmask_b32_dpp v59, v63, v59, vcc quad_perm:[2,3,0,1] row_mask:0xf bank_mask:0xf
    v_and_or_b32 v56, v56, -4, s20
    v_and_or_b32 v57, v57, -4, s20
    v_and_or_b32 v58, v58, -4, s20
    v_and_or_b32 v59, v59, -4, s20
    buffer_store_dwordx4 v[56:59], v11, s[8:11], 0 offen offset:384
    v_cndmask_b32_dpp v48, v52, v48, vcc quad_perm:[2,3,0,1] row_mask:0xf bank_mask:0xf
    v_cndmask_b32_dpp v49, v53, v49, vcc quad_perm:[2,3,0,1] row_mask:0xf bank_mask:0xf
    v_cndmask_b32_dpp v50, v54, v50, vcc quad_perm:[2,3,0,1] row_mask:0xf bank_mask:0xf
    v_cndmask_b32_dpp v51, v55, v51, vcc quad_perm:[2,3,0,1] row_mask:0xf bank_mask:0xf
    v_and_or_b32 v48, v48, -4, s20
    v_and_or_b32 v49, v49, -4, s20
    v_and_or_b32 v50, v50, -4, s20
    v_and_or_b32 v51, v51, -4, s20
    buffer_store_dwordx4 v[48:51], v11, s[8:11], 0 offen offset:512
    s_mov_b32 s22, 0
    s_mov_b64 exec, s[26:27]

    s_waitcnt vmcnt(0)
.k2_h1:
    buffer_load_dwordx4 v[24:27], v12, s[8:11], 0 offen offset:0 sc1
    buffer_load_dwordx4 v[28:31], v12, s[8:11], 0 offen offset:640 sc1
    buffer_load_dwordx4 v[32:35], v12, s[8:11], 0 offen offset:1280 sc1
    buffer_load_dwordx4 v[36:39], v12, s[8:11], 0 offen offset:1920 sc1
    buffer_load_dwordx4 v[40:43], v12, s[8:11], s44 offen offset:0 sc1
    buffer_load_dwordx4 v[44:47], v12, s[8:11], s44 offen offset:640 sc1
    buffer_load_dwordx4 v[48:51], v12, s[8:11], s44 offen offset:1280 sc1
    buffer_load_dwordx4 v[52:55], v12, s[8:11], s44 offen offset:1920 sc1
    s_mov_b64 exec, s[26:27]
    s_waitcnt vmcnt(0)
    v_or3_b32 v56, v24, v28, v32
    v_or3_b32 v57, v25, v29, v33
    v_or3_b32 v58, v26, v30, v34
    v_or3_b32 v59, v27, v31, v35
    v_or3_b32 v56, v56, v36, v40
    v_or3_b32 v57, v57, v37, v41
    v_or3_b32 v58, v58, v38, v42
    v_or3_b32 v59, v59, v39, v43
    v_or3_b32 v56, v56, v44, v48
    v_or3_b32 v57, v57, v45, v49
    v_or3_b32 v58, v58, v46, v50
    v_or3_b32 v59, v59, v47, v51
    v_or_b32 v56, v56, v52
    v_or_b32 v57, v57, v53
    v_or_b32 v58, v58, v54
    v_or_b32 v59, v59, v55
    v_or3_b32 v56, v56, v57, v58
    v_or_b32 v56, v56, v59
    v_and_b32 v56, 3, v56
    v_cmp_ne_u32 s[32:33], s20, v56
    s_cmp_eq_u64 s[32:33], 0
    s_cbranch_scc1 .k2_h1ok
    s_mov_b64 exec, s[32:33]
    s_add_u32 s22, s22, 1
    s_cmp_lt_u32 s22, 1048576
    s_cbranch_scc1 .k2_h1
    s_endpgm

.k2_h1ok:
    s_mov_b64 exec, -1
    v_pk_add_f32 v[24:25], v[24:25], v[40:41]
    v_pk_add_f32 v[26:27], v[26:27], v[42:43]
    v_pk_add_f32 v[28:29], v[28:29], v[44:45]
    v_pk_add_f32 v[30:31], v[30:31], v[46:47]
    v_pk_add_f32 v[32:33], v[32:33], v[48:49]
    v_pk_add_f32 v[34:35], v[34:35], v[50:51]
    v_pk_add_f32 v[36:37], v[36:37], v[52:53]
    v_pk_add_f32 v[38:39], v[38:39], v[54:55]
    v_pk_add_f32 v[24:25], v[24:25], v[32:33]
    v_pk_add_f32 v[26:27], v[26:27], v[34:35]
    v_pk_add_f32 v[28:29], v[28:29], v[36:37]
    v_pk_add_f32 v[30:31], v[30:31], v[38:39]
    v_pk_add_f32 v[24:25], v[24:25], v[28:29]
    v_pk_add_f32 v[26:27], v[26:27], v[30:31]
    s_nop 1
    v_permlane32_swap_b32 v24, v26
    v_permlane32_swap_b32 v25, v27
    v_pk_add_f32 v[24:25], v[24:25], v[26:27]
    s_nop 1
    v_permlane16_swap_b32 v24, v25
    v_add_f32 v24, v24, v25
    v_and_or_b32 v24, v24, -4, s21
    v_mov_b32 v25, v24
    s_nop 1
    v_permlane16_swap_b32 v24, v25
    v_mov_b32 v26, v24
    v_mov_b32 v27, v25
    s_nop 0
    v_permlane32_swap_b32 v24, v26
    v_permlane32_swap_b32 v25, v27
    s_mov_b64 exec, s[34:35]
    buffer_store_dwordx4 v[24:27], v13, s[8:11], s45 offen sc1
    s_mov_b64 exec, s[38:39]
    buffer_store_dwordx4 v[24:27], v13, s[8:11], 0 offen
    s_mov_b64 exec, -1
    s_nop 1
    s_mov_b32 s22, 0
.k2_h2o:
    buffer_load_dwordx4 v[28:31], v14, s[8:11], s50 offen sc1
    buffer_load_dwordx4 v[32:35], v14, s[8:11], s51 offen sc1
    buffer_load_dwordx4 v[36:39], v14, s[8:11], s52 offen sc1
    buffer_load_dwordx4 v[40:43], v14, s[8:11], s53 offen sc1
    buffer_load_dwordx4 v[44:47], v14, s[8:11], s54 offen sc1
    s_mov_b64 exec, -1
    s_waitcnt vmcnt(0)
.k2_h2oc:
    v_or3_b32 v20, v28, v32, v36
    v_or3_b32 v21, v29, v33, v37
    v_or3_b32 v22, v30, v34, v38
    v_or3_b32 v23, v31, v35, v39
    v_or3_b32 v20, v20, v40, v44
    v_or3_b32 v21, v21, v41, v45
    v_or3_b32 v22, v22, v42, v46
    v_or3_b32 v23, v23, v43, v47
    v_or3_b32 v20, v20, v21, v22
    v_or_b32 v20, v20, v23
    v_and_b32 v20, 3, v20
    v_cmp_ne_u32 s[32:33], s21, v20
    s_cmp_eq_u64 s[32:33], 0
    s_cbranch_scc1 .k2_h2ook
    s_mov_b64 exec, s[32:33]
    s_add_u32 s22, s22, 1
    s_cmp_lt_u32 s22, 1048576
    s_cbranch_scc1 .k2_h2o
    s_endpgm

.k2_h2ook:
.k2_h2r:
    buffer_load_dwordx4 v[48:51], v14, s[8:11], s55 offen sc1
    buffer_load_dwordx4 v[52:55], v14, s[8:11], s56 offen sc1
    buffer_load_dwordx4 v[56:59], v14, s[8:11], s57 offen sc1
    buffer_load_dwordx4 v[60:63], v14, s[8:11], s58 offen sc1
    buffer_load_dwordx4 v[64:67], v14, s[8:11], s59 offen sc1
    s_mov_b64 exec, -1
    s_waitcnt vmcnt(0)
.k2_h2rc:
    v_or3_b32 v20, v48, v52, v56
    v_or3_b32 v21, v49, v53, v57
    v_or3_b32 v22, v50, v54, v58
    v_or3_b32 v23, v51, v55, v59
    v_or3_b32 v20, v20, v60, v64
    v_or3_b32 v21, v21, v61, v65
    v_or3_b32 v22, v22, v62, v66
    v_or3_b32 v23, v23, v63, v67
    v_or3_b32 v20, v20, v21, v22
    v_or_b32 v20, v20, v23
    v_and_b32 v20, 3, v20
    v_cmp_ne_u32 s[32:33], s21, v20
    s_cmp_eq_u64 s[32:33], 0
    s_cbranch_scc1 .k2_h2rok
    s_mov_b64 exec, s[32:33]
    s_add_u32 s22, s22, 1
    s_cmp_lt_u32 s22, 1048576
    s_cbranch_scc1 .k2_h2r
    s_endpgm

.k2_h2rok:
    v_pk_add_f32 v[28:29], v[28:29], v[48:49]
    v_pk_add_f32 v[30:31], v[30:31], v[50:51]
    v_cvt_pk_bf16_f32 v28, v28, v29
    v_cvt_pk_bf16_f32 v29, v30, v31
    ds_write_b32 v15, v28 offset:0
    ds_write_b32 v15, v29 offset:1312
    v_pk_add_f32 v[32:33], v[32:33], v[52:53]
    v_pk_add_f32 v[34:35], v[34:35], v[54:55]
    v_cvt_pk_bf16_f32 v32, v32, v33
    v_cvt_pk_bf16_f32 v33, v34, v35
    ds_write_b32 v15, v32 offset:32
    ds_write_b32 v15, v33 offset:1344
    v_pk_add_f32 v[36:37], v[36:37], v[56:57]
    v_pk_add_f32 v[38:39], v[38:39], v[58:59]
    v_cvt_pk_bf16_f32 v36, v36, v37
    v_cvt_pk_bf16_f32 v37, v38, v39
    ds_write_b32 v15, v36 offset:64
    ds_write_b32 v15, v37 offset:1376
    v_pk_add_f32 v[40:41], v[40:41], v[60:61]
    v_pk_add_f32 v[42:43], v[42:43], v[62:63]
    v_cvt_pk_bf16_f32 v40, v40, v41
    v_cvt_pk_bf16_f32 v41, v42, v43
    ds_write_b32 v15, v40 offset:96
    ds_write_b32 v15, v41 offset:1408
    v_pk_add_f32 v[44:45], v[44:45], v[64:65]
    v_pk_add_f32 v[46:47], v[46:47], v[66:67]
    v_cvt_pk_bf16_f32 v44, v44, v45
    v_cvt_pk_bf16_f32 v45, v46, v47
    ds_write_b32 v15, v44 offset:128
    ds_write_b32 v15, v45 offset:1440
    v_add_u32 v13, s46, v13
    v_add_u32 v14, s46, v14
    s_sub_u32 s46, 0, s46
    s_add_u32 s19, s19, 1
    s_xor_b32 s20, s20, 3
    s_lshr_b32 s28, s19, 1
    s_and_b32 s28, s28, 1
    s_lshl_b32 s21, 1, s28
    s_branch .k2_step

.k2_stepM:
    s_waitcnt lgkmcnt(0)
    s_barrier

    s_add_u32 s28, s19, 1
    s_min_u32 s28, s28, 63
    s_lshl_b32 s29, s28, 19
    s_add_u32 s30, s29, 0x10000
    s_lshl_b32 s31, s28, 6
    s_lshl_b32 s47, s19, 16
    ds_read_b128 v[24:27], v4 offset:0
    ds_read_b128 v[28:31], v4 offset:64
    ds_read_b128 v[32:35], v4 offset:128
    ds_read_b128 v[36:39], v4 offset:192
    ds_read_b128 v[40:43], v4 offset:256
    ds_read_b128 v[44:47], v4 offset:320
    v_mov_b64 v[48:49], 0
    v_mov_b64 v[50:51], 0
    v_mov_b64 v[52:53], 0
    v_mov_b64 v[54:55], 0
    v_mov_b64 v[56:57], 0
    v_mov_b64 v[58:59], 0
    v_mov_b64 v[60:61], 0
    v_mov_b64 v[62:63], 0
    v_mov_b64 v[64:65], 0
    v_mov_b64 v[66:67], 0
    s_and_b32 s88, s28, 7
    s_cbranch_scc1 .fl_26
    s_lshl_b32 s88, s28, 4
    s_add_u32 s88, s88, 136183808
    v_mov_b32 v21, s88
    buffer_load_dword v20, v21, s[8:11], 0 offen sc1

.fl_26:
    s_and_b32 s88, s19, 1
    s_or_b32 s88, s88, s18
    s_cbranch_scc1 .fl_27
    s_lshl_b32 s88, s19, 6
    s_add_u32 s88, s88, 136187776
    s_mov_b64 exec, 1
    v_mov_b32 v23, s88
    v_mov_b32 v22, 1
    buffer_atomic_add v22, v23, s[8:11], 0 offen sc1
    s_mov_b64 exec, -1

.fl_27:
    s_waitcnt lgkmcnt(5)
    v_smfmac_f32_16x16x64_bf16 v[48:51], v[24:27], a[0:7], v3
    v_smfmac_f32_16x16x64_bf16 v[52:55], v[24:27], a[80:87], v3
    v_smfmac_f32_16x16x64_bf16 v[56:59], v[24:27], a[160:167], v3
    v_smfmac_f32_16x16x64_bf16 v[60:63], v[24:27], a[240:247], v3
    ds_read_b128 v[24:27], v4 offset:384
    s_waitcnt lgkmcnt(5)
    v_smfmac_f32_16x16x64_bf16 v[48:51], v[28:31], a[8:15], v3
    v_smfmac_f32_16x16x64_bf16 v[52:55], v[28:31], a[88:95], v3
    v_smfmac_f32_16x16x64_bf16 v[56:59], v[28:31], a[168:175], v3
    v_smfmac_f32_16x16x64_bf16 v[60:63], v[28:31], a[248:255], v3
    ds_read_b128 v[28:31], v4 offset:448
    s_waitcnt lgkmcnt(5)
    v_smfmac_f32_16x16x64_bf16 v[48:51], v[32:35], a[16:23], v3
    v_smfmac_f32_16x16x64_bf16 v[52:55], v[32:35], a[96:103], v3
    v_smfmac_f32_16x16x64_bf16 v[56:59], v[32:35], a[176:183], v3
    v_smfmac_f32_16x16x64_bf16 v[60:63], v[32:35], v[112:119], v3
    ds_read_b128 v[32:35], v4 offset:512
    s_waitcnt lgkmcnt(5)
    v_smfmac_f32_16x16x64_bf16 v[48:51], v[36:39], a[24:31], v3
    v_smfmac_f32_16x16x64_bf16 v[52:55], v[36:39], a[104:111], v3
    v_smfmac_f32_16x16x64_bf16 v[56:59], v[36:39], a[184:191], v3
    v_smfmac_f32_16x16x64_bf16 v[60:63], v[36:39], v[120:127], v3
    ds_read_b128 v[36:39], v4 offset:576
    s_waitcnt lgkmcnt(5)
    v_smfmac_f32_16x16x64_bf16 v[48:51], v[40:43], a[32:39], v3
    v_smfmac_f32_16x16x64_bf16 v[52:55], v[40:43], a[112:119], v3
    v_smfmac_f32_16x16x64_bf16 v[56:59], v[40:43], a[192:199], v3
    v_smfmac_f32_16x16x64_bf16 v[60:63], v[40:43], v[128:135], v3
    s_waitcnt lgkmcnt(4)
    v_smfmac_f32_16x16x64_bf16 v[48:51], v[44:47], a[40:47], v3
    v_smfmac_f32_16x16x64_bf16 v[52:55], v[44:47], a[120:127], v3
    v_smfmac_f32_16x16x64_bf16 v[56:59], v[44:47], a[200:207], v3
    v_smfmac_f32_16x16x64_bf16 v[60:63], v[44:47], v[136:143], v3
    s_waitcnt lgkmcnt(3)
    v_smfmac_f32_16x16x64_bf16 v[48:51], v[24:27], a[48:55], v3
    v_smfmac_f32_16x16x64_bf16 v[52:55], v[24:27], a[128:135], v3
    v_smfmac_f32_16x16x64_bf16 v[56:59], v[24:27], a[208:215], v3
    v_smfmac_f32_16x16x64_bf16 v[60:63], v[24:27], v[144:151], v3
    s_waitcnt lgkmcnt(2)
    v_smfmac_f32_16x16x64_bf16 v[48:51], v[28:31], a[56:63], v3
    v_smfmac_f32_16x16x64_bf16 v[52:55], v[28:31], a[136:143], v3
    v_smfmac_f32_16x16x64_bf16 v[56:59], v[28:31], a[216:223], v3
    v_smfmac_f32_16x16x64_bf16 v[60:63], v[28:31], v[152:159], v3
    s_waitcnt lgkmcnt(1)
    v_smfmac_f32_16x16x64_bf16 v[48:51], v[32:35], a[64:71], v3
    v_smfmac_f32_16x16x64_bf16 v[52:55], v[32:35], a[144:151], v3
    v_smfmac_f32_16x16x64_bf16 v[56:59], v[32:35], a[224:231], v3
    v_smfmac_f32_16x16x64_bf16 v[60:63], v[32:35], v[160:167], v3
    s_waitcnt lgkmcnt(0)
    v_smfmac_f32_16x16x64_bf16 v[48:51], v[36:39], a[72:79], v3
    v_smfmac_f32_16x16x64_bf16 v[52:55], v[36:39], a[152:159], v3
    v_smfmac_f32_16x16x64_bf16 v[56:59], v[36:39], a[232:239], v3
    v_smfmac_f32_16x16x64_bf16 v[60:63], v[36:39], v[168:175], v3
    v_smfmac_f32_16x16x64_bf16 v[64:67], v[24:27], v[224:231], v3
    ds_read_b128 v[24:27], v4 offset:0
    s_nop 2
    v_pk_add_f32 v[48:49], v[48:49], v[50:51]
    v_cvt_pk_bf16_f32 v48, v48, v49
    ds_write_b16 v1, v48 offset:0
    ds_write_b16_d16_hi v1, v48 offset:80
    v_pk_add_f32 v[52:53], v[52:53], v[54:55]
    v_cvt_pk_bf16_f32 v52, v52, v53
    ds_write_b16 v1, v52 offset:8
    ds_write_b16_d16_hi v1, v52 offset:88
    ds_read_b128 v[40:43], v2
    v_pk_add_f32 v[56:57], v[56:57], v[58:59]
    v_cvt_pk_bf16_f32 v56, v56, v57
    ds_write_b16 v1, v56 offset:640
    ds_write_b16_d16_hi v1, v56 offset:720
    v_pk_add_f32 v[60:61], v[60:61], v[62:63]
    v_cvt_pk_bf16_f32 v60, v60, v61
    ds_write_b16 v1, v60 offset:648
    ds_write_b16_d16_hi v1, v60 offset:728
    ds_read_b128 v[44:47], v2 offset:640
    v_smfmac_f32_16x16x64_bf16 v[64:67], v[28:31], v[232:239], v3
    ds_read_b128 v[28:31], v4 offset:64
    v_smfmac_f32_16x16x64_bf16 v[64:67], v[32:35], v[240:247], v3
    ds_read_b128 v[32:35], v4 offset:128
    v_smfmac_f32_16x16x64_bf16 v[64:67], v[36:39], v[248:255], v3
    ds_read_b128 v[36:39], v4 offset:192
    s_waitcnt lgkmcnt(8)
    v_mfma_f32_16x16x32_bf16 v[48:51], v[68:71], v[40:43], 0
    v_mfma_f32_16x16x32_bf16 v[52:55], v[72:75], v[40:43], 0
    s_waitcnt lgkmcnt(3)
    v_mfma_f32_16x16x32_bf16 v[56:59], v[44:47], v[40:43], 0
    s_and_b32 s88, s28, 7
    s_cbranch_scc1 .fl_28
    s_waitcnt vmcnt(0)
    v_readfirstlane_b32 s88, v20
    s_cmp_ge_u32 s88, 66
    s_cbranch_scc1 .fl_28
    s_lshl_b32 s91, s28, 4
    s_add_u32 s91, s91, 136183808

    v_mov_b32 v21, s91
    s_mov_b32 s89, 0

.wc_29:
    buffer_load_dword v20, v21, s[84:87], 0 offen sc1
    s_waitcnt vmcnt(0)
    v_readfirstlane_b32 s88, v20
    s_cmp_ge_u32 s88, 66
    s_cbranch_scc1 .wc_30
    s_sleep 4
    s_add_u32 s89, s89, 1
    s_cmp_lt_u32 s89, 1048576
    s_cbranch_scc1 .wc_29
    s_endpgm

.wc_30:
.fl_28:
    s_mov_b64 exec, s[48:49]
    buffer_store_dwordx4 v[44:47], v18, s[8:11], s47 offen sc1
    s_mov_b64 exec, -1
    buffer_load_dwordx4 v[68:71], v16, s[8:11], s29 offen
    buffer_load_dwordx4 v[72:75], v16, s[8:11], s30 offen
    v_smfmac_f32_16x16x64_bf16 v[64:67], v[24:27], v[176:183], v3
    ds_read_b128 v[24:27], v4 offset:256
    v_cndmask_b32_dpp v60, v52, v48, vcc quad_perm:[2,3,0,1] row_mask:0xf bank_mask:0xf
    v_cndmask_b32_dpp v61, v53, v49, vcc quad_perm:[2,3,0,1] row_mask:0xf bank_mask:0xf
    v_cndmask_b32_dpp v62, v54, v50, vcc quad_perm:[2,3,0,1] row_mask:0xf bank_mask:0xf
    v_cndmask_b32_dpp v63, v55, v51, vcc quad_perm:[2,3,0,1] row_mask:0xf bank_mask:0xf
    ds_write_b128 v6, v[60:63]
    v_cndmask_b32_dpp v58, v57, v56, vcc quad_perm:[2,3,0,1] row_mask:0xf bank_mask:0xf
    ds_write_b32 v7, v58
    s_waitcnt lgkmcnt(5)
    v_smfmac_f32_16x16x64_bf16 v[64:67], v[28:31], v[184:191], v3
    ds_read_b128 v[28:31], v4 offset:320
    s_waitcnt lgkmcnt(5)
    v_smfmac_f32_16x16x64_bf16 v[64:67], v[32:35], v[192:199], v3
    s_waitcnt lgkmcnt(0)
    s_barrier
    ds_read_b128 v[48:51], v5 offset:0
    ds_read_b128 v[52:55], v5 offset:1024
    ds_read_b128 v[56:59], v5 offset:2048
    ds_read_b128 v[60:63], v5 offset:3072
    ds_read_b128 v[40:43], v5 offset:4096
    v_smfmac_f32_16x16x64_bf16 v[64:67], v[36:39], v[200:207], v3
    v_smfmac_f32_16x16x64_bf16 v[64:67], v[24:27], v[208:215], v3
    v_smfmac_f32_16x16x64_bf16 v[64:67], v[28:31], v[216:223], v3
    s_waitcnt lgkmcnt(3)
    v_pk_add_f32 v[48:49], v[48:49], v[52:53]
    v_pk_add_f32 v[50:51], v[50:51], v[54:55]
    s_waitcnt lgkmcnt(1)
    v_pk_add_f32 v[56:57], v[56:57], v[60:61]
    v_pk_add_f32 v[58:59], v[58:59], v[62:63]
    s_waitcnt lgkmcnt(0)
    v_pk_add_f32 v[40:41], v[40:41], v[42:43]
    v_pk_add_f32 v[48:49], v[48:49], v[56:57]
    v_pk_add_f32 v[50:51], v[50:51], v[58:59]
    v_add_f32 v52, v40, v41
    v_cvt_pk_bf16_f32 v44, v48, v49
    v_cvt_pk_bf16_f32 v45, v50, v51
    v_cvt_pk_bf16_f32 v46, v52, v52
    v_lshlrev_b32 v48, 16, v44
    v_and_b32 v49, 0xffff0000, v44
    v_lshlrev_b32 v50, 16, v45
    v_and_b32 v51, 0xffff0000, v45
    v_lshlrev_b32 v52, 16, v46
    v_pk_mul_f32 v[48:49], v[48:49], s[42:43]
    v_pk_mul_f32 v[50:51], v[50:51], s[42:43]
    v_mul_f32 v52, s42, v52
    v_cvt_pk_bf16_f32 v44, v48, v49
    v_cvt_pk_bf16_f32 v45, v50, v51
    v_cvt_pk_bf16_f32 v46, v52, v52
    v_lshlrev_b32 v48, 16, v44
    v_and_b32 v49, 0xffff0000, v44
    v_lshlrev_b32 v50, 16, v45
    v_and_b32 v51, 0xffff0000, v45
    v_lshlrev_b32 v52, 16, v46
    v_max3_f32 v44, v48, v49, v50
    v_max3_f32 v44, v44, v51, v52
    s_nop 1
    v_max_f32_dpp v44, v44, v44 quad_perm:[2,3,0,1] row_mask:0xf bank_mask:0xf
    v_mov_b32 v45, v44
    s_nop 1
    v_permlane16_swap_b32 v44, v45
    v_max_f32 v44, v44, v45
    v_mov_b32 v45, v44
    s_nop 1
    v_permlane32_swap_b32 v44, v45
    v_max_f32 v44, v44, v45
    v_mul_f32 v44, s40, v44
    v_sub_f32 v44, 0, v44
    v_mov_b32 v45, v44
    v_pk_fma_f32 v[48:49], v[48:49], s[40:41], v[44:45]
    v_pk_fma_f32 v[50:51], v[50:51], s[40:41], v[44:45]
    v_fma_f32 v52, v52, s40, v44
    v_exp_f32 v48, v48
    v_exp_f32 v49, v49
    v_exp_f32 v50, v50
    v_exp_f32 v51, v51
    v_exp_f32 v52, v52
    v_pk_add_f32 v[44:45], v[48:49], v[50:51]
    v_add_f32 v44, v44, v45
    v_add_f32 v44, v44, v52
    s_nop 1
    v_add_f32_dpp v44, v44, v44 quad_perm:[2,3,0,1] row_mask:0xf bank_mask:0xf
    v_mov_b32 v45, v44
    s_nop 1
    v_permlane16_swap_b32 v44, v45
    v_add_f32 v44, v44, v45
    v_mov_b32 v45, v44
    s_nop 1
    v_permlane32_swap_b32 v44, v45
    v_add_f32 v44, v44, v45
    v_rcp_f32 v44, v44
    s_nop 0
    v_mov_b32 v45, v44
    v_pk_mul_f32 v[48:49], v[48:49], v[44:45]
    v_pk_mul_f32 v[50:51], v[50:51], v[44:45]
    v_mul_f32 v52, v52, v44
    v_cvt_pk_bf16_f32 v56, v48, v49
    v_cvt_pk_bf16_f32 v57, v50, v51
    v_mov_b32_dpp v53, v52 quad_perm:[2,3,0,1] row_mask:0xf bank_mask:0xf
    v_mov_b32_dpp v58, v56 quad_perm:[2,3,0,1] row_mask:0xf bank_mask:0xf
    v_mov_b32_dpp v59, v57 quad_perm:[2,3,0,1] row_mask:0xf bank_mask:0xf
    v_cvt_pk_bf16_f32 v60, v52, v53
    v_mov_b32 v61, 0
    v_mfma_f32_16x16x32_bf16 v[40:43], v[76:79], v[56:59], 0
    v_pk_add_f32 v[64:65], v[64:65], v[66:67]
    v_cvt_pk_bf16_f32 v62, v64, v65
    v_mov_b32 v63, 0
    s_nop 2
    v_mfma_f32_16x16x16_bf16 v[40:43], v[62:63], v[60:61], v[40:43]
    buffer_store_dword v62, v19, s[8:11], s47 offen sc1
    buffer_load_dwordx4 v[76:79], v17, s[8:11], s31 offen
    s_cmp_eq_u32 s19, 63
    s_cbranch_scc1 .k2_fin
    ds_read_b128 v[24:27], v10 offset:0
    ds_read_b128 v[28:31], v10 offset:64
    ds_read_b128 v[32:35], v10 offset:2304
    ds_read_b128 v[36:39], v10 offset:2368
    v_cvt_pk_bf16_f32 v48, v40, v41
    v_cvt_pk_bf16_f32 v49, v42, v43
    ds_write_b64 v8, v[48:49]
    ds_read_b128 v[40:43], v10 offset:4608
    ds_read_b128 v[44:47], v10 offset:4672
    s_waitcnt lgkmcnt(0)
    s_barrier
    ds_read_b128 v[64:67], v9
    ds_read_b128 v[20:23], v9 offset:64
    s_waitcnt lgkmcnt(1)
    v_mfma_f32_16x16x32_bf16 v[48:51], v[24:27], v[64:67], 0
    v_mfma_f32_16x16x32_bf16 v[52:55], v[32:35], v[64:67], 0
    s_waitcnt lgkmcnt(0)
    v_mfma_f32_16x16x32_bf16 v[48:51], v[28:31], v[20:23], v[48:51]
    v_mfma_f32_16x16x32_bf16 v[52:55], v[36:39], v[20:23], v[52:55]
    ds_read_b128 v[24:27], v10 offset:16128
    ds_read_b128 v[28:31], v10 offset:16192
    ds_read_b128 v[32:35], v10 offset:18432
    ds_read_b128 v[36:39], v10 offset:18496
    v_mfma_f32_16x16x32_bf16 v[56:59], v[40:43], v[64:67], 0
    v_mfma_f32_16x16x32_bf16 v[60:63], v[80:83], v[64:67], 0
    v_mfma_f32_16x16x32_bf16 v[56:59], v[44:47], v[20:23], v[56:59]
    v_mfma_f32_16x16x32_bf16 v[60:63], v[84:87], v[20:23], v[60:63]
    ds_read_b128 v[40:43], v10 offset:20736
    ds_read_b128 v[44:47], v10 offset:20800
    v_cndmask_b32_dpp v48, v52, v48, vcc quad_perm:[2,3,0,1] row_mask:0xf bank_mask:0xf
    v_cndmask_b32_dpp v49, v53, v49, vcc quad_perm:[2,3,0,1] row_mask:0xf bank_mask:0xf
    v_cndmask_b32_dpp v50, v54, v50, vcc quad_perm:[2,3,0,1] row_mask:0xf bank_mask:0xf
    v_cndmask_b32_dpp v51, v55, v51, vcc quad_perm:[2,3,0,1] row_mask:0xf bank_mask:0xf
    v_and_or_b32 v48, v48, -4, s20
    v_and_or_b32 v49, v49, -4, s20
    v_and_or_b32 v50, v50, -4, s20
    v_and_or_b32 v51, v51, -4, s20
    buffer_store_dwordx4 v[48:51], v11, s[8:11], 0 offen offset:0 sc1
    v_mfma_f32_16x16x32_bf16 v[48:51], v[88:91], v[64:67], 0
    v_mfma_f32_16x16x32_bf16 v[52:55], v[96:99], v[64:67], 0
    v_mfma_f32_16x16x32_bf16 v[48:51], v[92:95], v[20:23], v[48:51]
    v_mfma_f32_16x16x32_bf16 v[52:55], v[100:103], v[20:23], v[52:55]
    v_cndmask_b32_dpp v56, v60, v56, vcc quad_perm:[2,3,0,1] row_mask:0xf bank_mask:0xf
    v_cndmask_b32_dpp v57, v61, v57, vcc quad_perm:[2,3,0,1] row_mask:0xf bank_mask:0xf
    v_cndmask_b32_dpp v58, v62, v58, vcc quad_perm:[2,3,0,1] row_mask:0xf bank_mask:0xf
    v_cndmask_b32_dpp v59, v63, v59, vcc quad_perm:[2,3,0,1] row_mask:0xf bank_mask:0xf
    v_and_or_b32 v56, v56, -4, s20
    v_and_or_b32 v57, v57, -4, s20
    v_and_or_b32 v58, v58, -4, s20
    v_and_or_b32 v59, v59, -4, s20
    buffer_store_dwordx4 v[56:59], v11, s[8:11], 0 offen offset:128 sc1
    v_mfma_f32_16x16x32_bf16 v[56:59], v[104:107], v[64:67], 0
    s_waitcnt lgkmcnt(5)
    v_mfma_f32_16x16x32_bf16 v[60:63], v[24:27], v[64:67], 0
    v_mfma_f32_16x16x32_bf16 v[56:59], v[108:111], v[20:23], v[56:59]
    s_waitcnt lgkmcnt(4)
    v_mfma_f32_16x16x32_bf16 v[60:63], v[28:31], v[20:23], v[60:63]
    v_cndmask_b32_dpp v48, v52, v48, vcc quad_perm:[2,3,0,1] row_mask:0xf bank_mask:0xf
    v_cndmask_b32_dpp v49, v53, v49, vcc quad_perm:[2,3,0,1] row_mask:0xf bank_mask:0xf
    v_cndmask_b32_dpp v50, v54, v50, vcc quad_perm:[2,3,0,1] row_mask:0xf bank_mask:0xf
    v_cndmask_b32_dpp v51, v55, v51, vcc quad_perm:[2,3,0,1] row_mask:0xf bank_mask:0xf
    v_and_or_b32 v48, v48, -4, s20
    v_and_or_b32 v49, v49, -4, s20
    v_and_or_b32 v50, v50, -4, s20
    v_and_or_b32 v51, v51, -4, s20
    buffer_store_dwordx4 v[48:51], v11, s[8:11], 0 offen offset:256 sc1
    s_waitcnt lgkmcnt(3)
    v_mfma_f32_16x16x32_bf16 v[48:51], v[32:35], v[64:67], 0
    s_waitcnt lgkmcnt(1)
    v_mfma_f32_16x16x32_bf16 v[52:55], v[40:43], v[64:67], 0
    v_mfma_f32_16x16x32_bf16 v[48:51], v[36:39], v[20:23], v[48:51]
    s_waitcnt lgkmcnt(0)
    v_mfma_f32_16x16x32_bf16 v[52:55], v[44:47], v[20:23], v[52:55]
    v_cndmask_b32_dpp v56, v60, v56, vcc quad_perm:[2,3,0,1] row_mask:0xf bank_mask:0xf
    v_cndmask_b32_dpp v57, v61, v57, vcc quad_perm:[2,3,0,1] row_mask:0xf bank_mask:0xf
    v_cndmask_b32_dpp v58, v62, v58, vcc quad_perm:[2,3,0,1] row_mask:0xf bank_mask:0xf
    v_cndmask_b32_dpp v59, v63, v59, vcc quad_perm:[2,3,0,1] row_mask:0xf bank_mask:0xf
    v_and_or_b32 v56, v56, -4, s20
    v_and_or_b32 v57, v57, -4, s20
    v_and_or_b32 v58, v58, -4, s20
    v_and_or_b32 v59, v59, -4, s20
    buffer_store_dwordx4 v[56:59], v11, s[8:11], 0 offen offset:384 sc1
    v_cndmask_b32_dpp v48, v52, v48, vcc quad_perm:[2,3,0,1] row_mask:0xf bank_mask:0xf
    v_cndmask_b32_dpp v49, v53, v49, vcc quad_perm:[2,3,0,1] row_mask:0xf bank_mask:0xf
    v_cndmask_b32_dpp v50, v54, v50, vcc quad_perm:[2,3,0,1] row_mask:0xf bank_mask:0xf
    v_cndmask_b32_dpp v51, v55, v51, vcc quad_perm:[2,3,0,1] row_mask:0xf bank_mask:0xf
    v_and_or_b32 v48, v48, -4, s20
    v_and_or_b32 v49, v49, -4, s20
    v_and_or_b32 v50, v50, -4, s20
    v_and_or_b32 v51, v51, -4, s20
    buffer_store_dwordx4 v[48:51], v11, s[8:11], 0 offen offset:512 sc1
    s_mov_b32 s22, 0
    s_mov_b64 exec, s[26:27]

    s_waitcnt vmcnt(0)
.k2_h1M:
    buffer_load_dwordx4 v[24:27], v12, s[8:11], 0 offen offset:0 sc1
    buffer_load_dwordx4 v[28:31], v12, s[8:11], 0 offen offset:640 sc1
    buffer_load_dwordx4 v[32:35], v12, s[8:11], 0 offen offset:1280 sc1
    buffer_load_dwordx4 v[36:39], v12, s[8:11], 0 offen offset:1920 sc1
    buffer_load_dwordx4 v[40:43], v12, s[8:11], s44 offen offset:0 sc1
    buffer_load_dwordx4 v[44:47], v12, s[8:11], s44 offen offset:640 sc1
    buffer_load_dwordx4 v[48:51], v12, s[8:11], s44 offen offset:1280 sc1
    buffer_load_dwordx4 v[52:55], v12, s[8:11], s44 offen offset:1920 sc1
    s_mov_b64 exec, s[26:27]
    s_waitcnt vmcnt(0)
    v_or3_b32 v56, v24, v28, v32
    v_or3_b32 v57, v25, v29, v33
    v_or3_b32 v58, v26, v30, v34
    v_or3_b32 v59, v27, v31, v35
    v_or3_b32 v56, v56, v36, v40
    v_or3_b32 v57, v57, v37, v41
    v_or3_b32 v58, v58, v38, v42
    v_or3_b32 v59, v59, v39, v43
    v_or3_b32 v56, v56, v44, v48
    v_or3_b32 v57, v57, v45, v49
    v_or3_b32 v58, v58, v46, v50
    v_or3_b32 v59, v59, v47, v51
    v_or_b32 v56, v56, v52
    v_or_b32 v57, v57, v53
    v_or_b32 v58, v58, v54
    v_or_b32 v59, v59, v55
    v_or3_b32 v56, v56, v57, v58
    v_or_b32 v56, v56, v59
    v_and_b32 v56, 3, v56
    v_cmp_ne_u32 s[32:33], s20, v56
    s_cmp_eq_u64 s[32:33], 0
    s_cbranch_scc1 .k2_h1okM
    s_mov_b64 exec, s[32:33]
    s_add_u32 s22, s22, 1
    s_cmp_lt_u32 s22, 1048576
    s_cbranch_scc1 .k2_h1M
    s_endpgm

.k2_h1okM:
    s_mov_b64 exec, -1
    v_pk_add_f32 v[24:25], v[24:25], v[40:41]
    v_pk_add_f32 v[26:27], v[26:27], v[42:43]
    v_pk_add_f32 v[28:29], v[28:29], v[44:45]
    v_pk_add_f32 v[30:31], v[30:31], v[46:47]
    v_pk_add_f32 v[32:33], v[32:33], v[48:49]
    v_pk_add_f32 v[34:35], v[34:35], v[50:51]
    v_pk_add_f32 v[36:37], v[36:37], v[52:53]
    v_pk_add_f32 v[38:39], v[38:39], v[54:55]
    v_pk_add_f32 v[24:25], v[24:25], v[32:33]
    v_pk_add_f32 v[26:27], v[26:27], v[34:35]
    v_pk_add_f32 v[28:29], v[28:29], v[36:37]
    v_pk_add_f32 v[30:31], v[30:31], v[38:39]
    v_pk_add_f32 v[24:25], v[24:25], v[28:29]
    v_pk_add_f32 v[26:27], v[26:27], v[30:31]
    s_nop 1
    v_permlane32_swap_b32 v24, v26
    v_permlane32_swap_b32 v25, v27
    v_pk_add_f32 v[24:25], v[24:25], v[26:27]
    s_nop 1
    v_permlane16_swap_b32 v24, v25
    v_add_f32 v24, v24, v25
    v_and_or_b32 v24, v24, -4, s21
    v_mov_b32 v25, v24
    s_nop 1
    v_permlane16_swap_b32 v24, v25
    v_mov_b32 v26, v24
    v_mov_b32 v27, v25
    s_nop 0
    v_permlane32_swap_b32 v24, v26
    v_permlane32_swap_b32 v25, v27
    s_mov_b64 exec, s[34:35]
    buffer_store_dwordx4 v[24:27], v13, s[8:11], s45 offen sc1
    s_mov_b64 exec, s[38:39]
    buffer_store_dwordx4 v[24:27], v13, s[8:11], 0 offen sc1
    s_mov_b64 exec, -1
    s_nop 1
    s_mov_b32 s22, 0
.k2_h2oM:
    buffer_load_dwordx4 v[28:31], v14, s[8:11], s50 offen sc1
    buffer_load_dwordx4 v[32:35], v14, s[8:11], s51 offen sc1
    buffer_load_dwordx4 v[36:39], v14, s[8:11], s52 offen sc1
    buffer_load_dwordx4 v[40:43], v14, s[8:11], s53 offen sc1
    buffer_load_dwordx4 v[44:47], v14, s[8:11], s54 offen sc1
    s_mov_b64 exec, -1
    s_waitcnt vmcnt(0)
.k2_h2ocM:
    v_or3_b32 v20, v28, v32, v36
    v_or3_b32 v21, v29, v33, v37
    v_or3_b32 v22, v30, v34, v38
    v_or3_b32 v23, v31, v35, v39
    v_or3_b32 v20, v20, v40, v44
    v_or3_b32 v21, v21, v41, v45
    v_or3_b32 v22, v22, v42, v46
    v_or3_b32 v23, v23, v43, v47
    v_or3_b32 v20, v20, v21, v22
    v_or_b32 v20, v20, v23
    v_and_b32 v20, 3, v20
    v_cmp_ne_u32 s[32:33], s21, v20
    s_cmp_eq_u64 s[32:33], 0
    s_cbranch_scc1 .k2_h2ookM
    s_mov_b64 exec, s[32:33]
    s_add_u32 s22, s22, 1
    s_cmp_lt_u32 s22, 1048576
    s_cbranch_scc1 .k2_h2oM
    s_endpgm

.k2_h2ookM:
.k2_h2rM:
    buffer_load_dwordx4 v[48:51], v14, s[8:11], s55 offen sc1
    buffer_load_dwordx4 v[52:55], v14, s[8:11], s56 offen sc1
    buffer_load_dwordx4 v[56:59], v14, s[8:11], s57 offen sc1
    buffer_load_dwordx4 v[60:63], v14, s[8:11], s58 offen sc1
    buffer_load_dwordx4 v[64:67], v14, s[8:11], s59 offen sc1
    s_mov_b64 exec, -1
    s_waitcnt vmcnt(0)
.k2_h2rcM:
    v_or3_b32 v20, v48, v52, v56
    v_or3_b32 v21, v49, v53, v57
    v_or3_b32 v22, v50, v54, v58
    v_or3_b32 v23, v51, v55, v59
    v_or3_b32 v20, v20, v60, v64
    v_or3_b32 v21, v21, v61, v65
    v_or3_b32 v22, v22, v62, v66
    v_or3_b32 v23, v23, v63, v67
    v_or3_b32 v20, v20, v21, v22
    v_or_b32 v20, v20, v23
    v_and_b32 v20, 3, v20
    v_cmp_ne_u32 s[32:33], s21, v20
    s_cmp_eq_u64 s[32:33], 0
    s_cbranch_scc1 .k2_h2rokM
    s_mov_b64 exec, s[32:33]
    s_add_u32 s22, s22, 1
    s_cmp_lt_u32 s22, 1048576
    s_cbranch_scc1 .k2_h2rM
    s_endpgm

.k2_h2rokM:
    v_pk_add_f32 v[28:29], v[28:29], v[48:49]
    v_pk_add_f32 v[30:31], v[30:31], v[50:51]
    v_cvt_pk_bf16_f32 v28, v28, v29
    v_cvt_pk_bf16_f32 v29, v30, v31
    ds_write_b32 v15, v28 offset:0
    ds_write_b32 v15, v29 offset:1312
    v_pk_add_f32 v[32:33], v[32:33], v[52:53]
    v_pk_add_f32 v[34:35], v[34:35], v[54:55]
    v_cvt_pk_bf16_f32 v32, v32, v33
    v_cvt_pk_bf16_f32 v33, v34, v35
    ds_write_b32 v15, v32 offset:32
    ds_write_b32 v15, v33 offset:1344
    v_pk_add_f32 v[36:37], v[36:37], v[56:57]
    v_pk_add_f32 v[38:39], v[38:39], v[58:59]
    v_cvt_pk_bf16_f32 v36, v36, v37
    v_cvt_pk_bf16_f32 v37, v38, v39
    ds_write_b32 v15, v36 offset:64
    ds_write_b32 v15, v37 offset:1376
    v_pk_add_f32 v[40:41], v[40:41], v[60:61]
    v_pk_add_f32 v[42:43], v[42:43], v[62:63]
    v_cvt_pk_bf16_f32 v40, v40, v41
    v_cvt_pk_bf16_f32 v41, v42, v43
    ds_write_b32 v15, v40 offset:96
    ds_write_b32 v15, v41 offset:1408
    v_pk_add_f32 v[44:45], v[44:45], v[64:65]
    v_pk_add_f32 v[46:47], v[46:47], v[66:67]
    v_cvt_pk_bf16_f32 v44, v44, v45
    v_cvt_pk_bf16_f32 v45, v46, v47
    ds_write_b32 v15, v44 offset:128
    ds_write_b32 v15, v45 offset:1440
    v_add_u32 v13, s46, v13
    v_add_u32 v14, s46, v14
    s_sub_u32 s46, 0, s46
    s_add_u32 s19, s19, 1
    s_xor_b32 s20, s20, 3
    s_lshr_b32 s28, s19, 1
    s_and_b32 s28, s28, 1
    s_lshl_b32 s21, 1, s28
    s_branch .k2_stepM

.k2_fin:
    s_waitcnt vmcnt(0)
    s_endpgm
.globl k3_attn_kernel
.p2align 8
.type k3_attn_kernel,@function
k3_attn_kernel:
    s_cmp_ge_u32 s2, 384
    s_cbranch_scc1 .k3_end
    s_add_u32 s2, s2, 1664

    s_load_dwordx2 s[4:5], s[0:1], 96
    v_lshrrev_b32 v1, 6, v0
    s_nop 1
    v_readfirstlane_b32 s18, v1
    v_and_b32 v1, 63, v0
    s_waitcnt lgkmcnt(0)
    s_mov_b32 s8, s4
    s_mov_b32 s9, s5
    s_mov_b32 s10, 268435456
    s_mov_b32 s11, 0x00020000
    s_mov_b32 s40, 0x3fb8aa3b

    s_mov_b32 s16, s2
    s_add_u32 s16, s16, s18
    s_and_b32 s17, s16, 31
    s_lshr_b32 s16, s16, 5
    s_mov_b32 s41, 0x3db504f3
    v_and_b32 v2, 31, v1
    v_lshrrev_b32 v3, 5, v1
    s_lshl_b32 s28, s16, 19
    s_lshl_b32 s29, s17, 8
    s_add_u32 s28, s28, s29
    s_add_u32 s28, s28, 33554432
    v_lshlrev_b32 v4, 14, v2
    v_lshlrev_b32 v5, 5, v3
    v_add_u32 v4, v4, v5
    v_add_u32 v4, s28, v4
    v_add_u32 v6, 0x2000, v4
    s_lshl_b32 s28, s16, 16
    s_lshl_b32 s29, s17, 11
    s_add_u32 s28, s28, s29
    s_add_u32 s28, s28, 121634816
    v_and_b32 v7, 7, v2
    v_lshlrev_b32 v7, 8, v7
    v_add_u32 v7, v7, v5
    v_add_u32 v7, s28, v7
    buffer_load_dwordx4 v[16:19], v4, s[8:11], 0 offen offset:0
    buffer_load_dwordx4 v[48:51], v6, s[8:11], 0 offen offset:0
    buffer_load_dwordx4 v[80:83], v7, s[8:11], 0 offen offset:0
    buffer_load_dwordx4 v[20:23], v4, s[8:11], 0 offen offset:16
    buffer_load_dwordx4 v[52:55], v6, s[8:11], 0 offen offset:16
    buffer_load_dwordx4 v[84:87], v7, s[8:11], 0 offen offset:16
    buffer_load_dwordx4 v[24:27], v4, s[8:11], 0 offen offset:64
    buffer_load_dwordx4 v[56:59], v6, s[8:11], 0 offen offset:64
    buffer_load_dwordx4 v[88:91], v7, s[8:11], 0 offen offset:64
    buffer_load_dwordx4 v[28:31], v4, s[8:11], 0 offen offset:80
    buffer_load_dwordx4 v[60:63], v6, s[8:11], 0 offen offset:80
    buffer_load_dwordx4 v[92:95], v7, s[8:11], 0 offen offset:80
    buffer_load_dwordx4 v[32:35], v4, s[8:11], 0 offen offset:128
    buffer_load_dwordx4 v[64:67], v6, s[8:11], 0 offen offset:128
    buffer_load_dwordx4 v[96:99], v7, s[8:11], 0 offen offset:128
    buffer_load_dwordx4 v[36:39], v4, s[8:11], 0 offen offset:144
    buffer_load_dwordx4 v[68:71], v6, s[8:11], 0 offen offset:144
    buffer_load_dwordx4 v[100:103], v7, s[8:11], 0 offen offset:144
    buffer_load_dwordx4 v[40:43], v4, s[8:11], 0 offen offset:192
    buffer_load_dwordx4 v[72:75], v6, s[8:11], 0 offen offset:192
    buffer_load_dwordx4 v[104:107], v7, s[8:11], 0 offen offset:192
    buffer_load_dwordx4 v[44:47], v4, s[8:11], 0 offen offset:208
    buffer_load_dwordx4 v[76:79], v6, s[8:11], 0 offen offset:208
    buffer_load_dwordx4 v[108:111], v7, s[8:11], 0 offen offset:208
    s_lshl_b32 s28, s17, 19
    s_lshl_b32 s29, s16, 6
    s_add_u32 s28, s28, s29
    s_add_u32 s28, s28, 67108864
    v_lshlrev_b32 v8, 12, v2
    v_lshlrev_b32 v5, 3, v3
    v_add_u32 v8, v8, v5
    v_add_u32 v8, s28, v8
    s_lshl_b32 s28, s16, 16
    s_lshl_b32 s29, s17, 11
    s_add_u32 s28, s28, s29
    s_add_u32 s28, s28, 125829120
    v_lshlrev_b32 v9, 4, v2
    v_add_u32 v9, v9, v5
    v_add_u32 v9, s28, v9
    s_mov_b32 s28, 0
    buffer_load_dwordx2 v[144:145], v8, s[8:11], s28 offen
    buffer_load_dwordx2 v[146:147], v8, s[8:11], s28 offen offset:16
    buffer_load_dwordx2 v[148:149], v8, s[8:11], s28 offen offset:32
    buffer_load_dwordx2 v[150:151], v8, s[8:11], s28 offen offset:48
    buffer_load_dwordx2 v[152:153], v9, s[8:11], 0 offen offset:0
    v_mov_b32 v154, 0
    v_mov_b32 v155, 0
    s_add_u32 s28, s28, 0x20000
    buffer_load_dwordx2 v[156:157], v8, s[8:11], s28 offen
    buffer_load_dwordx2 v[158:159], v8, s[8:11], s28 offen offset:16
    buffer_load_dwordx2 v[160:161], v8, s[8:11], s28 offen offset:32
    buffer_load_dwordx2 v[162:163], v8, s[8:11], s28 offen offset:48
    buffer_load_dwordx2 v[164:165], v9, s[8:11], 0 offen offset:512
    v_mov_b32 v166, 0
    v_mov_b32 v167, 0
    s_add_u32 s28, s28, 0x20000
    buffer_load_dwordx2 v[168:169], v8, s[8:11], s28 offen
    buffer_load_dwordx2 v[170:171], v8, s[8:11], s28 offen offset:16
    buffer_load_dwordx2 v[172:173], v8, s[8:11], s28 offen offset:32
    buffer_load_dwordx2 v[174:175], v8, s[8:11], s28 offen offset:48
    buffer_load_dwordx2 v[176:177], v9, s[8:11], 0 offen offset:1024
    v_mov_b32 v178, 0
    v_mov_b32 v179, 0
    s_add_u32 s28, s28, 0x20000
    buffer_load_dwordx2 v[180:181], v8, s[8:11], s28 offen
    buffer_load_dwordx2 v[182:183], v8, s[8:11], s28 offen offset:16
    buffer_load_dwordx2 v[184:185], v8, s[8:11], s28 offen offset:32
    buffer_load_dwordx2 v[186:187], v8, s[8:11], s28 offen offset:48
    buffer_load_dwordx2 v[188:189], v9, s[8:11], 0 offen offset:1536
    v_mov_b32 v190, 0
    v_mov_b32 v191, 0
    s_add_u32 s28, s28, 0x20000
    s_waitcnt vmcnt(20)
    v_mfma_f32_32x32x16_bf16 v[112:127], v[48:51], v[16:19], 0
    v_mfma_f32_32x32x16_bf16 v[112:127], v[52:55], v[20:23], v[112:127]
    v_mfma_f32_32x32x16_bf16 v[112:127], v[56:59], v[24:27], v[112:127]
    v_mfma_f32_32x32x16_bf16 v[112:127], v[60:63], v[28:31], v[112:127]
    v_mfma_f32_32x32x16_bf16 v[112:127], v[64:67], v[32:35], v[112:127]
    v_mfma_f32_32x32x16_bf16 v[112:127], v[68:71], v[36:39], v[112:127]
    v_mfma_f32_32x32x16_bf16 v[112:127], v[72:75], v[40:43], v[112:127]
    v_mfma_f32_32x32x16_bf16 v[112:127], v[76:79], v[44:47], v[112:127]
    v_mfma_f32_32x32x16_bf16 v[128:143], v[80:83], v[16:19], 0
    v_mfma_f32_32x32x16_bf16 v[128:143], v[84:87], v[20:23], v[128:143]
    v_mfma_f32_32x32x16_bf16 v[128:143], v[88:91], v[24:27], v[128:143]
    v_mfma_f32_32x32x16_bf16 v[128:143], v[92:95], v[28:31], v[128:143]
    v_mfma_f32_32x32x16_bf16 v[128:143], v[96:99], v[32:35], v[128:143]
    v_mfma_f32_32x32x16_bf16 v[128:143], v[100:103], v[36:39], v[128:143]
    v_mfma_f32_32x32x16_bf16 v[128:143], v[104:107], v[40:43], v[128:143]
    v_mfma_f32_32x32x16_bf16 v[128:143], v[108:111], v[44:47], v[128:143]
    s_nop 15
    s_nop 7
    v_cvt_pk_bf16_f32 v16, v112, v113
    v_lshlrev_b32 v112, 16, v16
    v_and_b32 v113, 0xffff0000, v16
    v_cvt_pk_bf16_f32 v16, v114, v115
    v_lshlrev_b32 v114, 16, v16
    v_and_b32 v115, 0xffff0000, v16
    v_cvt_pk_bf16_f32 v16, v116, v117
    v_lshlrev_b32 v116, 16, v16
    v_and_b32 v117, 0xffff0000, v16
    v_cvt_pk_bf16_f32 v16, v118, v119
    v_lshlrev_b32 v118, 16, v16
    v_and_b32 v119, 0xffff0000, v16
    v_cvt_pk_bf16_f32 v16, v120, v121
    v_lshlrev_b32 v120, 16, v16
    v_and_b32 v121, 0xffff0000, v16
    v_cvt_pk_bf16_f32 v16, v122, v123
    v_lshlrev_b32 v122, 16, v16
    v_and_b32 v123, 0xffff0000, v16
    v_cvt_pk_bf16_f32 v16, v124, v125
    v_lshlrev_b32 v124, 16, v16
    v_and_b32 v125, 0xffff0000, v16
    v_cvt_pk_bf16_f32 v16, v126, v127
    v_lshlrev_b32 v126, 16, v16
    v_and_b32 v127, 0xffff0000, v16
    v_cvt_pk_bf16_f32 v16, v128, v129
    v_lshlrev_b32 v128, 16, v16
    v_and_b32 v129, 0xffff0000, v16
    v_cvt_pk_bf16_f32 v16, v130, v131
    v_lshlrev_b32 v130, 16, v16
    v_and_b32 v131, 0xffff0000, v16
    v_mul_f32 v112, s41, v112
    v_mul_f32 v113, s41, v113
    v_mul_f32 v114, s41, v114
    v_mul_f32 v115, s41, v115
    v_mul_f32 v116, s41, v116
    v_mul_f32 v117, s41, v117
    v_mul_f32 v118, s41, v118
    v_mul_f32 v119, s41, v119
    v_mul_f32 v120, s41, v120
    v_mul_f32 v121, s41, v121
    v_mul_f32 v122, s41, v122
    v_mul_f32 v123, s41, v123
    v_mul_f32 v124, s41, v124
    v_mul_f32 v125, s41, v125
    v_mul_f32 v126, s41, v126
    v_mul_f32 v127, s41, v127
    v_mul_f32 v128, s41, v128
    v_mul_f32 v129, s41, v129
    v_mul_f32 v130, s41, v130
    v_mul_f32 v131, s41, v131
    v_cvt_pk_bf16_f32 v16, v112, v113
    v_lshlrev_b32 v112, 16, v16
    v_and_b32 v113, 0xffff0000, v16
    v_cvt_pk_bf16_f32 v16, v114, v115
    v_lshlrev_b32 v114, 16, v16
    v_and_b32 v115, 0xffff0000, v16
    v_cvt_pk_bf16_f32 v16, v116, v117
    v_lshlrev_b32 v116, 16, v16
    v_and_b32 v117, 0xffff0000, v16
    v_cvt_pk_bf16_f32 v16, v118, v119
    v_lshlrev_b32 v118, 16, v16
    v_and_b32 v119, 0xffff0000, v16
    v_cvt_pk_bf16_f32 v16, v120, v121
    v_lshlrev_b32 v120, 16, v16
    v_and_b32 v121, 0xffff0000, v16
    v_cvt_pk_bf16_f32 v16, v122, v123
    v_lshlrev_b32 v122, 16, v16
    v_and_b32 v123, 0xffff0000, v16
    v_cvt_pk_bf16_f32 v16, v124, v125
    v_lshlrev_b32 v124, 16, v16
    v_and_b32 v125, 0xffff0000, v16
    v_cvt_pk_bf16_f32 v16, v126, v127
    v_lshlrev_b32 v126, 16, v16
    v_and_b32 v127, 0xffff0000, v16
    v_cvt_pk_bf16_f32 v16, v128, v129
    v_lshlrev_b32 v128, 16, v16
    v_and_b32 v129, 0xffff0000, v16
    v_cvt_pk_bf16_f32 v16, v130, v131
    v_lshlrev_b32 v130, 16, v16
    v_and_b32 v131, 0xffff0000, v16
    v_mov_b32 v17, 0xf149f2ca
    v_lshlrev_b32 v18, 2, v3
    v_sub_u32 v18, v2, v18
    v_cmp_le_i32 vcc, 0, v18
    s_nop 1
    v_cndmask_b32 v112, v17, v112, vcc
    v_cmp_le_i32 vcc, 1, v18
    s_nop 1
    v_cndmask_b32 v113, v17, v113, vcc
    v_cmp_le_i32 vcc, 2, v18
    s_nop 1
    v_cndmask_b32 v114, v17, v114, vcc
    v_cmp_le_i32 vcc, 3, v18
    s_nop 1
    v_cndmask_b32 v115, v17, v115, vcc
    v_cmp_le_i32 vcc, 8, v18
    s_nop 1
    v_cndmask_b32 v116, v17, v116, vcc
    v_cmp_le_i32 vcc, 9, v18
    s_nop 1
    v_cndmask_b32 v117, v17, v117, vcc
    v_cmp_le_i32 vcc, 10, v18
    s_nop 1
    v_cndmask_b32 v118, v17, v118, vcc
    v_cmp_le_i32 vcc, 11, v18
    s_nop 1
    v_cndmask_b32 v119, v17, v119, vcc
    v_cmp_le_i32 vcc, 16, v18
    s_nop 1
    v_cndmask_b32 v120, v17, v120, vcc
    v_cmp_le_i32 vcc, 17, v18
    s_nop 1
    v_cndmask_b32 v121, v17, v121, vcc
    v_cmp_le_i32 vcc, 18, v18
    s_nop 1
    v_cndmask_b32 v122, v17, v122, vcc
    v_cmp_le_i32 vcc, 19, v18
    s_nop 1
    v_cndmask_b32 v123, v17, v123, vcc
    v_cmp_le_i32 vcc, 24, v18
    s_nop 1
    v_cndmask_b32 v124, v17, v124, vcc
    v_cmp_le_i32 vcc, 25, v18
    s_nop 1
    v_cndmask_b32 v125, v17, v125, vcc
    v_cmp_le_i32 vcc, 26, v18
    s_nop 1
    v_cndmask_b32 v126, v17, v126, vcc
    v_cmp_le_i32 vcc, 27, v18
    s_nop 1
    v_cndmask_b32 v127, v17, v127, vcc
    v_max3_f32 v19, v112, v113, v114
    v_max3_f32 v19, v19, v115, v116
    v_max3_f32 v19, v19, v117, v118
    v_max3_f32 v19, v19, v119, v120
    v_max3_f32 v19, v19, v121, v122
    v_max3_f32 v19, v19, v123, v124
    v_max3_f32 v19, v19, v125, v126
    v_max3_f32 v19, v19, v127, v128
    v_max3_f32 v19, v19, v129, v130
    v_max_f32 v19, v19, v131
    v_mov_b32 v20, v19
    v_mov_b32 v21, v19
    s_nop 1
    v_permlane32_swap_b32 v20, v21
    s_nop 1
    v_max_f32 v19, v20, v21
    v_sub_f32 v112, v112, v19
    v_sub_f32 v113, v113, v19
    v_sub_f32 v114, v114, v19
    v_sub_f32 v115, v115, v19
    v_sub_f32 v116, v116, v19
    v_sub_f32 v117, v117, v19
    v_sub_f32 v118, v118, v19
    v_sub_f32 v119, v119, v19
    v_sub_f32 v120, v120, v19
    v_sub_f32 v121, v121, v19
    v_sub_f32 v122, v122, v19
    v_sub_f32 v123, v123, v19
    v_sub_f32 v124, v124, v19
    v_sub_f32 v125, v125, v19
    v_sub_f32 v126, v126, v19
    v_sub_f32 v127, v127, v19
    v_sub_f32 v128, v128, v19
    v_sub_f32 v129, v129, v19
    v_sub_f32 v130, v130, v19
    v_sub_f32 v131, v131, v19
    v_mul_f32 v112, s40, v112
    v_mul_f32 v113, s40, v113
    v_mul_f32 v114, s40, v114
    v_mul_f32 v115, s40, v115
    v_mul_f32 v116, s40, v116
    v_mul_f32 v117, s40, v117
    v_mul_f32 v118, s40, v118
    v_mul_f32 v119, s40, v119
    v_mul_f32 v120, s40, v120
    v_mul_f32 v121, s40, v121
    v_mul_f32 v122, s40, v122
    v_mul_f32 v123, s40, v123
    v_mul_f32 v124, s40, v124
    v_mul_f32 v125, s40, v125
    v_mul_f32 v126, s40, v126
    v_mul_f32 v127, s40, v127
    v_mul_f32 v128, s40, v128
    v_mul_f32 v129, s40, v129
    v_mul_f32 v130, s40, v130
    v_mul_f32 v131, s40, v131
    v_exp_f32 v112, v112
    v_exp_f32 v113, v113
    v_exp_f32 v114, v114
    v_exp_f32 v115, v115
    v_exp_f32 v116, v116
    v_exp_f32 v117, v117
    v_exp_f32 v118, v118
    v_exp_f32 v119, v119
    v_exp_f32 v120, v120
    v_exp_f32 v121, v121
    v_exp_f32 v122, v122
    v_exp_f32 v123, v123
    v_exp_f32 v124, v124
    v_exp_f32 v125, v125
    v_exp_f32 v126, v126
    v_exp_f32 v127, v127
    v_exp_f32 v128, v128
    v_exp_f32 v129, v129
    v_exp_f32 v130, v130
    v_exp_f32 v131, v131
    s_nop 1
    v_add_f32 v19, v112, v113
    v_add_f32 v19, v19, v114
    v_add_f32 v19, v19, v115
    v_add_f32 v19, v19, v116
    v_add_f32 v19, v19, v117
    v_add_f32 v19, v19, v118
    v_add_f32 v19, v19, v119
    v_add_f32 v19, v19, v120
    v_add_f32 v19, v19, v121
    v_add_f32 v19, v19, v122
    v_add_f32 v19, v19, v123
    v_add_f32 v19, v19, v124
    v_add_f32 v19, v19, v125
    v_add_f32 v19, v19, v126
    v_add_f32 v19, v19, v127
    v_add_f32 v19, v19, v128
    v_add_f32 v19, v19, v129
    v_add_f32 v19, v19, v130
    v_add_f32 v19, v19, v131
    v_mov_b32 v20, v19
    v_mov_b32 v21, v19
    s_nop 1
    v_permlane32_swap_b32 v20, v21
    s_nop 1
    v_add_f32 v19, v20, v21
    v_rcp_f32 v19, v19
    s_nop 1
    v_mul_f32 v112, v112, v19
    v_mul_f32 v113, v113, v19
    v_mul_f32 v114, v114, v19
    v_mul_f32 v115, v115, v19
    v_mul_f32 v116, v116, v19
    v_mul_f32 v117, v117, v19
    v_mul_f32 v118, v118, v19
    v_mul_f32 v119, v119, v19
    v_mul_f32 v120, v120, v19
    v_mul_f32 v121, v121, v19
    v_mul_f32 v122, v122, v19
    v_mul_f32 v123, v123, v19
    v_mul_f32 v124, v124, v19
    v_mul_f32 v125, v125, v19
    v_mul_f32 v126, v126, v19
    v_mul_f32 v127, v127, v19
    v_mul_f32 v128, v128, v19
    v_mul_f32 v129, v129, v19
    v_mul_f32 v130, v130, v19
    v_mul_f32 v131, v131, v19
    v_cvt_pk_bf16_f32 v24, v112, v113
    v_cvt_pk_bf16_f32 v25, v114, v115
    v_cvt_pk_bf16_f32 v26, v116, v117
    v_cvt_pk_bf16_f32 v27, v118, v119
    v_cvt_pk_bf16_f32 v28, v120, v121
    v_cvt_pk_bf16_f32 v29, v122, v123
    v_cvt_pk_bf16_f32 v30, v124, v125
    v_cvt_pk_bf16_f32 v31, v126, v127
    v_cvt_pk_bf16_f32 v32, v128, v129
    v_cvt_pk_bf16_f32 v33, v130, v131
    v_mov_b32 v34, 0
    v_mov_b32 v35, 0
    s_waitcnt vmcnt(0)
    s_nop 1
    v_mfma_f32_32x32x16_bf16 v[48:63], v[144:147], v[24:27], 0
    v_mfma_f32_32x32x16_bf16 v[48:63], v[148:151], v[28:31], v[48:63]
    v_mfma_f32_32x32x16_bf16 v[48:63], v[152:155], v[32:35], v[48:63]
    v_mfma_f32_32x32x16_bf16 v[64:79], v[156:159], v[24:27], 0
    v_mfma_f32_32x32x16_bf16 v[64:79], v[160:163], v[28:31], v[64:79]
    v_mfma_f32_32x32x16_bf16 v[64:79], v[164:167], v[32:35], v[64:79]
    v_mfma_f32_32x32x16_bf16 v[80:95], v[168:171], v[24:27], 0
    v_mfma_f32_32x32x16_bf16 v[80:95], v[172:175], v[28:31], v[80:95]
    v_mfma_f32_32x32x16_bf16 v[80:95], v[176:179], v[32:35], v[80:95]
    v_mfma_f32_32x32x16_bf16 v[96:111], v[180:183], v[24:27], 0
    v_mfma_f32_32x32x16_bf16 v[96:111], v[184:187], v[28:31], v[96:111]
    v_mfma_f32_32x32x16_bf16 v[96:111], v[188:191], v[32:35], v[96:111]
    s_lshl_b32 s28, s16, 18
    s_lshl_b32 s29, s17, 13
    s_add_u32 s28, s28, s29
    s_add_u32 s28, s28, 116391936
    v_lshlrev_b32 v4, 4, v1
    v_add_u32 v4, s28, v4
    s_movk_i32 s29, 0x1000
    s_nop 15
    s_nop 7
    v_cvt_pk_bf16_f32 v16, v48, v49
    v_cvt_pk_bf16_f32 v17, v50, v51
    v_cvt_pk_bf16_f32 v18, v52, v53
    v_cvt_pk_bf16_f32 v19, v54, v55
    v_cvt_pk_bf16_f32 v20, v56, v57
    v_cvt_pk_bf16_f32 v21, v58, v59
    v_cvt_pk_bf16_f32 v22, v60, v61
    v_cvt_pk_bf16_f32 v23, v62, v63
    s_nop 1
    v_permlane32_swap_b32 v16, v18
    v_permlane32_swap_b32 v17, v19
    v_permlane32_swap_b32 v20, v22
    v_permlane32_swap_b32 v21, v23
    s_nop 1
    buffer_store_dwordx4 v[16:19], v4, s[8:11], 0 offen offset:0
    buffer_store_dwordx4 v[20:23], v4, s[8:11], 0 offen offset:1024
    v_cvt_pk_bf16_f32 v24, v64, v65
    v_cvt_pk_bf16_f32 v25, v66, v67
    v_cvt_pk_bf16_f32 v26, v68, v69
    v_cvt_pk_bf16_f32 v27, v70, v71
    v_cvt_pk_bf16_f32 v28, v72, v73
    v_cvt_pk_bf16_f32 v29, v74, v75
    v_cvt_pk_bf16_f32 v30, v76, v77
    v_cvt_pk_bf16_f32 v31, v78, v79
    s_nop 1
    v_permlane32_swap_b32 v24, v26
    v_permlane32_swap_b32 v25, v27
    v_permlane32_swap_b32 v28, v30
    v_permlane32_swap_b32 v29, v31
    s_nop 1
    buffer_store_dwordx4 v[24:27], v4, s[8:11], 0 offen offset:2048
    buffer_store_dwordx4 v[28:31], v4, s[8:11], 0 offen offset:3072
    v_cvt_pk_bf16_f32 v16, v80, v81
    v_cvt_pk_bf16_f32 v17, v82, v83
    v_cvt_pk_bf16_f32 v18, v84, v85
    v_cvt_pk_bf16_f32 v19, v86, v87
    v_cvt_pk_bf16_f32 v20, v88, v89
    v_cvt_pk_bf16_f32 v21, v90, v91
    v_cvt_pk_bf16_f32 v22, v92, v93
    v_cvt_pk_bf16_f32 v23, v94, v95
    s_nop 1
    v_permlane32_swap_b32 v16, v18
    v_permlane32_swap_b32 v17, v19
    v_permlane32_swap_b32 v20, v22
    v_permlane32_swap_b32 v21, v23
    s_nop 1
    buffer_store_dwordx4 v[16:19], v4, s[8:11], s29 offen offset:0
    buffer_store_dwordx4 v[20:23], v4, s[8:11], s29 offen offset:1024
    v_cvt_pk_bf16_f32 v24, v96, v97
    v_cvt_pk_bf16_f32 v25, v98, v99
    v_cvt_pk_bf16_f32 v26, v100, v101
    v_cvt_pk_bf16_f32 v27, v102, v103
    v_cvt_pk_bf16_f32 v28, v104, v105
    v_cvt_pk_bf16_f32 v29, v106, v107
    v_cvt_pk_bf16_f32 v30, v108, v109
    v_cvt_pk_bf16_f32 v31, v110, v111
    s_nop 1
    v_permlane32_swap_b32 v24, v26
    v_permlane32_swap_b32 v25, v27
    v_permlane32_swap_b32 v28, v30
    v_permlane32_swap_b32 v29, v31
    s_nop 1
    buffer_store_dwordx4 v[24:27], v4, s[8:11], s29 offen offset:2048
    buffer_store_dwordx4 v[28:31], v4, s[8:11], s29 offen offset:3072
    s_waitcnt vmcnt(0)
    s_endpgm
.k3_end:
    s_endpgm
.globl k4_tail_kernel
.p2align 8
.type k4_tail_kernel,@function
k4_tail_kernel:
    s_cmp_ge_u32 s2, 240
    s_cbranch_scc1 .k4_end
    s_load_dwordx2 s[4:5], s[0:1], 96
    s_load_dwordx2 s[6:7], s[0:1], 80
    v_lshrrev_b32 v1, 6, v0
    s_nop 1
    v_readfirstlane_b32 s18, v1
    v_and_b32 v1, 63, v0
    v_and_b32 v2, 31, v1
    v_lshrrev_b32 v3, 5, v1

    s_mul_i32 s17, s2, 5462
    s_lshr_b32 s17, s17, 16
    s_mul_i32 s16, s17, 12
    s_sub_u32 s16, s2, s16
    s_waitcnt lgkmcnt(0)

    s_mov_b32 s8, s4
    s_mov_b32 s9, s5
    s_mov_b32 s10, 268435456
    s_mov_b32 s11, 0x00020000
    s_mov_b32 s12, s6
    s_mov_b32 s13, s7
    s_mov_b32 s14, 5242880
    s_mov_b32 s15, 0x00020000
    v_lshlrev_b32 v4, 4, v1
    s_lshl_b32 s28, s18, 15
    s_lshl_b32 s29, s17, 18
    s_add_u32 s29, s29, s28
    s_add_u32 s29, s29, 27262976
    v_add_u32 v5, s29, v4
    s_lshl_b32 s29, s16, 18
    s_add_u32 s29, s29, s28
    s_add_u32 s29, s29, 130023424
    v_add_u32 v4, s29, v4

    s_movk_i32 s28, 0
    buffer_load_dwordx4 v[24:27], v5, s[8:11], s28 offen offset:0
    buffer_load_dwordx4 v[28:31], v4, s[8:11], s28 offen offset:0
    buffer_load_dwordx4 v[32:35], v5, s[8:11], s28 offen offset:1024
    buffer_load_dwordx4 v[36:39], v4, s[8:11], s28 offen offset:1024
    buffer_load_dwordx4 v[40:43], v5, s[8:11], s28 offen offset:2048
    buffer_load_dwordx4 v[44:47], v4, s[8:11], s28 offen offset:2048
    buffer_load_dwordx4 v[48:51], v5, s[8:11], s28 offen offset:3072
    buffer_load_dwordx4 v[52:55], v4, s[8:11], s28 offen offset:3072
    s_movk_i32 s28, 4096
    buffer_load_dwordx4 v[56:59], v5, s[8:11], s28 offen offset:0
    buffer_load_dwordx4 v[60:63], v4, s[8:11], s28 offen offset:0
    buffer_load_dwordx4 v[64:67], v5, s[8:11], s28 offen offset:1024
    buffer_load_dwordx4 v[68:71], v4, s[8:11], s28 offen offset:1024
    buffer_load_dwordx4 v[72:75], v5, s[8:11], s28 offen offset:2048
    buffer_load_dwordx4 v[76:79], v4, s[8:11], s28 offen offset:2048
    buffer_load_dwordx4 v[80:83], v5, s[8:11], s28 offen offset:3072
    buffer_load_dwordx4 v[84:87], v4, s[8:11], s28 offen offset:3072
    s_movk_i32 s28, 8192
    buffer_load_dwordx4 v[88:91], v5, s[8:11], s28 offen offset:0
    buffer_load_dwordx4 v[92:95], v4, s[8:11], s28 offen offset:0
    buffer_load_dwordx4 v[96:99], v5, s[8:11], s28 offen offset:1024
    buffer_load_dwordx4 v[100:103], v4, s[8:11], s28 offen offset:1024
    buffer_load_dwordx4 v[104:107], v5, s[8:11], s28 offen offset:2048
    buffer_load_dwordx4 v[108:111], v4, s[8:11], s28 offen offset:2048
    buffer_load_dwordx4 v[112:115], v5, s[8:11], s28 offen offset:3072
    buffer_load_dwordx4 v[116:119], v4, s[8:11], s28 offen offset:3072
    s_movk_i32 s28, 12288
    buffer_load_dwordx4 v[120:123], v5, s[8:11], s28 offen offset:0
    buffer_load_dwordx4 v[124:127], v4, s[8:11], s28 offen offset:0
    buffer_load_dwordx4 v[128:131], v5, s[8:11], s28 offen offset:1024
    buffer_load_dwordx4 v[132:135], v4, s[8:11], s28 offen offset:1024
    buffer_load_dwordx4 v[136:139], v5, s[8:11], s28 offen offset:2048
    buffer_load_dwordx4 v[140:143], v4, s[8:11], s28 offen offset:2048
    buffer_load_dwordx4 v[144:147], v5, s[8:11], s28 offen offset:3072
    buffer_load_dwordx4 v[148:151], v4, s[8:11], s28 offen offset:3072
    s_movk_i32 s28, 16384
    buffer_load_dwordx4 v[152:155], v5, s[8:11], s28 offen offset:0
    buffer_load_dwordx4 v[156:159], v4, s[8:11], s28 offen offset:0
    buffer_load_dwordx4 v[160:163], v5, s[8:11], s28 offen offset:1024
    buffer_load_dwordx4 v[164:167], v4, s[8:11], s28 offen offset:1024
    buffer_load_dwordx4 v[168:171], v5, s[8:11], s28 offen offset:2048
    buffer_load_dwordx4 v[172:175], v4, s[8:11], s28 offen offset:2048
    buffer_load_dwordx4 v[176:179], v5, s[8:11], s28 offen offset:3072
    buffer_load_dwordx4 v[180:183], v4, s[8:11], s28 offen offset:3072
    s_movk_i32 s28, 20480
    buffer_load_dwordx4 v[184:187], v5, s[8:11], s28 offen offset:0
    buffer_load_dwordx4 v[188:191], v4, s[8:11], s28 offen offset:0
    buffer_load_dwordx4 v[192:195], v5, s[8:11], s28 offen offset:1024
    buffer_load_dwordx4 v[196:199], v4, s[8:11], s28 offen offset:1024
    buffer_load_dwordx4 v[200:203], v5, s[8:11], s28 offen offset:2048
    buffer_load_dwordx4 v[204:207], v4, s[8:11], s28 offen offset:2048
    buffer_load_dwordx4 v[208:211], v5, s[8:11], s28 offen offset:3072
    buffer_load_dwordx4 v[212:215], v4, s[8:11], s28 offen offset:3072
    s_waitcnt vmcnt(32)
    v_mfma_f32_32x32x16_bf16 v[8:23], v[24:27], v[28:31], 0
    v_mfma_f32_32x32x16_bf16 v[8:23], v[32:35], v[36:39], v[8:23]
    v_mfma_f32_32x32x16_bf16 v[8:23], v[40:43], v[44:47], v[8:23]
    v_mfma_f32_32x32x16_bf16 v[8:23], v[48:51], v[52:55], v[8:23]
    v_mfma_f32_32x32x16_bf16 v[8:23], v[56:59], v[60:63], v[8:23]
    v_mfma_f32_32x32x16_bf16 v[8:23], v[64:67], v[68:71], v[8:23]
    v_mfma_f32_32x32x16_bf16 v[8:23], v[72:75], v[76:79], v[8:23]
    v_mfma_f32_32x32x16_bf16 v[8:23], v[80:83], v[84:87], v[8:23]
    s_nop 7
    s_movk_i32 s28, 24576
    buffer_load_dwordx4 v[24:27], v5, s[8:11], s28 offen offset:0
    buffer_load_dwordx4 v[28:31], v4, s[8:11], s28 offen offset:0
    buffer_load_dwordx4 v[32:35], v5, s[8:11], s28 offen offset:1024
    buffer_load_dwordx4 v[36:39], v4, s[8:11], s28 offen offset:1024
    buffer_load_dwordx4 v[40:43], v5, s[8:11], s28 offen offset:2048
    buffer_load_dwordx4 v[44:47], v4, s[8:11], s28 offen offset:2048
    buffer_load_dwordx4 v[48:51], v5, s[8:11], s28 offen offset:3072
    buffer_load_dwordx4 v[52:55], v4, s[8:11], s28 offen offset:3072
    s_movk_i32 s28, 28672
    buffer_load_dwordx4 v[56:59], v5, s[8:11], s28 offen offset:0
    buffer_load_dwordx4 v[60:63], v4, s[8:11], s28 offen offset:0
    buffer_load_dwordx4 v[64:67], v5, s[8:11], s28 offen offset:1024
    buffer_load_dwordx4 v[68:71], v4, s[8:11], s28 offen offset:1024
    buffer_load_dwordx4 v[72:75], v5, s[8:11], s28 offen offset:2048
    buffer_load_dwordx4 v[76:79], v4, s[8:11], s28 offen offset:2048
    buffer_load_dwordx4 v[80:83], v5, s[8:11], s28 offen offset:3072
    buffer_load_dwordx4 v[84:87], v4, s[8:11], s28 offen offset:3072
    s_waitcnt vmcnt(32)
    v_mfma_f32_32x32x16_bf16 v[8:23], v[88:91], v[92:95], v[8:23]
    v_mfma_f32_32x32x16_bf16 v[8:23], v[96:99], v[100:103], v[8:23]
    v_mfma_f32_32x32x16_bf16 v[8:23], v[104:107], v[108:111], v[8:23]
    v_mfma_f32_32x32x16_bf16 v[8:23], v[112:115], v[116:119], v[8:23]
    v_mfma_f32_32x32x16_bf16 v[8:23], v[120:123], v[124:127], v[8:23]
    v_mfma_f32_32x32x16_bf16 v[8:23], v[128:131], v[132:135], v[8:23]
    v_mfma_f32_32x32x16_bf16 v[8:23], v[136:139], v[140:143], v[8:23]
    v_mfma_f32_32x32x16_bf16 v[8:23], v[144:147], v[148:151], v[8:23]
    s_waitcnt vmcnt(16)
    v_mfma_f32_32x32x16_bf16 v[8:23], v[152:155], v[156:159], v[8:23]
    v_mfma_f32_32x32x16_bf16 v[8:23], v[160:163], v[164:167], v[8:23]
    v_mfma_f32_32x32x16_bf16 v[8:23], v[168:171], v[172:175], v[8:23]
    v_mfma_f32_32x32x16_bf16 v[8:23], v[176:179], v[180:183], v[8:23]
    v_mfma_f32_32x32x16_bf16 v[8:23], v[184:187], v[188:191], v[8:23]
    v_mfma_f32_32x32x16_bf16 v[8:23], v[192:195], v[196:199], v[8:23]
    v_mfma_f32_32x32x16_bf16 v[8:23], v[200:203], v[204:207], v[8:23]
    v_mfma_f32_32x32x16_bf16 v[8:23], v[208:211], v[212:215], v[8:23]
    s_waitcnt vmcnt(0)
    v_mfma_f32_32x32x16_bf16 v[8:23], v[24:27], v[28:31], v[8:23]
    v_mfma_f32_32x32x16_bf16 v[8:23], v[32:35], v[36:39], v[8:23]
    v_mfma_f32_32x32x16_bf16 v[8:23], v[40:43], v[44:47], v[8:23]
    v_mfma_f32_32x32x16_bf16 v[8:23], v[48:51], v[52:55], v[8:23]
    v_mfma_f32_32x32x16_bf16 v[8:23], v[56:59], v[60:63], v[8:23]
    v_mfma_f32_32x32x16_bf16 v[8:23], v[64:67], v[68:71], v[8:23]
    v_mfma_f32_32x32x16_bf16 v[8:23], v[72:75], v[76:79], v[8:23]
    v_mfma_f32_32x32x16_bf16 v[8:23], v[80:83], v[84:87], v[8:23]
    v_lshlrev_b32 v6, 4, v1
    s_lshl_b32 s28, s18, 12
    v_add_u32 v6, s28, v6
    s_nop 15
    s_nop 7

    ds_write_b128 v6, v[8:11] offset:0
    ds_write_b128 v6, v[12:15] offset:1024
    ds_write_b128 v6, v[16:19] offset:2048
    ds_write_b128 v6, v[20:23] offset:3072
    s_waitcnt lgkmcnt(0)
    s_barrier
    s_cmp_ge_u32 s18, 4
    s_cbranch_scc1 .k4_end
    v_lshlrev_b32 v6, 4, v0

    ds_read_b128 v[24:27], v6 offset:0
    ds_read_b128 v[28:31], v6 offset:4096
    ds_read_b128 v[32:35], v6 offset:8192
    ds_read_b128 v[36:39], v6 offset:12288
    ds_read_b128 v[40:43], v6 offset:16384
    ds_read_b128 v[44:47], v6 offset:20480
    ds_read_b128 v[48:51], v6 offset:24576
    ds_read_b128 v[52:55], v6 offset:28672
    v_mul_u32_u24 v4, 2560, v2
    v_lshlrev_b32 v5, 3, v3
    v_add_u32 v4, v4, v5
    s_mul_i32 s28, s16, 81920
    s_lshl_b32 s29, s17, 6
    s_add_u32 s28, s28, s29
    s_lshl_b32 s29, s18, 4
    s_add_u32 s28, s28, s29
    s_add_u32 s28, s28, 4259840
    v_add_u32 v4, s28, v4
    s_waitcnt lgkmcnt(0)

    v_pk_add_f32 v[24:25], v[24:25], v[40:41]
    v_pk_add_f32 v[26:27], v[26:27], v[42:43]
    v_pk_add_f32 v[28:29], v[28:29], v[44:45]
    v_pk_add_f32 v[30:31], v[30:31], v[46:47]
    v_pk_add_f32 v[32:33], v[32:33], v[48:49]
    v_pk_add_f32 v[34:35], v[34:35], v[50:51]
    v_pk_add_f32 v[36:37], v[36:37], v[52:53]
    v_pk_add_f32 v[38:39], v[38:39], v[54:55]
    v_pk_add_f32 v[24:25], v[24:25], v[32:33]
    v_pk_add_f32 v[26:27], v[26:27], v[34:35]
    v_pk_add_f32 v[28:29], v[28:29], v[36:37]
    v_pk_add_f32 v[30:31], v[30:31], v[38:39]
    v_pk_add_f32 v[24:25], v[24:25], v[28:29]
    v_pk_add_f32 v[26:27], v[26:27], v[30:31]
    v_cvt_pk_bf16_f32 v24, v24, v25
    v_cvt_pk_bf16_f32 v25, v26, v27
    buffer_store_dwordx2 v[24:25], v4, s[12:15], 0 offen
    s_waitcnt vmcnt(0)

.k4_end:
    s_endpgm
.section .rodata,"a"
.p2align 6
.amdhsa_kernel k0_transpose_kernel
  .amdhsa_next_free_vgpr 80
  .amdhsa_next_free_sgpr 102
  .amdhsa_accum_offset 80
  .amdhsa_group_segment_fixed_size 0
  .amdhsa_kernarg_size 104
  .amdhsa_user_sgpr_count 2
  .amdhsa_user_sgpr_kernarg_segment_ptr 1
  .amdhsa_system_sgpr_workgroup_id_x 1
.end_amdhsa_kernel
.p2align 6
.amdhsa_kernel k2_chain_kernel
  .amdhsa_next_free_vgpr 512
  .amdhsa_next_free_sgpr 102
  .amdhsa_accum_offset 256
  .amdhsa_group_segment_fixed_size 0
  .amdhsa_kernarg_size 104
  .amdhsa_user_sgpr_count 2
  .amdhsa_user_sgpr_kernarg_segment_ptr 1
  .amdhsa_system_sgpr_workgroup_id_x 1
.end_amdhsa_kernel
.p2align 6
.amdhsa_kernel k3_attn_kernel
  .amdhsa_next_free_vgpr 192
  .amdhsa_next_free_sgpr 102
  .amdhsa_accum_offset 192
  .amdhsa_group_segment_fixed_size 0
  .amdhsa_kernarg_size 104
  .amdhsa_user_sgpr_count 2
  .amdhsa_user_sgpr_kernarg_segment_ptr 1
  .amdhsa_system_sgpr_workgroup_id_x 1
.end_amdhsa_kernel
.p2align 6
.amdhsa_kernel k4_tail_kernel
  .amdhsa_next_free_vgpr 216
  .amdhsa_next_free_sgpr 102
  .amdhsa_accum_offset 216
  .amdhsa_group_segment_fixed_size 0
  .amdhsa_kernarg_size 104
  .amdhsa_user_sgpr_count 2
  .amdhsa_user_sgpr_kernarg_segment_ptr 1
  .amdhsa_system_sgpr_workgroup_id_x 1
.end_amdhsa_kernel
```
